```python
import torch

def _softmax(x, axis=-1):
    return torch.softmax(x, dim=axis)
def _gelu(x):
    return torch.nn.functional.gelu(x, approximate="tanh")
def _silu(x):
    return torch.nn.functional.silu(x)
def _sigmoid(x):
    return torch.sigmoid(x)
def _layernorm(x, axis=-1, eps=1e-5):
    m = x.mean(dim=axis, keepdim=True)
    v = x.var(dim=axis, keepdim=True, unbiased=False)
    return (x - m) / torch.sqrt(v + eps)
def _scatter_add(tgt, idx, src, axis=0):
    return tgt.clone().index_add_(axis, idx, src)
def _segment_sum(src, seg, n):
    out = torch.zeros((n,) + src.shape[1:], dtype=src.dtype)
    return out.index_add_(0, seg, src)
def _pad(x, pw):
    flat = tuple(v for pair in reversed(pw) for v in pair)
    return torch.nn.functional.pad(x, flat)

kernel_name = 'sequential_preLN__linear_attn_block__dense_activation_mish__prompt'

def setup_inputs():

    _w = (lambda a: (lambda t: t.to(torch.bfloat16) if t.is_floating_point() else t)(torch.as_tensor(a)))
    def _A_setup():
        B, S, D = 1, 2048, 512
        return {
            "x": _w((lambda *s: torch.randn(*s, dtype=torch.bfloat16) * 0.05)(B, S, D)),
            "wqkv": _w((lambda *s: torch.randn(*s, dtype=torch.bfloat16) * 0.05)(D, 3 * D)),
            "wo": _w((lambda *s: torch.randn(*s, dtype=torch.bfloat16) * 0.05)(D, D)),
        }
    _A_in = _A_setup()

    def _B_setup():
        B, S, D, F = 1, 2048, 512, 1792
        return {
            "x": _w((lambda *s: torch.randn(*s, dtype=torch.bfloat16) * 0.05)(B, S, D)),
            "w1": _w((lambda *s: torch.randn(*s, dtype=torch.bfloat16) * 0.8)(D, F) * (D ** -0.5)),
            "b1": _w((lambda *s: torch.randn(*s, dtype=torch.bfloat16) * 0.2)(F)),
            "w2": _w((lambda *s: torch.randn(*s, dtype=torch.bfloat16) * 0.1)(F, D) * (F ** -0.5)),
        }
    _B_in = _B_setup()

    return {
        "A_x": _A_in["x"],
        "A_wqkv": _A_in["wqkv"],
        "A_wo": _A_in["wo"],
        "B_x": _B_in["x"],
        "B_w1": _B_in["w1"],
        "B_b1": _B_in["b1"],
        "B_w2": _B_in["w2"],
    }

def reference(A_x, A_wqkv, A_wo, B_x, B_w1, B_b1, B_w2):
    def _A_ref(x, wqkv, wo):
        B, S, D = x.shape
        H = 32; Dh = D // H
        qkv = (lambda x, *d: x.permute(*d))((x @ wqkv).reshape(B, S, 3, H, Dh), 2, 0, 3, 1, 4)
        q, k, v = qkv[0], qkv[1], qkv[2]
        phi = lambda t: torch.where(t > 0, t + 1, torch.exp(t)) + 1e-6
        pq, pk = phi(q), phi(k)
        kv = torch.einsum("bhsd,bhse->bhde", pk, v)
        z = torch.einsum("bhsd->bhd", pk)
        num = torch.einsum("bhqd,bhde->bhqe", pq, kv)
        den = torch.einsum("bhqd,bhd->bhq", pq, z)[..., None] + 1e-6
        o = num / den
        return (lambda x, *d: x.permute(*d))(o, 0, 2, 1, 3).reshape(B, S, D) @ wo

    def _B_ref(x, w1, b1, w2):
        h = torch.einsum("bsd,df->bsf", x, w1) + b1
        sp = torch.log1p(torch.exp(-torch.abs(h))) + torch.where(h > 0, h, torch.zeros_like(h))
        act = h * torch.tanh(sp)
        return torch.einsum("bsf,fd->bsd", act, w2)

    x = A_x
    h = x + _A_ref(_layernorm(x, axis=-1), A_wqkv, A_wo)
    h2 = h + _B_ref(_layernorm(h, axis=-1), B_w1, B_b1, B_w2)
    return h2
```

```asm
; @launch grid=(256,1,1) block=(256,1,1) lds=163840
.amdgcn_target "amdgcn-amd-amdhsa--gfx950"
.text
.globl sequential_preLN__linear_attn_block__dense_activation_mish__prompt_kernel
.p2align 12
.type sequential_preLN__linear_attn_block__dense_activation_mish__prompt_kernel,@function
sequential_preLN__linear_attn_block__dense_activation_mish__prompt_kernel:
  s_cmp_ge_u32 s2, 256
  s_cbranch_scc1 L_end
  s_load_dwordx2 s[8:9], s[0:1], 0
  s_load_dwordx2 s[12:13], s[0:1], 8
  s_load_dwordx2 s[36:37], s[0:1], 72
  s_load_dwordx2 s[16:17], s[0:1], 48
  s_load_dwordx2 s[32:33], s[0:1], 64
  s_load_dwordx2 s[20:21], s[0:1], 32
  s_load_dwordx2 s[40:41], s[0:1], 40
  s_load_dwordx2 s[28:29], s[0:1], 56
  s_load_dwordx2 s[76:77], s[0:1], 16
  s_getpc_b64 s[26:27]
L_pc:
  s_lshl_b32 s57, s2, 10
  s_and_b32 s57, s57, 0xe000
  v_lshl_add_u32 v30, v0, 5, s57
  v_min_u32 v30, L_split_s-L_pc, v30
  global_load_dword a253, v30, s[26:27]
  s_mov_b32 s10, 2097152
  s_mov_b32 s11, 0x20000
  s_mov_b32 s14, 1572864
  s_mov_b32 s15, 0x20000
  s_mov_b32 s38, 17825792
  s_mov_b32 s39, 0x20000
  s_mov_b32 s34, 256
  s_mov_b32 s35, 0x20000
  s_mov_b32 s18, 1835008
  s_mov_b32 s19, 0x20000
  s_mov_b32 s22, 1835008
  s_mov_b32 s23, 0x20000
  s_mov_b32 s42, 3584
  s_mov_b32 s43, 0x20000
  s_mov_b32 s30, 2097152
  s_mov_b32 s31, 0x20000
  v_lshrrev_b32 v30, 6, v0
  v_and_b32 v1, 63, v0
  v_readfirstlane_b32 s3, v30
  v_lshlrev_b32 v2, 4, v1
  v_lshlrev_b32 v3, 2, v0
  s_and_b32 s4, s2, 7
  s_lshl_b32 s4, s4, 1
  s_bfe_u32 s57, s2, 0x10003
  s_add_u32 s4, s4, s57
  s_lshr_b32 s5, s2, 4
  s_lshl_b32 s64, s4, 2
  s_add_u32 s64, s64, s3
  s_lshr_b32 s54, s5, 1
  s_and_b32 s58, s5, 1
  s_lshl_b32 s58, s58, 1
  s_add_u32 s54, s54, s58
  s_lshl_b32 s57, s57, 2
  s_add_u32 s54, s54, s57
  s_and_b32 s58, s2, 7
  s_add_u32 s54, s54, s58
  s_and_b32 s54, s54, 7
  v_lshrrev_b32 v30, 4, v1
  v_and_b32 v31, 7, v1
  v_xor_b32 v30, v30, v31
  v_lshlrev_b32 v30, 4, v30
  v_lshrrev_b32 v31, 3, v1
  v_lshl_add_u32 v30, v31, 10, v30
  s_lshl_b32 s57, s64, 15
  v_add_u32 v4, s57, v30
  v_xor_b32 v5, 64, v4
  v_add_u32 v5, 7168, v5
  v_add_u32 v6, 14336, v4
  v_add_u32 v7, 14336, v5
  v_lshrrev_b32 v30, 2, v0
  v_mul_u32_u24 v30, 3072, v30
  v_and_b32 v31, 0x30, v2
  s_lshl_b32 s57, s5, 6
  v_add3_u32 v9, v30, v31, s57
  v_add_u32 v8, 1024, v9
  s_lshl_b32 s62, s3, 12
  s_lshl_b32 s63, s3, 11
  s_mov_b32 s69, s54
  s_mov_b32 s100, s54
  s_lshr_b32 s67, s5, 1
  s_xor_b32 s67, s67, 4
  s_sub_u32 s101, s67, s54
  s_and_b32 s101, s101, 7
  v_mov_b32 v24, 0
  v_mov_b32 v25, 0
  v_mov_b32 v26, 0
  v_mov_b32 v27, 0
  v_lshlrev_b32 v28, 4, v0
  s_lshl_b32 s61, s2, 12
  s_add_u32 s60, s61, 65536
  s_waitcnt lgkmcnt(0)
  s_cmp_lt_u32 s2, 16
  s_cbranch_scc0 L_noinit_1
  buffer_store_dwordx4 v[24:27], v28, s[36:39], s61 offen sc1
  buffer_store_dwordx4 v[24:27], v28, s[36:39], s60 offen sc1
L_noinit_1:
  s_mul_i32 s56, s69, 196608
  s_add_u32 m0, s63, 32768
  s_add_u32 s69, s69, 1
  buffer_load_dwordx4 v8, s[12:15], s56 offen lds
  s_and_b32 s69, s69, 7
  buffer_load_dwordx4 v8, s[12:15], s56 offen offset:1024 lds
  s_lshl_b32 s55, s54, 7
  s_add_u32 m0, s62, 98304
  s_add_u32 s54, s54, 1
  buffer_load_dwordx4 v4, s[8:11], s55 offen offset:0 lds
  s_and_b32 s54, s54, 7
  buffer_load_dwordx4 v5, s[8:11], s55 offen offset:1024 lds
  buffer_load_dwordx4 v6, s[8:11], s55 offen offset:2048 lds
  buffer_load_dwordx4 v7, s[8:11], s55 offen offset:3072 lds
  s_mul_i32 s56, s69, 196608
  s_add_u32 m0, s63, 40960
  s_add_u32 s69, s69, 1
  buffer_load_dwordx4 v8, s[12:15], s56 offen lds
  s_mov_b32 s44, 0x3f803f80
  s_mov_b32 s46, 0
  s_mov_b32 s47, -1
  s_mov_b32 s48, 0xffff0000
  s_mov_b32 s49, 0xffff0000
  s_mov_b32 s52, 0x358637bd
  s_mov_b32 s53, 0x358637bd
  s_mov_b32 s24, 0x3f317218
  s_and_b32 s69, s69, 7
  buffer_load_dwordx4 v8, s[12:15], s56 offen offset:1024 lds
  s_mov_b32 s25, 0x3f317218
  s_lshl_b32 s68, s3, 10
  s_getreg_b32 s45, hwreg(HW_REG_XCC_ID)
  s_and_b32 s45, s45, 15
  s_or_b32 s45, s45, 0x100
  v_lshrrev_b32 v30, 5, v0
  v_bfe_u32 v31, v1, 1, 3
  v_xor_b32 v30, v30, v31
  s_mul_i32 s56, s69, 196608
  s_add_u32 m0, s63, 49152
  s_add_u32 s69, s69, 1
  buffer_load_dwordx4 v8, s[12:15], s56 offen lds
  v_lshlrev_b32 v30, 4, v30
  v_and_b32 v31, 31, v1
  v_lshl_add_u32 v30, v31, 7, v30
  s_add_u32 s57, s62, 98304
  v_add_u32 v10, s57, v30
  v_xor_b32 v11, 32, v10
  v_xor_b32 v12, 64, v10
  v_xor_b32 v13, 96, v10
  s_and_b32 s69, s69, 7
  buffer_load_dwordx4 v8, s[12:15], s56 offen offset:1024 lds
  s_and_b32 s57, s5, 1
  s_lshl_b32 s57, s57, 1
  s_lshr_b32 s58, s3, 1
  s_add_u32 s57, s57, s58
  s_xor_b32 s57, s57, s3
  s_lshl_b32 s57, s57, 12
  s_and_b32 s58, s3, 1
  s_lshl_b32 s58, s58, 1
  s_lshl_b32 s55, s54, 7
  s_add_u32 m0, s62, 114688
  s_add_u32 s54, s54, 1
  buffer_load_dwordx4 v4, s[8:11], s55 offen offset:0 lds
  s_xor_b32 s58, s58, s3
  s_lshl_b32 s58, s58, 5
  s_or_b32 s57, s57, s58
  v_xor_b32 v28, s57, v10
  v_xor_b32 v29, 32, v28
  v_bfe_u32 v31, v1, 2, 2
  v_lshlrev_b32 v30, 6, v31
  v_bfe_u32 v31, v1, 4, 1
  s_and_b32 s54, s54, 7
  buffer_load_dwordx4 v5, s[8:11], s55 offen offset:1024 lds
  v_lshl_add_u32 v30, v31, 5, v30
  v_and_b32 v31, 3, v1
  v_lshl_add_u32 v30, v31, 3, v30
  v_lshrrev_b32 v31, 5, v1
  s_add_u32 s57, s63, 32768
  v_add_u32 v30, s57, v30
  v_lshl_add_u32 v14, v31, 9, v30
  v_xor_b32 v15, 2048, v14
  buffer_load_dwordx4 v6, s[8:11], s55 offen offset:2048 lds
  v_xor_b32 v16, 4096, v14
  v_xor_b32 v17, 6144, v14
  s_mul_i32 s58, s3, 3328
  s_add_u32 s58, s58, 147456
  v_bfe_u32 v30, v1, 4, 1
  v_mul_u32_u24 v30, 102, v30
  v_lshrrev_b32 v31, 5, v1
  v_mad_u32_u24 v32, v31, 17, v30
  buffer_load_dwordx4 v7, s[8:11], s55 offen offset:3072 lds
  v_and_b32 v31, 15, v1
  v_add_u32 v32, v32, v31
  v_lshl_add_u32 v32, v32, 4, s58
  v_accvgpr_write_b32 a128, v32
  v_and_b32 v33, 3, v1
  v_bfe_u32 v31, v1, 3, 1
  v_lshl_add_u32 v33, v31, 2, v33
  v_mul_u32_u24 v31, 11, v33
  s_waitcnt vmcnt(8)
  s_barrier
  s_cmp_eq_u32 s101, 0
  s_cselect_b64 exec, -1, 0
  ds_read_b128 a[136:139], v28 offset:0
  ds_read_b128 a[140:143], v29 offset:0
  s_mov_b64 exec, -1
  ds_read_b128 v[128:131], v10 offset:0
  ds_read_b128 v[132:135], v11 offset:0
  ds_read_b128 v[136:139], v12 offset:0
  ds_read_b128 v[140:143], v13 offset:0
  ds_read_b64_tr_b16 v[64:65], v14 offset:0
  ds_read_b64_tr_b16 v[66:67], v14 offset:256
  ds_read_b64_tr_b16 v[68:69], v14 offset:1024
  ds_read_b64_tr_b16 v[70:71], v14 offset:1280
  ds_read_b64_tr_b16 v[72:73], v15 offset:0
  ds_read_b64_tr_b16 v[74:75], v15 offset:256
  ds_read_b64_tr_b16 v[76:77], v15 offset:1024
  ds_read_b64_tr_b16 v[78:79], v15 offset:1280
  ds_read_b64_tr_b16 v[80:81], v16 offset:0
  ds_read_b64_tr_b16 v[82:83], v16 offset:256
  ds_read_b64_tr_b16 v[84:85], v16 offset:1024
  ds_read_b64_tr_b16 v[86:87], v16 offset:1280
  ds_read_b64_tr_b16 v[88:89], v17 offset:0
  ds_read_b64_tr_b16 v[90:91], v17 offset:256
  ds_read_b64_tr_b16 v[92:93], v17 offset:1024
  ds_read_b64_tr_b16 v[94:95], v17 offset:1280
  s_mul_i32 s56, s69, 196608
  s_add_u32 m0, s63, 57344
  s_add_u32 s69, s69, 1
  buffer_load_dwordx4 v8, s[12:15], s56 offen lds
  v_lshrrev_b32 v31, 5, v31
  v_mul_u32_u24 v31, 133, v31
  v_add_u32 v33, v33, v31
  v_bfe_u32 v31, v1, 2, 1
  v_mad_u32_u24 v31, v31, 17, v30
  v_lshl_add_u32 v33, v31, 2, v33
  v_add_u32 v33, 64, v33
  v_bfe_u32 v30, v1, 1, 3
  s_and_b32 s69, s69, 7
  buffer_load_dwordx4 v8, s[12:15], s56 offen offset:1024 lds
  v_bfe_u32 v31, v1, 1, 1
  v_mad_u32_u24 v31, v31, 3, 2
  v_cmp_gt_u32 vcc, 6, v30
  v_mov_b32 v32, 0x3e800000
  s_nop 0
  v_cndmask_b32 v30, v31, v30, vcc
  v_mul_u32_u24 v30, 136, v30
  v_and_b32 v31, 1, v1
  v_mul_u32_u24 v31, 68, v31
  s_lshl_b32 s55, s54, 7
  s_add_u32 m0, s62, 131072
  s_add_u32 s54, s54, 1
  buffer_load_dwordx4 v4, s[8:11], s55 offen offset:0 lds
  v_add3_u32 v30, v30, v31, 64
  v_cndmask_b32 v31, 2, 3, vcc
  v_add_u32 v30, v30, v31
  v_cndmask_b32 v32, 0, v32, vcc
  v_cndmask_b32 v33, v33, v30, s[46:47]
  v_accvgpr_write_b32 a130, v32
  v_lshl_add_u32 v33, v33, 2, s58
  v_accvgpr_write_b32 a129, v33
  s_and_b32 s54, s54, 7
  buffer_load_dwordx4 v5, s[8:11], s55 offen offset:1024 lds
  v_lshrrev_b32 v33, 3, v1
  s_lshl_b32 s57, s3, 4
  v_add_u32 v30, s57, v33
  v_mul_u32_u24 v30, 3584, v30
  v_and_b32 v31, 0x70, v2
  v_and_b32 v32, 16, v1
  v_lshlrev_b32 v32, 2, v32
  v_xor_b32 v31, v31, v32
  buffer_load_dwordx4 v6, s[8:11], s55 offen offset:2048 lds
  s_lshl_b32 s57, s5, 8
  s_and_b32 s58, s2, 31
  s_lshl_b32 s58, s58, 7
  s_cmp_lt_u32 s2, 224
  s_cselect_b32 s57, s57, s58
  v_add3_u32 v30, v30, v31, s57
  v_accvgpr_write_b32 a131, v30
  v_lshl_add_u32 v30, v33, 10, v31
  buffer_load_dwordx4 v7, s[8:11], s55 offen offset:3072 lds
  v_accvgpr_write_b32 a132, v30
  s_and_b32 s57, s4, 1
  s_lshl_b32 s50, s57, 2
  s_xor_b32 s50, s50, s67
  s_lshr_b32 s58, s4, 1
  s_xor_b32 s50, s50, s58
  s_lshl_b32 s57, s57, 3
  s_and_b32 s58, s5, 1
  s_lshl_b32 s58, s58, 2
  s_or_b32 s57, s57, s58
  s_xor_b32 s51, s57, s67
  s_xor_b32 s57, s51, s3
  s_lshl_b32 s57, s57, 15
  s_lshl_b32 s58, s67, 7
  s_or_b32 s75, s57, s58
  s_add_u32 s66, s2, 32
  s_and_b32 s66, s66, 0x100
  s_lshl_b32 s66, s66, 22
  s_add_u32 s66, s66, 128
  s_lshr_b32 s71, 0xbf80, s5
  s_and_b32 s71, s71, 1
  s_mul_i32 s57, s71, 7
  s_sub_u32 s57, s5, s57
  s_min_u32 s99, s57, 7
  s_lshl_b32 s57, s99, 2
  s_xor_b32 s99, s99, 4
  s_mov_b32 s96, 0x06543210
  s_mov_b32 s97, 0x654321
  s_lshr_b64 s[96:97], s[96:97], s57
  s_mul_i32 s57, s71, 0x7777777
  s_add_u32 s94, s96, s57
  s_and_b32 s57, s94, 15
  s_lshl_b32 s57, s57, 17
  s_lshl_b32 s58, s3, 14
  s_add_u32 s95, s57, s58
  s_and_b32 s58, s58, 0x4000
  s_lshr_b32 s57, s3, 1
  s_lshl_b32 s57, s57, 2
  s_lshr_b32 s57, s94, s57
  s_bfe_u32 s59, s57, 0x40004
  s_lshl_b32 s59, s59, 17
  s_add_u32 s96, s59, s58
  s_bfe_u32 s59, s57, 0x4000c
  s_lshl_b32 s59, s59, 17
  s_add_u32 s97, s59, s58
  s_bfe_u32 s59, s57, 0x40014
  s_lshl_b32 s59, s59, 17
  s_add_u32 s98, s59, s58
  s_lshl_b32 s72, s64, 9
  s_lshl_b32 s58, s5, 2
  s_add_u32 s72, s72, s58
  s_add_u32 s72, s72, 65536
  v_bfe_u32 v31, v1, 2, 2
  v_lshlrev_b32 v30, 7, v31
  v_and_b32 v31, 8, v1
  v_lshl_add_u32 v30, v31, 3, v30
  v_bfe_u32 v31, v1, 4, 1
  v_lshl_add_u32 v30, v31, 5, v30
  v_and_b32 v31, 3, v1
  v_lshl_add_u32 v30, v31, 3, v30
  v_lshrrev_b32 v31, 5, v1
  v_lshl_add_u32 v30, v31, 9, v30
  v_accvgpr_write_b32 a133, v30
  s_and_b32 s57, s5, 1
  s_lshl_b32 s57, s57, 1
  s_lshl_b32 s58, s4, 2
  s_add_u32 s59, s57, s58
  s_lshr_b32 s58, s3, 1
  s_add_u32 s65, s59, s58
  s_lshl_b32 s57, s67, 1
  s_and_b32 s58, s3, 1
  s_add_u32 s73, s57, s58
  s_lshl_b32 s74, s65, 9
  s_add_u32 s74, s74, 65536
  s_lshl_b32 s57, s65, 15
  s_lshl_b32 s58, s73, 11
  s_add_u32 s57, s57, s58
  s_add_u32 s57, s57, 0
  s_lshl_b32 s59, s65, 12
  s_lshl_b32 s58, s67, 9
  s_add_u32 s59, s59, s58
  s_add_u32 s59, s59, 262144
  s_lshl_b32 s60, s64, 15
  s_lshl_b32 s58, s5, 11
  s_add_u32 s60, s60, s58
  s_add_u32 s60, s60, 1048576
  v_and_b32 v32, 15, v1
  v_lshlrev_b32 v32, 7, v32
  v_add_u32 v30, s60, v32
  v_and_b32 v31, 0x180, v32
  v_add_u32 v33, s59, v31
  v_cndmask_b32 v30, v30, v33, s[48:49]
  v_add_u32 v33, s74, v31
  v_cndmask_b32 v30, v30, v33, s[46:47]
  v_accvgpr_write_b32 a135, v30
  v_add_u32 v30, s57, v32
  v_accvgpr_write_b32 a134, v30
  v_lshrrev_b32 v30, 2, v1
  v_xor_b32 v30, v30, v1
  v_and_b32 v30, 4, v30
  v_cmp_eq_u32 vcc, 0, v30
  v_mov_b32 v31, 0x3f803f80
  s_nop 0
  v_cndmask_b32 v30, 0, v31, vcc
  v_accvgpr_write_b32 a148, v30
  v_accvgpr_write_b32 a149, v30
  v_accvgpr_write_b32 a150, v30
  v_accvgpr_write_b32 a151, v30
  s_and_b32 s58, s3, 1
  s_lshl_b32 s58, s58, 3
  s_xor_b32 s58, s58, s51
  s_lshl_b32 s57, s65, 4
  s_add_u32 s57, s57, s58
  s_lshl_b32 s57, s57, 11
  s_add_u32 s70, s57, 1048576
  s_and_b32 s58, s58, 8
  s_lshl_b32 s58, s58, 2
  s_add_u32 s51, s74, s58
  v_mov_b32 v18, 0
  v_mov_b32 v19, 0
  v_mov_b32 v20, 0
  v_mov_b32 v21, 0
  v_mov_b32 v22, 0
  v_mov_b32 v23, 0
  s_cmp_lt_u32 s2, 16
  s_cbranch_scc0 L_nofl_2
  s_cmp_eq_u32 s3, 0
  s_cbranch_scc0 L_nofl_2
  s_add_u32 s57, s2, 0
  s_lshl_b32 s57, s57, 2
  v_mov_b32 v30, 1
  s_mov_b64 exec, 1
  buffer_store_dword v30, v1, s[32:35], s57 offen sc1
  s_mov_b64 exec, -1
L_nofl_2:
  s_waitcnt lgkmcnt(14)
  v_dot2c_f32_bf16 v18, s44, v128
  v_dot2c_f32_bf16 v19, v128, v128
  v_dot2c_f32_bf16 v20, s44, v129
  v_dot2c_f32_bf16 v21, v129, v129
  v_dot2c_f32_bf16 v18, s44, v130
  v_dot2c_f32_bf16 v19, v130, v130
  v_dot2c_f32_bf16 v20, s44, v131
  v_dot2c_f32_bf16 v21, v131, v131
  v_dot2c_f32_bf16 v18, s44, v132
  v_dot2c_f32_bf16 v19, v132, v132
  v_dot2c_f32_bf16 v20, s44, v133
  v_dot2c_f32_bf16 v21, v133, v133
  v_dot2c_f32_bf16 v18, s44, v134
  v_dot2c_f32_bf16 v19, v134, v134
  v_dot2c_f32_bf16 v20, s44, v135
  v_dot2c_f32_bf16 v21, v135, v135
  v_dot2c_f32_bf16 v18, s44, v136
  v_dot2c_f32_bf16 v19, v136, v136
  v_dot2c_f32_bf16 v20, s44, v137
  v_dot2c_f32_bf16 v21, v137, v137
  v_dot2c_f32_bf16 v18, s44, v138
  v_dot2c_f32_bf16 v19, v138, v138
  v_dot2c_f32_bf16 v20, s44, v139
  v_dot2c_f32_bf16 v21, v139, v139
  v_dot2c_f32_bf16 v18, s44, v140
  v_dot2c_f32_bf16 v19, v140, v140
  v_dot2c_f32_bf16 v20, s44, v141
  v_dot2c_f32_bf16 v21, v141, v141
  v_dot2c_f32_bf16 v18, s44, v142
  v_dot2c_f32_bf16 v19, v142, v142
  v_dot2c_f32_bf16 v20, s44, v143
  v_dot2c_f32_bf16 v21, v143, v143
  v_dot2c_f32_bf16 v22, s44, v64
  s_waitcnt lgkmcnt(13)
  v_dot2c_f32_bf16 v23, s44, v68
  v_dot2c_f32_bf16 v22, s44, v65
  v_dot2c_f32_bf16 v23, s44, v69
  v_dot2c_f32_bf16 v22, s44, v66
  s_waitcnt lgkmcnt(12)
  v_dot2c_f32_bf16 v23, s44, v70
  v_dot2c_f32_bf16 v22, s44, v67
  v_dot2c_f32_bf16 v23, s44, v71
  s_waitcnt vmcnt(6)
  s_barrier
  v_mfma_f32_32x32x16_bf16 v[32:47], v[128:131], v[64:67], 0
  s_cmp_eq_u32 s101, 1
  s_cselect_b64 exec, -1, 0
  ds_read_b128 a[136:139], v28 offset:16384
  ds_read_b128 a[140:143], v29 offset:16384
  s_mov_b64 exec, -1
  ds_read_b128 v[144:147], v10 offset:16384
  ds_read_b128 v[148:151], v11 offset:16384
  ds_read_b128 v[152:155], v12 offset:16384
  s_mul_i32 s56, s69, 196608
  s_add_u32 m0, s63, 65536
  v_mfma_f32_32x32x16_bf16 v[48:63], v[128:131], v[68:71], 0
  s_waitcnt lgkmcnt(13)
  ds_read_b128 v[156:159], v13 offset:16384
  ds_read_b64_tr_b16 v[96:97], v14 offset:8192
  ds_read_b64_tr_b16 v[98:99], v14 offset:8448
  s_add_u32 s69, s69, 1
  buffer_load_dwordx4 v8, s[12:15], s56 offen lds
  v_mfma_f32_32x32x16_bf16 v[32:47], v[132:135], v[72:75], v[32:47]
  s_waitcnt lgkmcnt(14)
  ds_read_b64_tr_b16 v[100:101], v14 offset:9216
  ds_read_b64_tr_b16 v[102:103], v14 offset:9472
  ds_read_b64_tr_b16 v[104:105], v15 offset:8192
  s_and_b32 s69, s69, 7
  buffer_load_dwordx4 v8, s[12:15], s56 offen offset:1024 lds
  v_mfma_f32_32x32x16_bf16 v[48:63], v[132:135], v[76:79], v[48:63]
  s_waitcnt lgkmcnt(14)
  ds_read_b64_tr_b16 v[106:107], v15 offset:8448
  ds_read_b64_tr_b16 v[108:109], v15 offset:9216
  ds_read_b64_tr_b16 v[110:111], v15 offset:9472
  s_lshl_b32 s55, s54, 7
  s_add_u32 m0, s62, 98304
  v_mfma_f32_32x32x16_bf16 v[32:47], v[136:139], v[80:83], v[32:47]
  s_waitcnt lgkmcnt(14)
  ds_read_b64_tr_b16 v[112:113], v16 offset:8192
  ds_read_b64_tr_b16 v[114:115], v16 offset:8448
  ds_read_b64_tr_b16 v[116:117], v16 offset:9216
  s_add_u32 s54, s54, 1
  buffer_load_dwordx4 v4, s[8:11], s55 offen offset:0 lds
  v_mfma_f32_32x32x16_bf16 v[48:63], v[136:139], v[84:87], v[48:63]
  ds_read_b64_tr_b16 v[118:119], v16 offset:9472
  ds_read_b64_tr_b16 v[120:121], v17 offset:8192
  ds_read_b64_tr_b16 v[122:123], v17 offset:8448
  s_and_b32 s54, s54, 7
  buffer_load_dwordx4 v5, s[8:11], s55 offen offset:1024 lds
  v_mfma_f32_32x32x16_bf16 v[32:47], v[140:143], v[88:91], v[32:47]
  s_waitcnt lgkmcnt(14)
  ds_read_b64_tr_b16 v[124:125], v17 offset:9216
  ds_read_b64_tr_b16 v[126:127], v17 offset:9472
  buffer_load_dwordx4 v6, s[8:11], s55 offen offset:2048 lds
  buffer_load_dwordx4 v7, s[8:11], s55 offen offset:3072 lds
  v_mfma_f32_32x32x16_bf16 v[48:63], v[140:143], v[92:95], v[48:63]
  s_waitcnt lgkmcnt(12)
  v_dot2c_f32_bf16 v18, s44, v144
  v_dot2c_f32_bf16 v19, v144, v144
  v_dot2c_f32_bf16 v20, s44, v145
  v_dot2c_f32_bf16 v21, v145, v145
  v_dot2c_f32_bf16 v18, s44, v146
  v_dot2c_f32_bf16 v19, v146, v146
  v_dot2c_f32_bf16 v20, s44, v147
  v_dot2c_f32_bf16 v21, v147, v147
  v_dot2c_f32_bf16 v18, s44, v148
  v_dot2c_f32_bf16 v19, v148, v148
  v_dot2c_f32_bf16 v20, s44, v149
  v_dot2c_f32_bf16 v21, v149, v149
  v_dot2c_f32_bf16 v18, s44, v150
  v_dot2c_f32_bf16 v19, v150, v150
  v_dot2c_f32_bf16 v20, s44, v151
  v_dot2c_f32_bf16 v21, v151, v151
  v_dot2c_f32_bf16 v18, s44, v152
  v_dot2c_f32_bf16 v19, v152, v152
  v_dot2c_f32_bf16 v20, s44, v153
  v_dot2c_f32_bf16 v21, v153, v153
  v_dot2c_f32_bf16 v18, s44, v154
  v_dot2c_f32_bf16 v19, v154, v154
  v_dot2c_f32_bf16 v20, s44, v155
  v_dot2c_f32_bf16 v21, v155, v155
  v_dot2c_f32_bf16 v18, s44, v156
  v_dot2c_f32_bf16 v19, v156, v156
  v_dot2c_f32_bf16 v20, s44, v157
  v_dot2c_f32_bf16 v21, v157, v157
  v_dot2c_f32_bf16 v18, s44, v158
  v_dot2c_f32_bf16 v19, v158, v158
  v_dot2c_f32_bf16 v20, s44, v159
  v_dot2c_f32_bf16 v21, v159, v159
  v_dot2c_f32_bf16 v22, s44, v96
  v_dot2c_f32_bf16 v23, s44, v100
  v_dot2c_f32_bf16 v22, s44, v97
  v_dot2c_f32_bf16 v23, s44, v101
  v_dot2c_f32_bf16 v22, s44, v98
  v_dot2c_f32_bf16 v23, s44, v102
  v_dot2c_f32_bf16 v22, s44, v99
  v_dot2c_f32_bf16 v23, s44, v103
  s_waitcnt vmcnt(6)
  s_barrier
  v_mfma_f32_32x32x16_bf16 v[32:47], v[144:147], v[96:99], v[32:47]
  s_cmp_eq_u32 s101, 2
  s_cselect_b64 exec, -1, 0
  ds_read_b128 a[136:139], v28 offset:32768
  ds_read_b128 a[140:143], v29 offset:32768
  s_mov_b64 exec, -1
  ds_read_b128 v[160:163], v10 offset:32768
  ds_read_b128 v[164:167], v11 offset:32768
  ds_read_b128 v[168:171], v12 offset:32768
  s_mul_i32 s56, s69, 196608
  s_add_u32 m0, s63, 73728
  v_mfma_f32_32x32x16_bf16 v[48:63], v[144:147], v[100:103], v[48:63]
  s_waitcnt lgkmcnt(13)
  ds_read_b128 v[172:175], v13 offset:32768
  ds_read_b64_tr_b16 v[64:65], v14 offset:16384
  ds_read_b64_tr_b16 v[66:67], v14 offset:16640
  s_add_u32 s69, s69, 1
  buffer_load_dwordx4 v8, s[12:15], s56 offen lds
  v_mfma_f32_32x32x16_bf16 v[32:47], v[148:151], v[104:107], v[32:47]
  s_waitcnt lgkmcnt(14)
  ds_read_b64_tr_b16 v[68:69], v14 offset:17408
  ds_read_b64_tr_b16 v[70:71], v14 offset:17664
  ds_read_b64_tr_b16 v[72:73], v15 offset:16384
  s_and_b32 s69, s69, 7
  buffer_load_dwordx4 v8, s[12:15], s56 offen offset:1024 lds
  v_mfma_f32_32x32x16_bf16 v[48:63], v[148:151], v[108:111], v[48:63]
  s_waitcnt lgkmcnt(14)
  ds_read_b64_tr_b16 v[74:75], v15 offset:16640
  ds_read_b64_tr_b16 v[76:77], v15 offset:17408
  ds_read_b64_tr_b16 v[78:79], v15 offset:17664
  s_lshl_b32 s55, s54, 7
  s_add_u32 m0, s62, 114688
  v_mfma_f32_32x32x16_bf16 v[32:47], v[152:155], v[112:115], v[32:47]
  s_waitcnt lgkmcnt(14)
  ds_read_b64_tr_b16 v[80:81], v16 offset:16384
  ds_read_b64_tr_b16 v[82:83], v16 offset:16640
  ds_read_b64_tr_b16 v[84:85], v16 offset:17408
  s_add_u32 s54, s54, 1
  buffer_load_dwordx4 v4, s[8:11], s55 offen offset:0 lds
  v_mfma_f32_32x32x16_bf16 v[48:63], v[152:155], v[116:119], v[48:63]
  ds_read_b64_tr_b16 v[86:87], v16 offset:17664
  ds_read_b64_tr_b16 v[88:89], v17 offset:16384
  ds_read_b64_tr_b16 v[90:91], v17 offset:16640
  s_and_b32 s54, s54, 7
  buffer_load_dwordx4 v5, s[8:11], s55 offen offset:1024 lds
  v_mfma_f32_32x32x16_bf16 v[32:47], v[156:159], v[120:123], v[32:47]
  s_waitcnt lgkmcnt(14)
  ds_read_b64_tr_b16 v[92:93], v17 offset:17408
  ds_read_b64_tr_b16 v[94:95], v17 offset:17664
  buffer_load_dwordx4 v6, s[8:11], s55 offen offset:2048 lds
  buffer_load_dwordx4 v7, s[8:11], s55 offen offset:3072 lds
  v_mfma_f32_32x32x16_bf16 v[48:63], v[156:159], v[124:127], v[48:63]
  s_waitcnt lgkmcnt(12)
  v_dot2c_f32_bf16 v18, s44, v160
  v_dot2c_f32_bf16 v19, v160, v160
  v_dot2c_f32_bf16 v20, s44, v161
  v_dot2c_f32_bf16 v21, v161, v161
  v_dot2c_f32_bf16 v18, s44, v162
  v_dot2c_f32_bf16 v19, v162, v162
  v_dot2c_f32_bf16 v20, s44, v163
  v_dot2c_f32_bf16 v21, v163, v163
  v_dot2c_f32_bf16 v18, s44, v164
  v_dot2c_f32_bf16 v19, v164, v164
  v_dot2c_f32_bf16 v20, s44, v165
  v_dot2c_f32_bf16 v21, v165, v165
  v_dot2c_f32_bf16 v18, s44, v166
  v_dot2c_f32_bf16 v19, v166, v166
  v_dot2c_f32_bf16 v20, s44, v167
  v_dot2c_f32_bf16 v21, v167, v167
  v_dot2c_f32_bf16 v18, s44, v168
  v_dot2c_f32_bf16 v19, v168, v168
  v_dot2c_f32_bf16 v20, s44, v169
  v_dot2c_f32_bf16 v21, v169, v169
  v_dot2c_f32_bf16 v18, s44, v170
  v_dot2c_f32_bf16 v19, v170, v170
  v_dot2c_f32_bf16 v20, s44, v171
  v_dot2c_f32_bf16 v21, v171, v171
  v_dot2c_f32_bf16 v18, s44, v172
  v_dot2c_f32_bf16 v19, v172, v172
  v_dot2c_f32_bf16 v20, s44, v173
  v_dot2c_f32_bf16 v21, v173, v173
  v_dot2c_f32_bf16 v18, s44, v174
  v_dot2c_f32_bf16 v19, v174, v174
  v_dot2c_f32_bf16 v20, s44, v175
  v_dot2c_f32_bf16 v21, v175, v175
  v_dot2c_f32_bf16 v22, s44, v64
  v_dot2c_f32_bf16 v23, s44, v68
  v_dot2c_f32_bf16 v22, s44, v65
  v_dot2c_f32_bf16 v23, s44, v69
  v_dot2c_f32_bf16 v22, s44, v66
  v_dot2c_f32_bf16 v23, s44, v70
  v_dot2c_f32_bf16 v22, s44, v67
  v_dot2c_f32_bf16 v23, s44, v71
  s_waitcnt vmcnt(6)
  s_barrier
  v_mfma_f32_32x32x16_bf16 v[32:47], v[160:163], v[64:67], v[32:47]
  s_cmp_eq_u32 s101, 3
  s_cselect_b64 exec, -1, 0
  ds_read_b128 a[136:139], v28 offset:0
  ds_read_b128 a[140:143], v29 offset:0
  s_mov_b64 exec, -1
  ds_read_b128 v[176:179], v10 offset:0
  ds_read_b128 v[180:183], v11 offset:0
  ds_read_b128 v[184:187], v12 offset:0
  s_mul_i32 s56, s69, 196608
  s_add_u32 m0, s63, 81920
  v_mfma_f32_32x32x16_bf16 v[48:63], v[160:163], v[68:71], v[48:63]
  s_waitcnt lgkmcnt(13)
  ds_read_b128 v[188:191], v13 offset:0
  ds_read_b64_tr_b16 v[96:97], v14 offset:24576
  ds_read_b64_tr_b16 v[98:99], v14 offset:24832
  s_add_u32 s69, s69, 1
  buffer_load_dwordx4 v8, s[12:15], s56 offen lds
  v_mfma_f32_32x32x16_bf16 v[32:47], v[164:167], v[72:75], v[32:47]
  s_waitcnt lgkmcnt(14)
  ds_read_b64_tr_b16 v[100:101], v14 offset:25600
  ds_read_b64_tr_b16 v[102:103], v14 offset:25856
  ds_read_b64_tr_b16 v[104:105], v15 offset:24576
  s_and_b32 s69, s69, 7
  buffer_load_dwordx4 v8, s[12:15], s56 offen offset:1024 lds
  v_mfma_f32_32x32x16_bf16 v[48:63], v[164:167], v[76:79], v[48:63]
  s_waitcnt lgkmcnt(14)
  ds_read_b64_tr_b16 v[106:107], v15 offset:24832
  ds_read_b64_tr_b16 v[108:109], v15 offset:25600
  ds_read_b64_tr_b16 v[110:111], v15 offset:25856
  s_lshl_b32 s55, s54, 7
  s_add_u32 m0, s62, 131072
  v_mfma_f32_32x32x16_bf16 v[32:47], v[168:171], v[80:83], v[32:47]
  s_waitcnt lgkmcnt(14)
  ds_read_b64_tr_b16 v[112:113], v16 offset:24576
  ds_read_b64_tr_b16 v[114:115], v16 offset:24832
  ds_read_b64_tr_b16 v[116:117], v16 offset:25600
  s_add_u32 s54, s54, 1
  buffer_load_dwordx4 v4, s[8:11], s55 offen offset:0 lds
  v_mfma_f32_32x32x16_bf16 v[48:63], v[168:171], v[84:87], v[48:63]
  ds_read_b64_tr_b16 v[118:119], v16 offset:25856
  ds_read_b64_tr_b16 v[120:121], v17 offset:24576
  ds_read_b64_tr_b16 v[122:123], v17 offset:24832
  s_and_b32 s54, s54, 7
  buffer_load_dwordx4 v5, s[8:11], s55 offen offset:1024 lds
  v_mfma_f32_32x32x16_bf16 v[32:47], v[172:175], v[88:91], v[32:47]
  s_waitcnt lgkmcnt(14)
  ds_read_b64_tr_b16 v[124:125], v17 offset:25600
  ds_read_b64_tr_b16 v[126:127], v17 offset:25856
  buffer_load_dwordx4 v6, s[8:11], s55 offen offset:2048 lds
  buffer_load_dwordx4 v7, s[8:11], s55 offen offset:3072 lds
  v_mfma_f32_32x32x16_bf16 v[48:63], v[172:175], v[92:95], v[48:63]
  s_waitcnt lgkmcnt(12)
  v_dot2c_f32_bf16 v18, s44, v176
  v_dot2c_f32_bf16 v19, v176, v176
  v_dot2c_f32_bf16 v20, s44, v177
  v_dot2c_f32_bf16 v21, v177, v177
  v_dot2c_f32_bf16 v18, s44, v178
  v_dot2c_f32_bf16 v19, v178, v178
  v_dot2c_f32_bf16 v20, s44, v179
  v_dot2c_f32_bf16 v21, v179, v179
  v_dot2c_f32_bf16 v18, s44, v180
  v_dot2c_f32_bf16 v19, v180, v180
  v_dot2c_f32_bf16 v20, s44, v181
  v_dot2c_f32_bf16 v21, v181, v181
  v_dot2c_f32_bf16 v18, s44, v182
  v_dot2c_f32_bf16 v19, v182, v182
  v_dot2c_f32_bf16 v20, s44, v183
  v_dot2c_f32_bf16 v21, v183, v183
  v_dot2c_f32_bf16 v18, s44, v184
  v_dot2c_f32_bf16 v19, v184, v184
  v_dot2c_f32_bf16 v20, s44, v185
  v_dot2c_f32_bf16 v21, v185, v185
  v_dot2c_f32_bf16 v18, s44, v186
  v_dot2c_f32_bf16 v19, v186, v186
  v_dot2c_f32_bf16 v20, s44, v187
  v_dot2c_f32_bf16 v21, v187, v187
  v_dot2c_f32_bf16 v18, s44, v188
  v_dot2c_f32_bf16 v19, v188, v188
  v_dot2c_f32_bf16 v20, s44, v189
  v_dot2c_f32_bf16 v21, v189, v189
  v_dot2c_f32_bf16 v18, s44, v190
  v_dot2c_f32_bf16 v19, v190, v190
  v_dot2c_f32_bf16 v20, s44, v191
  v_dot2c_f32_bf16 v21, v191, v191
  v_dot2c_f32_bf16 v22, s44, v96
  v_dot2c_f32_bf16 v23, s44, v100
  v_dot2c_f32_bf16 v22, s44, v97
  v_dot2c_f32_bf16 v23, s44, v101
  v_dot2c_f32_bf16 v22, s44, v98
  v_dot2c_f32_bf16 v23, s44, v102
  v_dot2c_f32_bf16 v22, s44, v99
  v_dot2c_f32_bf16 v23, s44, v103
  s_waitcnt vmcnt(6)
  s_barrier
  v_mfma_f32_32x32x16_bf16 v[32:47], v[176:179], v[96:99], v[32:47]
  s_cmp_eq_u32 s101, 4
  s_cselect_b64 exec, -1, 0
  ds_read_b128 a[136:139], v28 offset:16384
  ds_read_b128 a[140:143], v29 offset:16384
  s_mov_b64 exec, -1
  ds_read_b128 v[192:195], v10 offset:16384
  ds_read_b128 v[196:199], v11 offset:16384
  ds_read_b128 v[200:203], v12 offset:16384
  s_mul_i32 s56, s69, 196608
  s_add_u32 m0, s63, 90112
  v_mfma_f32_32x32x16_bf16 v[48:63], v[176:179], v[100:103], v[48:63]
  s_waitcnt lgkmcnt(13)
  ds_read_b128 v[204:207], v13 offset:16384
  ds_read_b64_tr_b16 v[64:65], v14 offset:32768
  ds_read_b64_tr_b16 v[66:67], v14 offset:33024
  s_add_u32 s69, s69, 1
  buffer_load_dwordx4 v8, s[12:15], s56 offen lds
  v_mfma_f32_32x32x16_bf16 v[32:47], v[180:183], v[104:107], v[32:47]
  s_waitcnt lgkmcnt(14)
  ds_read_b64_tr_b16 v[68:69], v14 offset:33792
  ds_read_b64_tr_b16 v[70:71], v14 offset:34048
  ds_read_b64_tr_b16 v[72:73], v15 offset:32768
  s_and_b32 s69, s69, 7
  buffer_load_dwordx4 v8, s[12:15], s56 offen offset:1024 lds
  v_mfma_f32_32x32x16_bf16 v[48:63], v[180:183], v[108:111], v[48:63]
  s_waitcnt lgkmcnt(14)
  ds_read_b64_tr_b16 v[74:75], v15 offset:33024
  ds_read_b64_tr_b16 v[76:77], v15 offset:33792
  ds_read_b64_tr_b16 v[78:79], v15 offset:34048
  s_lshl_b32 s55, s54, 7
  s_add_u32 m0, s62, 98304
  v_mfma_f32_32x32x16_bf16 v[32:47], v[184:187], v[112:115], v[32:47]
  s_waitcnt lgkmcnt(14)
  ds_read_b64_tr_b16 v[80:81], v16 offset:32768
  ds_read_b64_tr_b16 v[82:83], v16 offset:33024
  ds_read_b64_tr_b16 v[84:85], v16 offset:33792
  s_add_u32 s54, s54, 1
  buffer_load_dwordx4 v4, s[8:11], s55 offen offset:0 lds
  v_mfma_f32_32x32x16_bf16 v[48:63], v[184:187], v[116:119], v[48:63]
  ds_read_b64_tr_b16 v[86:87], v16 offset:34048
  ds_read_b64_tr_b16 v[88:89], v17 offset:32768
  ds_read_b64_tr_b16 v[90:91], v17 offset:33024
  s_and_b32 s54, s54, 7
  buffer_load_dwordx4 v5, s[8:11], s55 offen offset:1024 lds
  v_mfma_f32_32x32x16_bf16 v[32:47], v[188:191], v[120:123], v[32:47]
  s_waitcnt lgkmcnt(14)
  ds_read_b64_tr_b16 v[92:93], v17 offset:33792
  ds_read_b64_tr_b16 v[94:95], v17 offset:34048
  buffer_load_dwordx4 v6, s[8:11], s55 offen offset:2048 lds
  buffer_load_dwordx4 v7, s[8:11], s55 offen offset:3072 lds
  v_mfma_f32_32x32x16_bf16 v[48:63], v[188:191], v[124:127], v[48:63]
  s_waitcnt lgkmcnt(12)
  v_dot2c_f32_bf16 v18, s44, v192
  v_dot2c_f32_bf16 v19, v192, v192
  v_dot2c_f32_bf16 v20, s44, v193
  v_dot2c_f32_bf16 v21, v193, v193
  v_dot2c_f32_bf16 v18, s44, v194
  v_dot2c_f32_bf16 v19, v194, v194
  v_dot2c_f32_bf16 v20, s44, v195
  v_dot2c_f32_bf16 v21, v195, v195
  v_dot2c_f32_bf16 v18, s44, v196
  v_dot2c_f32_bf16 v19, v196, v196
  v_dot2c_f32_bf16 v20, s44, v197
  v_dot2c_f32_bf16 v21, v197, v197
  v_dot2c_f32_bf16 v18, s44, v198
  v_dot2c_f32_bf16 v19, v198, v198
  v_dot2c_f32_bf16 v20, s44, v199
  v_dot2c_f32_bf16 v21, v199, v199
  v_dot2c_f32_bf16 v18, s44, v200
  v_dot2c_f32_bf16 v19, v200, v200
  v_dot2c_f32_bf16 v20, s44, v201
  v_dot2c_f32_bf16 v21, v201, v201
  v_dot2c_f32_bf16 v18, s44, v202
  v_dot2c_f32_bf16 v19, v202, v202
  v_dot2c_f32_bf16 v20, s44, v203
  v_dot2c_f32_bf16 v21, v203, v203
  v_dot2c_f32_bf16 v18, s44, v204
  v_dot2c_f32_bf16 v19, v204, v204
  v_dot2c_f32_bf16 v20, s44, v205
  v_dot2c_f32_bf16 v21, v205, v205
  v_dot2c_f32_bf16 v18, s44, v206
  v_dot2c_f32_bf16 v19, v206, v206
  v_dot2c_f32_bf16 v20, s44, v207
  v_dot2c_f32_bf16 v21, v207, v207
  v_dot2c_f32_bf16 v22, s44, v64
  v_dot2c_f32_bf16 v23, s44, v68
  v_dot2c_f32_bf16 v22, s44, v65
  v_dot2c_f32_bf16 v23, s44, v69
  v_dot2c_f32_bf16 v22, s44, v66
  v_dot2c_f32_bf16 v23, s44, v70
  v_dot2c_f32_bf16 v22, s44, v67
  v_dot2c_f32_bf16 v23, s44, v71
  s_waitcnt vmcnt(6)
  s_barrier
  v_mfma_f32_32x32x16_bf16 v[32:47], v[192:195], v[64:67], v[32:47]
  s_cmp_eq_u32 s101, 5
  s_cselect_b64 exec, -1, 0
  ds_read_b128 a[136:139], v28 offset:32768
  ds_read_b128 a[140:143], v29 offset:32768
  s_mov_b64 exec, -1
  ds_read_b128 v[208:211], v10 offset:32768
  ds_read_b128 v[212:215], v11 offset:32768
  ds_read_b128 v[216:219], v12 offset:32768
  s_lshl_b32 s55, s54, 7
  s_add_u32 m0, s62, 114688
  s_add_u32 s54, s54, 1
  v_mfma_f32_32x32x16_bf16 v[48:63], v[192:195], v[68:71], v[48:63]
  s_waitcnt lgkmcnt(13)
  ds_read_b128 v[220:223], v13 offset:32768
  ds_read_b64_tr_b16 v[96:97], v14 offset:40960
  ds_read_b64_tr_b16 v[98:99], v14 offset:41216
  buffer_load_dwordx4 v4, s[8:11], s55 offen offset:0 lds
  s_and_b32 s54, s54, 7
  buffer_load_dwordx4 v5, s[8:11], s55 offen offset:1024 lds
  v_mfma_f32_32x32x16_bf16 v[32:47], v[196:199], v[72:75], v[32:47]
  s_waitcnt lgkmcnt(14)
  ds_read_b64_tr_b16 v[100:101], v14 offset:41984
  ds_read_b64_tr_b16 v[102:103], v14 offset:42240
  ds_read_b64_tr_b16 v[104:105], v15 offset:40960
  buffer_load_dwordx4 v6, s[8:11], s55 offen offset:2048 lds
  buffer_load_dwordx4 v7, s[8:11], s55 offen offset:3072 lds
  v_accvgpr_read_b32 v4, a131
  v_mfma_f32_32x32x16_bf16 v[48:63], v[196:199], v[76:79], v[48:63]
  s_waitcnt lgkmcnt(14)
  ds_read_b64_tr_b16 v[106:107], v15 offset:41216
  ds_read_b64_tr_b16 v[108:109], v15 offset:41984
  ds_read_b64_tr_b16 v[110:111], v15 offset:42240
  v_accvgpr_read_b32 v5, a132
  v_min_u32 v6, 15, v1
  v_lshlrev_b32 v6, 2, v6
  v_mfma_f32_32x32x16_bf16 v[32:47], v[200:203], v[80:83], v[32:47]
  s_waitcnt lgkmcnt(14)
  ds_read_b64_tr_b16 v[112:113], v16 offset:40960
  ds_read_b64_tr_b16 v[114:115], v16 offset:41216
  ds_read_b64_tr_b16 v[116:117], v16 offset:41984
  v_add_u32 v7, s66, v4
  buffer_load_dword v8, v6, s[32:35], 0 offen sc1
  s_mul_i32 s56, s100, 196608
  v_mfma_f32_32x32x16_bf16 v[48:63], v[200:203], v[84:87], v[48:63]
  ds_read_b64_tr_b16 v[118:119], v16 offset:42240
  ds_read_b64_tr_b16 v[120:121], v17 offset:40960
  ds_read_b64_tr_b16 v[122:123], v17 offset:41216
  s_add_u32 m0, s68, 0
  s_add_u32 s100, s100, 1
  buffer_load_dwordx4 v9, s[12:15], s56 offen lds
  v_mfma_f32_32x32x16_bf16 v[32:47], v[204:207], v[88:91], v[32:47]
  s_waitcnt lgkmcnt(14)
  ds_read_b64_tr_b16 v[124:125], v17 offset:41984
  ds_read_b64_tr_b16 v[126:127], v17 offset:42240
  s_and_b32 s100, s100, 7
  s_mul_i32 s56, s100, 196608
  s_add_u32 m0, s68, 4096
  v_mfma_f32_32x32x16_bf16 v[48:63], v[204:207], v[92:95], v[48:63]
  s_waitcnt lgkmcnt(13)
  s_add_u32 s100, s100, 1
  buffer_load_dwordx4 v9, s[12:15], s56 offen lds
  s_and_b32 s100, s100, 7
  v_dot2c_f32_bf16 v18, s44, v208
  v_dot2c_f32_bf16 v19, v208, v208
  v_dot2c_f32_bf16 v20, s44, v209
  v_dot2c_f32_bf16 v21, v209, v209
  v_dot2c_f32_bf16 v18, s44, v210
  v_dot2c_f32_bf16 v19, v210, v210
  v_dot2c_f32_bf16 v20, s44, v211
  v_dot2c_f32_bf16 v21, v211, v211
  v_dot2c_f32_bf16 v18, s44, v212
  v_dot2c_f32_bf16 v19, v212, v212
  v_dot2c_f32_bf16 v20, s44, v213
  v_dot2c_f32_bf16 v21, v213, v213
  v_dot2c_f32_bf16 v18, s44, v214
  v_dot2c_f32_bf16 v19, v214, v214
  v_dot2c_f32_bf16 v20, s44, v215
  v_dot2c_f32_bf16 v21, v215, v215
  v_dot2c_f32_bf16 v18, s44, v216
  v_dot2c_f32_bf16 v19, v216, v216
  v_dot2c_f32_bf16 v20, s44, v217
  v_dot2c_f32_bf16 v21, v217, v217
  v_dot2c_f32_bf16 v18, s44, v218
  v_dot2c_f32_bf16 v19, v218, v218
  v_dot2c_f32_bf16 v20, s44, v219
  v_dot2c_f32_bf16 v21, v219, v219
  v_dot2c_f32_bf16 v18, s44, v220
  v_dot2c_f32_bf16 v19, v220, v220
  v_dot2c_f32_bf16 v20, s44, v221
  v_dot2c_f32_bf16 v21, v221, v221
  v_dot2c_f32_bf16 v18, s44, v222
  v_dot2c_f32_bf16 v19, v222, v222
  v_dot2c_f32_bf16 v20, s44, v223
  v_dot2c_f32_bf16 v21, v223, v223
  v_dot2c_f32_bf16 v22, s44, v96
  v_dot2c_f32_bf16 v23, s44, v100
  v_dot2c_f32_bf16 v22, s44, v97
  v_dot2c_f32_bf16 v23, s44, v101
  v_dot2c_f32_bf16 v22, s44, v98
  s_waitcnt lgkmcnt(12)
  v_dot2c_f32_bf16 v23, s44, v102
  v_dot2c_f32_bf16 v22, s44, v99
  v_dot2c_f32_bf16 v23, s44, v103
  v_mfma_f32_32x32x16_bf16 v[32:47], v[208:211], v[96:99], v[32:47]
  ds_read_b64_tr_b16 v[64:65], v14 offset:49152
  ds_read_b64_tr_b16 v[66:67], v14 offset:49408
  ds_read_b64_tr_b16 v[68:69], v14 offset:50176
  s_mul_i32 s56, s100, 196608
  s_add_u32 m0, s68, 8192
  v_mfma_f32_32x32x16_bf16 v[48:63], v[208:211], v[100:103], v[48:63]
  s_waitcnt lgkmcnt(13)
  ds_read_b64_tr_b16 v[70:71], v14 offset:50432
  ds_read_b64_tr_b16 v[72:73], v15 offset:49152
  ds_read_b64_tr_b16 v[74:75], v15 offset:49408
  s_add_u32 s100, s100, 1
  buffer_load_dwordx4 v9, s[12:15], s56 offen lds
  v_mfma_f32_32x32x16_bf16 v[32:47], v[212:215], v[104:107], v[32:47]
  s_waitcnt lgkmcnt(14)
  ds_read_b64_tr_b16 v[76:77], v15 offset:50176
  ds_read_b64_tr_b16 v[78:79], v15 offset:50432
  ds_read_b64_tr_b16 v[80:81], v16 offset:49152
  s_and_b32 s100, s100, 7
  s_mul_i32 s56, s100, 196608
  v_mfma_f32_32x32x16_bf16 v[48:63], v[212:215], v[108:111], v[48:63]
  s_waitcnt lgkmcnt(14)
  ds_read_b64_tr_b16 v[82:83], v16 offset:49408
  ds_read_b64_tr_b16 v[84:85], v16 offset:50176
  ds_read_b64_tr_b16 v[86:87], v16 offset:50432
  s_add_u32 m0, s68, 12288
  s_add_u32 s100, s100, 1
  v_mfma_f32_32x32x16_bf16 v[32:47], v[216:219], v[112:115], v[32:47]
  s_waitcnt lgkmcnt(14)
  ds_read_b64_tr_b16 v[88:89], v17 offset:49152
  ds_read_b64_tr_b16 v[90:91], v17 offset:49408
  ds_read_b64_tr_b16 v[92:93], v17 offset:50176
  buffer_load_dwordx4 v9, s[12:15], s56 offen lds
  s_and_b32 s100, s100, 7
  v_mfma_f32_32x32x16_bf16 v[48:63], v[216:219], v[116:119], v[48:63]
  ds_read_b64_tr_b16 v[94:95], v17 offset:50432
  s_mul_i32 s56, s100, 196608
  s_add_u32 m0, s68, 16384
  v_mfma_f32_32x32x16_bf16 v[32:47], v[220:223], v[120:123], v[32:47]
  s_waitcnt lgkmcnt(14)
  s_add_u32 s100, s100, 1
  buffer_load_dwordx4 v9, s[12:15], s56 offen lds
  v_mfma_f32_32x32x16_bf16 v[48:63], v[220:223], v[124:127], v[48:63]
  s_waitcnt vmcnt(10) lgkmcnt(12)
  s_and_b32 s100, s100, 7
  v_dot2c_f32_bf16 v22, s44, v64
  v_dot2c_f32_bf16 v23, s44, v68
  v_dot2c_f32_bf16 v22, s44, v65
  v_dot2c_f32_bf16 v23, s44, v69
  v_dot2c_f32_bf16 v22, s44, v66
  v_dot2c_f32_bf16 v23, s44, v70
  v_dot2c_f32_bf16 v22, s44, v67
  v_dot2c_f32_bf16 v23, s44, v71
  s_lshl_b32 s57, s3, 2
  s_add_u32 s57, s57, 160768
  v_add_u32 v30, s57, v2
  ds_read_b128 v[224:227], v10 offset:0
  ds_read_b128 v[228:231], v11 offset:0
  ds_read_b128 v[232:235], v12 offset:0
  ds_read_b128 v[236:239], v13 offset:0
  s_barrier
  ds_read_b64_tr_b16 v[96:97], v14 offset:57344
  ds_read_b64_tr_b16 v[98:99], v14 offset:57600
  ds_read_b64_tr_b16 v[100:101], v14 offset:58368
  ds_read_b64_tr_b16 v[102:103], v14 offset:58624
  ds_read_b64_tr_b16 v[104:105], v15 offset:57344
  ds_read_b64_tr_b16 v[106:107], v15 offset:57600
  ds_read_b64_tr_b16 v[108:109], v15 offset:58368
  ds_read_b64_tr_b16 v[110:111], v15 offset:58624
  ds_read_b64_tr_b16 v[112:113], v16 offset:57344
  ds_read_b64_tr_b16 v[114:115], v16 offset:57600
  ds_read_b64_tr_b16 v[116:117], v16 offset:58368
  ds_read_b64_tr_b16 v[118:119], v16 offset:58624
  ds_read_b64_tr_b16 v[120:121], v17 offset:57344
  ds_read_b64_tr_b16 v[122:123], v17 offset:57600
  ds_read_b64_tr_b16 v[124:125], v17 offset:58368
  ds_read_b64_tr_b16 v[126:127], v17 offset:58624
  s_cmp_eq_u32 s101, 6
  s_cselect_b64 exec, -1, 0
  ds_read_b128 a[136:139], v28 offset:0
  ds_read_b128 a[140:143], v29 offset:0
  s_mov_b64 exec, -1
  s_waitcnt lgkmcnt(14)
  v_dot2c_f32_bf16 v18, s44, v224
  v_dot2c_f32_bf16 v19, v224, v224
  v_dot2c_f32_bf16 v20, s44, v225
  v_dot2c_f32_bf16 v21, v225, v225
  v_dot2c_f32_bf16 v18, s44, v226
  v_dot2c_f32_bf16 v19, v226, v226
  v_dot2c_f32_bf16 v20, s44, v227
  v_dot2c_f32_bf16 v21, v227, v227
  v_dot2c_f32_bf16 v18, s44, v228
  v_dot2c_f32_bf16 v19, v228, v228
  v_dot2c_f32_bf16 v20, s44, v229
  v_dot2c_f32_bf16 v21, v229, v229
  v_dot2c_f32_bf16 v18, s44, v230
  v_dot2c_f32_bf16 v19, v230, v230
  v_dot2c_f32_bf16 v20, s44, v231
  v_dot2c_f32_bf16 v21, v231, v231
  v_dot2c_f32_bf16 v18, s44, v232
  v_dot2c_f32_bf16 v19, v232, v232
  v_dot2c_f32_bf16 v20, s44, v233
  v_dot2c_f32_bf16 v21, v233, v233
  v_dot2c_f32_bf16 v18, s44, v234
  v_dot2c_f32_bf16 v19, v234, v234
  v_dot2c_f32_bf16 v20, s44, v235
  v_dot2c_f32_bf16 v21, v235, v235
  v_dot2c_f32_bf16 v18, s44, v236
  v_dot2c_f32_bf16 v19, v236, v236
  v_dot2c_f32_bf16 v20, s44, v237
  v_dot2c_f32_bf16 v21, v237, v237
  v_dot2c_f32_bf16 v18, s44, v238
  v_dot2c_f32_bf16 v19, v238, v238
  v_dot2c_f32_bf16 v20, s44, v239
  v_dot2c_f32_bf16 v21, v239, v239
  v_dot2c_f32_bf16 v22, s44, v96
  s_waitcnt lgkmcnt(13)
  v_dot2c_f32_bf16 v23, s44, v100
  v_dot2c_f32_bf16 v22, s44, v97
  v_dot2c_f32_bf16 v23, s44, v101
  v_dot2c_f32_bf16 v22, s44, v98
  s_waitcnt lgkmcnt(12)
  v_dot2c_f32_bf16 v23, s44, v102
  v_dot2c_f32_bf16 v22, s44, v99
  v_dot2c_f32_bf16 v23, s44, v103
  s_nop 2
  v_permlane32_swap_b32 v22, v23
  v_add_f32 v22, v22, v23
  ds_write_b32 v30, v22
  v_mfma_f32_32x32x16_bf16 v[32:47], v[224:227], v[64:67], v[32:47]
  s_mul_i32 s56, s100, 196608
  s_add_u32 m0, s68, 20480
  v_mfma_f32_32x32x16_bf16 v[48:63], v[224:227], v[68:71], v[48:63]
  s_add_u32 s100, s100, 1
  buffer_load_dwordx4 v9, s[12:15], s56 offen lds
  v_mfma_f32_32x32x16_bf16 v[32:47], v[228:231], v[72:75], v[32:47]
  s_and_b32 s100, s100, 7
  s_mul_i32 s56, s100, 196608
  v_mfma_f32_32x32x16_bf16 v[48:63], v[228:231], v[76:79], v[48:63]
  s_add_u32 m0, s68, 24576
  s_add_u32 s100, s100, 1
  v_mfma_f32_32x32x16_bf16 v[32:47], v[232:235], v[80:83], v[32:47]
  buffer_load_dwordx4 v9, s[12:15], s56 offen lds
  s_and_b32 s100, s100, 7
  v_mfma_f32_32x32x16_bf16 v[48:63], v[232:235], v[84:87], v[48:63]
  s_mul_i32 s56, s100, 196608
  s_add_u32 m0, s68, 28672
  v_mfma_f32_32x32x16_bf16 v[32:47], v[236:239], v[88:91], v[32:47]
  s_add_u32 s100, s100, 1
  buffer_load_dwordx4 v9, s[12:15], s56 offen lds
  v_mfma_f32_32x32x16_bf16 v[48:63], v[236:239], v[92:95], v[48:63]
  s_waitcnt vmcnt(9)
  s_and_b32 s100, s100, 7
  v_and_b32 v30, 0x1f0, v2
  v_add_u32 v30, 160768, v30
  ds_read_b128 v[240:243], v10 offset:16384
  ds_read_b128 v[244:247], v11 offset:16384
  ds_read_b128 v[248:251], v12 offset:16384
  ds_read_b128 v[252:255], v13 offset:16384
  s_waitcnt lgkmcnt(4)
  s_barrier
  ds_read_b128 v[64:67], v30
  ds_read_b128 v[68:71], v30 offset:512
  s_cmp_eq_u32 s101, 7
  s_cselect_b64 exec, -1, 0
  ds_read_b128 a[136:139], v28 offset:16384
  ds_read_b128 a[140:143], v29 offset:16384
  s_mov_b64 exec, -1
  s_mov_b64 s[12:13], s[76:77]
  s_mov_b32 s14, 524288
  s_xor_b32 s26, s75, 393216
  s_add_u32 m0, s62, 131072
  s_add_u32 s26, s26, 0
  s_add_u32 s27, s26, 7168
  buffer_load_dwordx4 v5, s[12:15], s26 offen offset:0 lds
  buffer_load_dwordx4 v5, s[12:15], s27 offen offset:1024 lds
  s_waitcnt lgkmcnt(5)
  v_dot2c_f32_bf16 v18, s44, v240
  v_dot2c_f32_bf16 v19, v240, v240
  v_dot2c_f32_bf16 v20, s44, v241
  v_dot2c_f32_bf16 v21, v241, v241
  v_dot2c_f32_bf16 v18, s44, v242
  v_dot2c_f32_bf16 v19, v242, v242
  v_dot2c_f32_bf16 v20, s44, v243
  v_dot2c_f32_bf16 v21, v243, v243
  s_waitcnt lgkmcnt(4)
  v_dot2c_f32_bf16 v18, s44, v244
  v_dot2c_f32_bf16 v19, v244, v244
  v_dot2c_f32_bf16 v20, s44, v245
  v_dot2c_f32_bf16 v21, v245, v245
  v_dot2c_f32_bf16 v18, s44, v246
  v_dot2c_f32_bf16 v19, v246, v246
  v_dot2c_f32_bf16 v20, s44, v247
  v_dot2c_f32_bf16 v21, v247, v247
  s_waitcnt lgkmcnt(3)
  v_dot2c_f32_bf16 v18, s44, v248
  v_dot2c_f32_bf16 v19, v248, v248
  v_dot2c_f32_bf16 v20, s44, v249
  v_dot2c_f32_bf16 v21, v249, v249
  v_dot2c_f32_bf16 v18, s44, v250
  v_dot2c_f32_bf16 v19, v250, v250
  v_dot2c_f32_bf16 v20, s44, v251
  v_dot2c_f32_bf16 v21, v251, v251
  s_waitcnt lgkmcnt(2)
  v_dot2c_f32_bf16 v18, s44, v252
  v_dot2c_f32_bf16 v19, v252, v252
  v_dot2c_f32_bf16 v20, s44, v253
  v_dot2c_f32_bf16 v21, v253, v253
  v_dot2c_f32_bf16 v18, s44, v254
  v_dot2c_f32_bf16 v19, v254, v254
  v_dot2c_f32_bf16 v20, s44, v255
  v_dot2c_f32_bf16 v21, v255, v255
  v_mfma_f32_32x32x16_bf16 v[32:47], v[240:243], v[96:99], v[32:47]
  s_nop 0
  v_add_f32 v18, v18, v20
  v_add_f32 v19, v19, v21
  s_lshl_b32 s57, s3, 7
  s_add_u32 s57, s57, 161792
  v_permlane32_swap_b32 v18, v19
  v_and_b32 v30, 31, v1
  v_mfma_f32_32x32x16_bf16 v[48:63], v[240:243], v[100:103], v[48:63]
  v_add_f32 v18, v18, v19
  v_lshl_add_u32 v30, v30, 2, s57
  v_mov_b32 v19, v18
  v_lshrrev_b32 v31, 5, v1
  v_lshl_add_u32 v31, v31, 4, s57
  v_permlane32_swap_b32 v18, v19
  v_mfma_f32_32x32x16_bf16 v[32:47], v[244:247], v[104:107], v[32:47]
  v_mul_f32 v18, 0xbb000000, v18
  v_mul_f32 v19, 0x3b000000, v19
  v_fma_f32 v19, -v18, v18, v19
  v_max_f32 v19, 0, v19
  v_add_f32 v19, 0x3727c5ac, v19
  v_mfma_f32_32x32x16_bf16 v[48:63], v[244:247], v[108:111], v[48:63]
  v_rsq_f32 v28, v19
  v_cvt_pk_bf16_f32 v20, v18, v18
  v_mul_f32 v29, 0x3fb8aa3b, v28
  v_lshlrev_b32 v20, 16, v20
  ds_write_b32 v30, v29
  v_mfma_f32_32x32x16_bf16 v[32:47], v[248:251], v[112:115], v[32:47]
  s_waitcnt lgkmcnt(1)
  v_sub_f32 v20, v18, v20
  v_add_f32 v64, v64, v65
  v_cndmask_b32 v18, v18, v20, s[46:47]
  v_add_f32 v66, v66, v67
  v_add_f32 v68, v68, v69
  v_add_f32 v70, v70, v71
  v_mfma_f32_32x32x16_bf16 v[48:63], v[248:251], v[116:119], v[48:63]
  v_cvt_pk_bf16_f32 v24, v18, v18
  v_add_f32 v22, v64, v66
  v_add_f32 v23, v68, v70
  ds_read_b128 v[80:83], v31 offset:0
  ds_read_b128 v[84:87], v31 offset:32
  ds_read_b128 v[88:91], v31 offset:64
  v_mfma_f32_32x32x16_bf16 v[32:47], v[252:255], v[120:123], v[32:47]
  ds_read_b128 v[92:95], v31 offset:96
  v_cvt_pk_bf16_f32 v20, v22, v23
  v_mov_b32 v73, 0
  v_lshlrev_b32 v21, 16, v20
  v_and_b32 v20, 0xffff0000, v20
  v_sub_f32 v21, v22, v21
  v_mfma_f32_32x32x16_bf16 v[48:63], v[252:255], v[124:127], v[48:63]
  v_sub_f32 v20, v23, v20
  v_cvt_pk_bf16_f32 v72, v22, v21
  v_cvt_pk_bf16_f32 v76, v23, v20
  v_mov_b32 v74, 0
  v_mov_b32 v75, 0
  v_mov_b32 v77, 0
  v_mov_b32 v78, 0
  v_mov_b32 v79, 0
  v_mfma_f32_32x32x16_bf16 v[32:47], v[24:27], v[72:75], v[32:47]
  s_nop 0
  v_mfma_f32_32x32x16_bf16 v[48:63], v[24:27], v[76:79], v[48:63]
  s_waitcnt vmcnt(10)
  s_movk_i32 s61, 0x3fff
L_dbgp_3:
  v_cmp_ne_u32 vcc, 1, v8
  v_mov_b32 v18, s45
  s_cbranch_vccz L_dbgd_4
  s_sub_u32 s61, s61, 1
  s_cbranch_scc1 L_dbgd_4
  buffer_load_dword v8, v6, s[32:35], 0 offen sc1
  s_waitcnt vmcnt(0)
  s_branch L_dbgp_3
L_dbgd_4:
  buffer_store_dword v18, off, s[36:39], s72 offset:384 sc1
  v_accvgpr_read_b32 v10, a128
  v_accvgpr_read_b32 v11, a129
  s_xor_b32 s26, s75, 393216
  s_add_u32 m0, s62, 131072
  s_add_u32 s26, s26, 14336
  s_add_u32 s27, s26, 7168
  buffer_load_dwordx4 v5, s[12:15], s26 offen offset:2048 lds
  buffer_load_dwordx4 v5, s[12:15], s27 offen offset:3072 lds
  v_accvgpr_read_b32 v12, a130
  v_mov_b32 v115, 0x3e800000
  v_mov_b32 v119, 0x3e800000
  v_mov_b32 v123, 0x3e800000
  v_mov_b32 v122, 0
  v_mov_b32 v19, 0
  v_mov_b32 v20, 0
  s_waitcnt lgkmcnt(3)
  v_pk_mul_f32 v[32:33], v[32:33], v[80:81]
  v_pk_mul_f32 v[34:35], v[34:35], v[82:83]
  s_waitcnt lgkmcnt(2)
  v_pk_mul_f32 v[36:37], v[36:37], v[84:85]
  v_pk_mul_f32 v[38:39], v[38:39], v[86:87]
  s_waitcnt lgkmcnt(1)
  v_pk_mul_f32 v[40:41], v[40:41], v[88:89]
  v_pk_mul_f32 v[42:43], v[42:43], v[90:91]
  s_waitcnt lgkmcnt(0)
  v_pk_mul_f32 v[44:45], v[44:45], v[92:93]
  v_pk_mul_f32 v[46:47], v[46:47], v[94:95]
  v_exp_f32 v96, v32 clamp
  v_exp_f32 v97, v33 clamp
  v_exp_f32 v98, v34 clamp
  v_exp_f32 v99, v35 clamp
  v_exp_f32 v100, v36 clamp
  s_xor_b32 s26, s75, 131072
  s_add_u32 m0, s62, 98304
  s_add_u32 s26, s26, 0
  s_add_u32 s27, s26, 7168
  buffer_load_dwordx4 v5, s[12:15], s26 offen offset:0 lds
  buffer_load_dwordx4 v5, s[12:15], s27 offen offset:1024 lds
  v_exp_f32 v101, v37 clamp
  v_exp_f32 v102, v38 clamp
  v_exp_f32 v103, v39 clamp
  v_exp_f32 v104, v40 clamp
  v_exp_f32 v105, v41 clamp
  v_exp_f32 v106, v42 clamp
  v_exp_f32 v107, v43 clamp
  v_exp_f32 v108, v44 clamp
  v_exp_f32 v109, v45 clamp
  v_exp_f32 v110, v46 clamp
  v_exp_f32 v111, v47 clamp
  v_pk_fma_f32 v[32:33], v[32:33], s[24:25], 1.0 op_sel_hi:[1,1,0]
  v_pk_fma_f32 v[34:35], v[34:35], s[24:25], 1.0 op_sel_hi:[1,1,0]
  v_pk_fma_f32 v[36:37], v[36:37], s[24:25], 1.0 op_sel_hi:[1,1,0]
  v_pk_fma_f32 v[38:39], v[38:39], s[24:25], 1.0 op_sel_hi:[1,1,0]
  v_pk_fma_f32 v[40:41], v[40:41], s[24:25], 1.0 op_sel_hi:[1,1,0]
  v_pk_fma_f32 v[42:43], v[42:43], s[24:25], 1.0 op_sel_hi:[1,1,0]
  v_pk_fma_f32 v[44:45], v[44:45], s[24:25], 1.0 op_sel_hi:[1,1,0]
  v_pk_fma_f32 v[46:47], v[46:47], s[24:25], 1.0 op_sel_hi:[1,1,0]
  v_pk_mul_f32 v[48:49], v[48:49], v[80:81]
  s_xor_b32 s26, s75, 131072
  s_add_u32 m0, s62, 98304
  s_add_u32 s26, s26, 14336
  s_add_u32 s27, s26, 7168
  buffer_load_dwordx4 v5, s[12:15], s26 offen offset:2048 lds
  buffer_load_dwordx4 v5, s[12:15], s27 offen offset:3072 lds
  v_pk_mul_f32 v[50:51], v[50:51], v[82:83]
  v_pk_mul_f32 v[52:53], v[52:53], v[84:85]
  v_pk_mul_f32 v[54:55], v[54:55], v[86:87]
  v_pk_mul_f32 v[56:57], v[56:57], v[88:89]
  v_pk_mul_f32 v[58:59], v[58:59], v[90:91]
  v_pk_mul_f32 v[60:61], v[60:61], v[92:93]
  v_pk_mul_f32 v[62:63], v[62:63], v[94:95]
  v_max_f32 v32, v32, v96
  v_max_f32 v33, v33, v97
  v_max_f32 v34, v34, v98
  v_max_f32 v35, v35, v99
  v_max_f32 v36, v36, v100
  v_max_f32 v37, v37, v101
  v_max_f32 v38, v38, v102
  v_max_f32 v39, v39, v103
  v_max_f32 v40, v40, v104
  v_max_f32 v41, v41, v105
  v_max_f32 v42, v42, v106
  v_max_f32 v43, v43, v107
  v_max_f32 v44, v44, v108
  v_max_f32 v45, v45, v109
  v_max_f32 v46, v46, v110
  v_max_f32 v47, v47, v111
  v_pk_add_f32 v[32:33], v[32:33], s[52:53]
  v_pk_add_f32 v[34:35], v[34:35], s[52:53]
  v_pk_add_f32 v[36:37], v[36:37], s[52:53]
  v_pk_add_f32 v[38:39], v[38:39], s[52:53]
  v_pk_add_f32 v[40:41], v[40:41], s[52:53]
  v_pk_add_f32 v[42:43], v[42:43], s[52:53]
  v_pk_add_f32 v[44:45], v[44:45], s[52:53]
  v_pk_add_f32 v[46:47], v[46:47], s[52:53]
  v_cvt_pk_bf16_f32 v96, v32, v33
  v_cvt_pk_bf16_f32 v97, v34, v35
  v_cvt_pk_bf16_f32 v98, v36, v37
  v_cvt_pk_bf16_f32 v99, v38, v39
  v_dot2c_f32_bf16 v20, s44, v96
  v_dot2c_f32_bf16 v19, s44, v97
  v_dot2c_f32_bf16 v20, s44, v98
  v_dot2c_f32_bf16 v19, s44, v99
  v_cvt_pk_bf16_f32 v104, v48, v49
  v_cvt_pk_bf16_f32 v105, v50, v51
  v_cvt_pk_bf16_f32 v106, v52, v53
  v_cvt_pk_bf16_f32 v107, v54, v55
  s_nop 1
  v_mfma_f32_32x32x16_bf16 v[64:79], v[96:99], v[104:107], 0
  v_cvt_pk_bf16_f32 v100, v40, v41
  v_cvt_pk_bf16_f32 v101, v42, v43
  v_cvt_pk_bf16_f32 v102, v44, v45
  v_cvt_pk_bf16_f32 v103, v46, v47
  v_cvt_pk_bf16_f32 v108, v56, v57
  v_cvt_pk_bf16_f32 v109, v58, v59
  v_cvt_pk_bf16_f32 v110, v60, v61
  v_cvt_pk_bf16_f32 v111, v62, v63
  v_dot2c_f32_bf16 v20, s44, v100
  v_dot2c_f32_bf16 v19, s44, v101
  v_dot2c_f32_bf16 v20, s44, v102
  v_dot2c_f32_bf16 v19, s44, v103
  v_mfma_f32_32x32x16_bf16 v[64:79], v[100:103], v[108:111], v[64:79]
  s_waitcnt vmcnt(9)
  s_nop 0
  v_add_f32 v19, v19, v20
  v_and_b32 v31, 0x3ff, v14
  v_mul_f32 v19, 0x3fb8aa3b, v19
  s_add_u32 s58, s68, 0
  v_mov_b32 v20, v19
  v_add_u32 v14, s58, v31
  s_mul_i32 s58, s3, 576
  v_permlane32_swap_b32 v19, v20
  v_add_f32 v19, v19, v20
  s_lshl_b32 s57, s5, 12
  v_cndmask_b32 v12, v19, v12, s[46:47]
  ds_write_b32 v11, v12
  s_add_u32 s57, s57, s58
  s_add_u32 s58, s58, 147456
  v_add_u32 v30, s58, v3
  v_cndmask_b32 v112, v64, v72, s[48:49]
  v_cndmask_b32 v113, v65, v73, s[48:49]
  v_cndmask_b32 v114, v66, v74, s[48:49]
  ds_write_b128 v10, v[112:115] offset:0
  v_cndmask_b32 v116, v67, v75, s[48:49]
  v_cndmask_b32 v117, v68, v76, s[48:49]
  v_cndmask_b32 v118, v69, v77, s[48:49]
  ds_write_b128 v10, v[116:119] offset:544
  v_cndmask_b32 v120, v70, v78, s[48:49]
  v_cndmask_b32 v121, v71, v79, s[48:49]
  ds_write_b128 v10, v[120:123] offset:1088
  v_xor_b32 v15, 1024, v14
  v_xor_b32 v16, 2048, v14
  v_xor_b32 v17, 3072, v14
  s_waitcnt lgkmcnt(0)
  s_barrier
  ds_read2st64_b32 v[32:33], v30 offset0:0 offset1:13
  ds_read2st64_b32 v[34:35], v30 offset0:26 offset1:39
  ds_read2st64_b32 v[36:37], v30 offset0:1 offset1:14
  ds_read2st64_b32 v[38:39], v30 offset0:27 offset1:40
  ds_read2st64_b32 v[40:41], v30 offset0:2 offset1:15
  ds_read2st64_b32 v[42:43], v30 offset0:28 offset1:41
  ds_read2st64_b32 v[44:45], v30 offset0:3 offset1:16
  ds_read2st64_b32 v[46:47], v30 offset0:29 offset1:42
  ds_read_b64_tr_b16 v[64:65], v14 offset:0
  ds_read_b64_tr_b16 v[66:67], v14 offset:256
  ds_read_b64_tr_b16 v[68:69], v14 offset:4096
  ds_read_b64_tr_b16 v[70:71], v14 offset:4352
  ds_read_b64_tr_b16 v[72:73], v14 offset:8192
  ds_read_b64_tr_b16 v[74:75], v14 offset:8448
  s_waitcnt lgkmcnt(12)
  v_pk_add_f32 v[32:33], v[32:33], v[34:35]
  v_add_f32 v32, v32, v33
  buffer_atomic_add_f32 v32, v3, s[36:39], s57 offen offset:0
  s_waitcnt lgkmcnt(10)
  v_pk_add_f32 v[36:37], v[36:37], v[38:39]
  v_add_f32 v36, v36, v37
  buffer_atomic_add_f32 v36, v3, s[36:39], s57 offen offset:256
  s_waitcnt lgkmcnt(8)
  v_pk_add_f32 v[40:41], v[40:41], v[42:43]
  v_add_f32 v40, v40, v41
  buffer_atomic_add_f32 v40, v3, s[36:39], s57 offen offset:512
  s_waitcnt lgkmcnt(6)
  v_pk_add_f32 v[44:45], v[44:45], v[46:47]
  v_add_f32 v44, v44, v45
  s_mov_b64 exec, 0xffff
  buffer_atomic_add_f32 v44, v3, s[36:39], s57 offen offset:768
  s_mov_b64 exec, -1
  s_waitcnt lgkmcnt(4)
  v_mfma_f32_32x32x16_bf16 v[48:63], v[64:67], v[128:131], 0
  ds_read_b64_tr_b16 v[76:77], v14 offset:12288
  ds_read_b64_tr_b16 v[78:79], v14 offset:12544
  ds_read_b64_tr_b16 v[80:81], v14 offset:16384
  ds_read_b64_tr_b16 v[82:83], v14 offset:16640
  s_xor_b32 s26, s75, 0
  s_add_u32 m0, s62, 81920
  s_add_u32 s26, s26, 0
  s_lshl_b32 s57, s3, 2
  v_mfma_f32_16x16x32_bf16 a[144:147], a[148:151], v[64:67], 0
  s_waitcnt lgkmcnt(6)
  v_and_b32 v108, 0x1f0, v2
  s_add_u32 s57, s57, 160768
  v_mfma_f32_32x32x16_bf16 v[48:63], v[68:71], v[144:147], v[48:63]
  ds_read_b64_tr_b16 v[84:85], v14 offset:20480
  ds_read_b64_tr_b16 v[86:87], v14 offset:20736
  ds_read_b64_tr_b16 v[88:89], v14 offset:24576
  ds_read_b64_tr_b16 v[90:91], v14 offset:24832
  s_add_u32 s27, s26, 7168
  buffer_load_dwordx4 v5, s[12:15], s26 offen offset:0 lds
  buffer_load_dwordx4 v5, s[12:15], s27 offen offset:1024 lds
  v_add_u32 v109, s57, v108
  v_mfma_f32_16x16x32_bf16 a[144:147], a[148:151], v[68:71], a[144:147]
  s_waitcnt lgkmcnt(8)
  v_add_u32 v107, 160768, v108
  v_and_b32 v9, 31, v1
  v_mfma_f32_32x32x16_bf16 v[48:63], v[72:75], v[160:163], v[48:63]
  ds_read_b64_tr_b16 v[92:93], v14 offset:28672
  ds_read_b64_tr_b16 v[94:95], v14 offset:28928
  ds_read_b64_tr_b16 v[64:65], v15 offset:0
  ds_read_b64_tr_b16 v[66:67], v15 offset:256
  s_xor_b32 s26, s75, 0
  s_add_u32 m0, s62, 81920
  s_add_u32 s26, s26, 14336
  v_min_u32 v9, 16, v9
  v_mfma_f32_16x16x32_bf16 a[144:147], a[148:151], v[72:75], a[144:147]
  s_waitcnt lgkmcnt(10)
  v_lshrrev_b32 v30, 5, v1
  v_mad_u32_u24 v9, v30, 17, v9
  v_mfma_f32_32x32x16_bf16 v[48:63], v[76:79], v[176:179], v[48:63]
  ds_read_b64_tr_b16 v[68:69], v16 offset:0
  ds_read_b64_tr_b16 v[70:71], v16 offset:256
  s_add_u32 s27, s26, 7168
  buffer_load_dwordx4 v5, s[12:15], s26 offen offset:2048 lds
  buffer_load_dwordx4 v5, s[12:15], s27 offen offset:3072 lds
  v_lshlrev_b32 v9, 4, v9
  v_mfma_f32_16x16x32_bf16 a[144:147], a[148:151], v[76:79], a[144:147]
  s_waitcnt lgkmcnt(10)
  s_lshl_b32 s60, s5, 12
  v_and_b32 v30, 15, v1
  v_mfma_f32_32x32x16_bf16 v[48:63], v[80:83], v[192:195], v[48:63]
  ds_read_b64_tr_b16 v[72:73], v17 offset:0
  ds_read_b64_tr_b16 v[74:75], v17 offset:256
  s_xor_b32 s26, s75, 262144
  s_add_u32 m0, s62, 114688
  s_add_u32 s26, s26, 0
  v_lshlrev_b32 v6, 2, v30
  v_mfma_f32_16x16x32_bf16 a[144:147], a[148:151], v[80:83], a[144:147]
  s_waitcnt lgkmcnt(10)
  v_and_b32 v12, 28, v6
  v_accvgpr_read_b32 v104, a133
  v_mfma_f32_32x32x16_bf16 v[48:63], v[84:87], v[208:211], v[48:63]
  ds_read_b64_tr_b16 v[76:77], v15 offset:4096
  ds_read_b64_tr_b16 v[78:79], v15 offset:4352
  s_add_u32 s27, s26, 7168
  buffer_load_dwordx4 v5, s[12:15], s26 offen offset:0 lds
  buffer_load_dwordx4 v5, s[12:15], s27 offen offset:1024 lds
  s_and_b32 s58, s3, 1
  v_mfma_f32_16x16x32_bf16 a[144:147], a[148:151], v[84:87], a[144:147]
  s_waitcnt lgkmcnt(10)
  s_mul_i32 s58, s58, 32832
  v_xor_b32 v104, s58, v104
  v_mfma_f32_32x32x16_bf16 v[48:63], v[88:91], v[224:227], v[48:63]
  ds_read_b64_tr_b16 v[80:81], v16 offset:4096
  ds_read_b64_tr_b16 v[82:83], v16 offset:4352
  s_xor_b32 s26, s75, 262144
  s_add_u32 m0, s62, 114688
  s_add_u32 s26, s26, 14336
  v_add_u32 v104, 81920, v104
  v_mfma_f32_16x16x32_bf16 a[144:147], a[148:151], v[88:91], a[144:147]
  s_waitcnt lgkmcnt(10)
  v_xor_b32 v105, 64, v104
  s_lshl_b32 s57, s65, 15
  v_mfma_f32_32x32x16_bf16 v[48:63], v[92:95], v[240:243], v[48:63]
  ds_read_b64_tr_b16 v[84:85], v17 offset:4096
  ds_read_b64_tr_b16 v[86:87], v17 offset:4352
  s_add_u32 s27, s26, 7168
  buffer_load_dwordx4 v5, s[12:15], s26 offen offset:2048 lds
  buffer_load_dwordx4 v5, s[12:15], s27 offen offset:3072 lds
  s_lshl_b32 s58, s73, 11
  v_mfma_f32_16x16x32_bf16 a[144:147], a[148:151], v[92:95], a[144:147]
  s_waitcnt lgkmcnt(10)
  s_add_u32 s57, s57, s58
  s_add_u32 s76, s57, 0
  v_mfma_f32_32x32x16_bf16 v[48:63], v[64:67], v[132:135], v[48:63]
  s_waitcnt lgkmcnt(8)
  ds_read_b64_tr_b16 v[88:89], v15 offset:8192
  ds_read_b64_tr_b16 v[90:91], v15 offset:8448
  v_accvgpr_read_b32 v0, a135
  buffer_load_dword a254, v0, s[36:39], 0 offen sc1
  v_accvgpr_read_b32 v0, a134
  s_lshl_b32 s57, s65, 12
  v_mfma_f32_32x32x16_bf16 v[48:63], v[68:71], v[136:139], v[48:63]
  s_waitcnt lgkmcnt(8)
  ds_read_b64_tr_b16 v[92:93], v16 offset:8192
  ds_read_b64_tr_b16 v[94:95], v16 offset:8448
  buffer_load_dword a250, v0, s[28:31], 0 offen sc1
  v_and_b32 v0, 3, v1
  v_lshlrev_b32 v0, 20, v0
  s_lshl_b32 s58, s67, 9
  v_mfma_f32_32x32x16_bf16 v[48:63], v[72:75], v[140:143], v[48:63]
  s_waitcnt lgkmcnt(8)
  ds_read_b64_tr_b16 v[64:65], v17 offset:8192
  ds_read_b64_tr_b16 v[66:67], v17 offset:8448
  s_lshl_b32 s26, s3, 22
  s_add_u32 s26, s26, 0x80000
  buffer_load_dword a252, v0, s[36:39], s26 offen
  ds_write_b32 v109, a144
  s_add_u32 s57, s57, s58
  v_mfma_f32_32x32x16_bf16 v[48:63], v[76:79], v[148:151], v[48:63]
  s_waitcnt lgkmcnt(9)
  ds_read_b64_tr_b16 v[68:69], v15 offset:12288
  ds_read_b64_tr_b16 v[70:71], v15 offset:12544
  s_and_b32 s58, s3, 1
  s_lshl_b32 s58, s58, 3
  s_add_u32 s57, s57, s58
  s_add_u32 s77, s57, 262144
  v_mfma_f32_32x32x16_bf16 v[48:63], v[80:83], v[152:155], v[48:63]
  s_waitcnt lgkmcnt(9)
  ds_read_b64_tr_b16 v[72:73], v16 offset:12288
  ds_read_b64_tr_b16 v[74:75], v16 offset:12544
  s_lshl_b32 s57, s64, 15
  s_lshl_b32 s58, s5, 11
  s_add_u32 s57, s57, s58
  s_add_u32 s54, s57, 1048576
  v_mfma_f32_32x32x16_bf16 v[48:63], v[84:87], v[156:159], v[48:63]
  ds_read_b64_tr_b16 v[76:77], v17 offset:12288
  ds_read_b64_tr_b16 v[78:79], v17 offset:12544
  s_waitcnt lgkmcnt(6)
  s_barrier
  ds_read_b128 v[116:119], v107
  s_mov_b32 s55, 0x41800000
  v_mfma_f32_32x32x16_bf16 v[48:63], v[88:91], v[164:167], v[48:63]
  ds_read_b64_tr_b16 v[80:81], v15 offset:16384
  ds_read_b64_tr_b16 v[82:83], v15 offset:16640
  s_mov_b32 s56, 0x35c1a2a0
  v_mov_b32 v113, 0
  v_mov_b32 v114, 0
  v_mov_b32 v115, 0
  v_mfma_f32_32x32x16_bf16 v[48:63], v[92:95], v[168:171], v[48:63]
  ds_read_b64_tr_b16 v[84:85], v16 offset:16384
  ds_read_b64_tr_b16 v[86:87], v16 offset:16640
  v_accvgpr_read_b32 v96, a136
  v_accvgpr_read_b32 v97, a137
  v_accvgpr_read_b32 v98, a138
  v_accvgpr_read_b32 v99, a139
  v_mfma_f32_32x32x16_bf16 v[48:63], v[64:67], v[172:175], v[48:63]
  s_waitcnt lgkmcnt(9)
  ds_read_b64_tr_b16 v[88:89], v17 offset:16384
  ds_read_b64_tr_b16 v[90:91], v17 offset:16640
  v_accvgpr_read_b32 v100, a140
  v_accvgpr_read_b32 v101, a141
  v_accvgpr_read_b32 v102, a142
  v_accvgpr_read_b32 v103, a143
  v_mfma_f32_32x32x16_bf16 v[48:63], v[68:71], v[180:183], v[48:63]
  s_waitcnt lgkmcnt(9)
  ds_read_b64_tr_b16 v[92:93], v15 offset:20480
  ds_read_b64_tr_b16 v[94:95], v15 offset:20736
  v_permlane32_swap_b32 v96, v98
  v_permlane32_swap_b32 v97, v99
  v_permlane32_swap_b32 v100, v102
  v_permlane32_swap_b32 v101, v103
  v_mfma_f32_32x32x16_bf16 v[48:63], v[72:75], v[184:187], v[48:63]
  s_waitcnt lgkmcnt(9)
  ds_read_b64_tr_b16 v[64:65], v16 offset:20480
  ds_read_b64_tr_b16 v[66:67], v16 offset:20736
  v_lshlrev_b32 v32, 16, v96
  v_and_b32 v33, 0xffff0000, v96
  v_lshlrev_b32 v34, 16, v97
  v_and_b32 v35, 0xffff0000, v97
  v_mfma_f32_32x32x16_bf16 v[48:63], v[76:79], v[188:191], v[48:63]
  s_waitcnt lgkmcnt(8)
  ds_read_b64_tr_b16 v[68:69], v17 offset:20480
  ds_read_b64_tr_b16 v[70:71], v17 offset:20736
  v_add_f32 v116, v116, v117
  v_add_f32 v118, v118, v119
  v_add_f32 v22, v116, v118
  v_cvt_pk_bf16_f32 v23, v22, v22
  v_mfma_f32_32x32x16_bf16 v[48:63], v[80:83], v[196:199], v[48:63]
  s_waitcnt lgkmcnt(8)
  ds_read_b64_tr_b16 v[72:73], v15 offset:24576
  ds_read_b64_tr_b16 v[74:75], v15 offset:24832
  v_lshlrev_b32 v23, 16, v23
  v_sub_f32 v23, v22, v23
  v_cvt_pk_bf16_f32 v112, v22, v23
  v_lshlrev_b32 v36, 16, v98
  v_mfma_f32_32x32x16_bf16 v[48:63], v[84:87], v[200:203], v[48:63]
  s_waitcnt lgkmcnt(8)
  ds_read_b64_tr_b16 v[76:77], v16 offset:24576
  ds_read_b64_tr_b16 v[78:79], v16 offset:24832
  v_and_b32 v37, 0xffff0000, v98
  v_lshlrev_b32 v38, 16, v99
  v_and_b32 v39, 0xffff0000, v99
  v_lshlrev_b32 v40, 16, v100
  v_mfma_f32_32x32x16_bf16 v[48:63], v[88:91], v[204:207], v[48:63]
  s_waitcnt lgkmcnt(8)
  ds_read_b64_tr_b16 v[80:81], v17 offset:24576
  ds_read_b64_tr_b16 v[82:83], v17 offset:24832
  v_and_b32 v41, 0xffff0000, v100
  v_lshlrev_b32 v42, 16, v101
  v_and_b32 v43, 0xffff0000, v101
  v_lshlrev_b32 v44, 16, v102
  v_mfma_f32_32x32x16_bf16 v[48:63], v[92:95], v[212:215], v[48:63]
  s_waitcnt lgkmcnt(8)
  ds_read_b64_tr_b16 v[84:85], v15 offset:28672
  ds_read_b64_tr_b16 v[86:87], v15 offset:28928
  v_and_b32 v45, 0xffff0000, v102
  v_lshlrev_b32 v46, 16, v103
  v_and_b32 v47, 0xffff0000, v103
  v_mfma_f32_32x32x16_bf16 v[48:63], v[64:67], v[216:219], v[48:63]
  s_waitcnt lgkmcnt(8)
  ds_read_b64_tr_b16 v[88:89], v16 offset:28672
  ds_read_b64_tr_b16 v[90:91], v16 offset:28928
  v_mfma_f32_32x32x16_bf16 v[48:63], v[68:71], v[220:223], v[48:63]
  s_waitcnt lgkmcnt(8)
  ds_read_b64_tr_b16 v[92:93], v17 offset:28672
  ds_read_b64_tr_b16 v[94:95], v17 offset:28928
  v_mfma_f32_32x32x16_bf16 v[48:63], v[72:75], v[228:231], v[48:63]
  s_waitcnt lgkmcnt(8)
  v_mfma_f32_32x32x16_bf16 v[48:63], v[76:79], v[232:235], v[48:63]
  s_waitcnt lgkmcnt(6)
  v_mfma_f32_32x32x16_bf16 v[48:63], v[80:83], v[236:239], v[48:63]
  s_waitcnt lgkmcnt(4)
  v_mfma_f32_32x32x16_bf16 v[48:63], v[84:87], v[244:247], v[48:63]
  s_waitcnt lgkmcnt(2)
  v_mfma_f32_32x32x16_bf16 v[48:63], v[88:91], v[248:251], v[48:63]
  s_waitcnt lgkmcnt(0)
  v_mfma_f32_32x32x16_bf16 v[48:63], v[92:95], v[252:255], v[48:63]
  v_mfma_f32_32x32x16_bf16 v[48:63], v[112:115], v[24:27], v[48:63]
  s_nop 11
  v_pk_mul_f32 v[48:49], v[48:49], v[28:29] op_sel:[0,1] op_sel_hi:[1,1]
  v_pk_mul_f32 v[50:51], v[50:51], v[28:29] op_sel:[0,1] op_sel_hi:[1,1]
  buffer_load_dword v8, v6, s[36:39], s74 offen offset:384 sc1
  buffer_load_dwordx4 v[128:131], v9, s[36:39], s60 offen offset:0 sc1
  buffer_load_dwordx4 v[132:135], v9, s[36:39], s60 offen offset:544 sc1
  buffer_load_dwordx4 v[136:139], v9, s[36:39], s60 offen offset:1088 sc1
  buffer_load_dwordx4 v[140:143], v9, s[36:39], s60 offen offset:1632 sc1
  buffer_load_dwordx4 v[144:147], v9, s[36:39], s60 offen offset:2176 sc1
  buffer_load_dwordx4 v[148:151], v9, s[36:39], s60 offen offset:2720 sc1
  v_pk_mul_f32 v[52:53], v[52:53], v[28:29] op_sel:[0,1] op_sel_hi:[1,1]
  v_pk_mul_f32 v[54:55], v[54:55], v[28:29] op_sel:[0,1] op_sel_hi:[1,1]
  v_pk_mul_f32 v[56:57], v[56:57], v[28:29] op_sel:[0,1] op_sel_hi:[1,1]
  v_pk_mul_f32 v[58:59], v[58:59], v[28:29] op_sel:[0,1] op_sel_hi:[1,1]
  v_pk_mul_f32 v[60:61], v[60:61], v[28:29] op_sel:[0,1] op_sel_hi:[1,1]
  v_pk_mul_f32 v[62:63], v[62:63], v[28:29] op_sel:[0,1] op_sel_hi:[1,1]
  v_exp_f32 v80, v48 clamp
  v_exp_f32 v81, v49 clamp
  v_exp_f32 v82, v50 clamp
  v_exp_f32 v83, v51 clamp
  v_exp_f32 v84, v52 clamp
  v_exp_f32 v85, v53 clamp
  v_exp_f32 v86, v54 clamp
  v_exp_f32 v87, v55 clamp
  v_exp_f32 v88, v56 clamp
  v_exp_f32 v89, v57 clamp
  s_xor_b32 s26, s50, 0
  s_mul_i32 s26, s26, 229376
  s_add_u32 m0, s63, 32768
  s_add_u32 s27, s26, 27648
  buffer_load_dwordx4 v4, s[20:23], s26 offen lds
  buffer_load_dwordx4 v4, s[20:23], s27 offen offset:1024 lds
  v_exp_f32 v90, v58 clamp
  v_exp_f32 v91, v59 clamp
  v_exp_f32 v92, v60 clamp
  v_exp_f32 v93, v61 clamp
  v_exp_f32 v94, v62 clamp
  v_exp_f32 v95, v63 clamp
  v_pk_fma_f32 v[48:49], v[48:49], s[24:25], 1.0 op_sel_hi:[1,1,0]
  v_pk_fma_f32 v[50:51], v[50:51], s[24:25], 1.0 op_sel_hi:[1,1,0]
  v_pk_fma_f32 v[52:53], v[52:53], s[24:25], 1.0 op_sel_hi:[1,1,0]
  v_pk_fma_f32 v[54:55], v[54:55], s[24:25], 1.0 op_sel_hi:[1,1,0]
  v_pk_fma_f32 v[56:57], v[56:57], s[24:25], 1.0 op_sel_hi:[1,1,0]
  v_pk_fma_f32 v[58:59], v[58:59], s[24:25], 1.0 op_sel_hi:[1,1,0]
  v_pk_fma_f32 v[60:61], v[60:61], s[24:25], 1.0 op_sel_hi:[1,1,0]
  v_pk_fma_f32 v[62:63], v[62:63], s[24:25], 1.0 op_sel_hi:[1,1,0]
  v_max_f32 v48, v48, v80
  v_max_f32 v49, v49, v81
  s_xor_b32 s26, s50, 1
  s_mul_i32 s26, s26, 229376
  s_add_u32 m0, s63, 40960
  s_add_u32 s27, s26, 27648
  buffer_load_dwordx4 v4, s[20:23], s26 offen lds
  buffer_load_dwordx4 v4, s[20:23], s27 offen offset:1024 lds
  v_max_f32 v50, v50, v82
  v_max_f32 v51, v51, v83
  v_max_f32 v52, v52, v84
  v_max_f32 v53, v53, v85
  v_max_f32 v54, v54, v86
  v_max_f32 v55, v55, v87
  v_max_f32 v56, v56, v88
  v_max_f32 v57, v57, v89
  v_max_f32 v58, v58, v90
  v_max_f32 v59, v59, v91
  v_max_f32 v60, v60, v92
  v_max_f32 v61, v61, v93
  v_max_f32 v62, v62, v94
  v_max_f32 v63, v63, v95
  v_pk_add_f32 v[48:49], v[48:49], s[52:53]
  v_pk_add_f32 v[50:51], v[50:51], s[52:53]
  v_pk_add_f32 v[52:53], v[52:53], s[52:53]
  v_pk_add_f32 v[54:55], v[54:55], s[52:53]
  v_pk_add_f32 v[56:57], v[56:57], s[52:53]
  v_pk_add_f32 v[58:59], v[58:59], s[52:53]
  v_pk_add_f32 v[60:61], v[60:61], s[52:53]
  v_pk_add_f32 v[62:63], v[62:63], s[52:53]
  v_cvt_pk_bf16_f32 v64, v48, v49
  v_cvt_pk_bf16_f32 v65, v50, v51
  v_cvt_pk_bf16_f32 v66, v52, v53
  v_cvt_pk_bf16_f32 v67, v54, v55
  v_cvt_pk_bf16_f32 v68, v56, v57
  v_cvt_pk_bf16_f32 v69, v58, v59
  v_cvt_pk_bf16_f32 v70, v60, v61
  v_cvt_pk_bf16_f32 v71, v62, v63
  s_movk_i32 s61, 0x3fff
L_tgp_5:
  s_waitcnt vmcnt(10)
  v_cmp_eq_u32 vcc, 0, v8
  s_cbranch_vccz L_tgd_6
  s_sub_u32 s61, s61, 1
  s_cbranch_scc1 L_tgd_6
  buffer_load_dword v8, v6, s[36:39], s74 offen offset:384 sc1
  s_waitcnt vmcnt(0)
  s_branch L_tgp_5
L_tgd_6:
  v_cmp_ne_u32 vcc, s45, v8
  s_movk_i32 s61, 0x3fff
  s_cbranch_vccnz L_split_s
L_split:
  s_waitcnt vmcnt(4)
L_kvp_7:
  v_min3_f32 v30, v131, v135, v139
  v_min3_f32 v31, v143, v147, v151
  v_min_f32 v30, v30, v31
  v_cvt_pk_bf16_f32 v152, v128, v129
  v_cvt_pk_bf16_f32 v153, v130, v132
  v_cvt_pk_bf16_f32 v154, v133, v134
  v_cvt_pk_bf16_f32 v155, v136, v137
  v_cmp_neq_f32 vcc, s55, v30
  s_nop 0
  v_mfma_f32_32x32x16_bf16 v[224:239], v[152:155], v[64:67], 0
  v_cvt_pk_bf16_f32 v156, v140, v141
  v_cvt_pk_bf16_f32 v157, v142, v144
  v_cvt_pk_bf16_f32 v158, v145, v146
  v_cvt_pk_bf16_f32 v159, v148, v149
  s_cbranch_vccz L_kvd_8
  s_sub_u32 s61, s61, 1
  s_cbranch_scc1 L_kvd_8
  buffer_load_dwordx4 v[128:131], v9, s[36:39], s60 offen offset:0 sc1
  buffer_load_dwordx4 v[132:135], v9, s[36:39], s60 offen offset:544 sc1
  buffer_load_dwordx4 v[136:139], v9, s[36:39], s60 offen offset:1088 sc1
  buffer_load_dwordx4 v[140:143], v9, s[36:39], s60 offen offset:1632 sc1
  buffer_load_dwordx4 v[144:147], v9, s[36:39], s60 offen offset:2176 sc1
  buffer_load_dwordx4 v[148:151], v9, s[36:39], s60 offen offset:2720 sc1
  s_waitcnt vmcnt(0)
  s_branch L_kvp_7
L_kvd_8:
  v_mfma_f32_32x32x16_bf16 v[240:255], v[156:159], v[68:71], 0
  v_add_f32 v232, s56, v232
  v_rcp_f32 v232, v232
  s_nop 0
  v_pk_mul_f32 v[224:225], v[224:225], v[232:233] op_sel_hi:[1,0]
  v_pk_mul_f32 v[226:227], v[226:227], v[232:233] op_sel_hi:[1,0]
  v_pk_mul_f32 v[228:229], v[228:229], v[232:233] op_sel_hi:[1,0]
  v_pk_mul_f32 v[230:231], v[230:231], v[232:233] op_sel_hi:[1,0]
  v_cvt_pk_bf16_f32 v72, v224, v225
  v_cvt_pk_bf16_f32 v73, v226, v227
  v_cvt_pk_bf16_f32 v74, v228, v229
  v_cvt_pk_bf16_f32 v75, v230, v231
  s_nop 0
  v_add_f32 v248, s56, v248
  v_rcp_f32 v248, v248
  s_nop 0
  v_pk_mul_f32 v[240:241], v[240:241], v[248:249] op_sel_hi:[1,0]
  v_pk_mul_f32 v[242:243], v[242:243], v[248:249] op_sel_hi:[1,0]
  v_pk_mul_f32 v[244:245], v[244:245], v[248:249] op_sel_hi:[1,0]
  v_pk_mul_f32 v[246:247], v[246:247], v[248:249] op_sel_hi:[1,0]
  v_cvt_pk_bf16_f32 v76, v240, v241
  v_cvt_pk_bf16_f32 v77, v242, v243
  v_cvt_pk_bf16_f32 v78, v244, v245
  v_cvt_pk_bf16_f32 v79, v246, v247
  buffer_store_dwordx4 v[72:75], v2, s[36:39], s54 offen offset:0
  buffer_store_dwordx4 v[76:79], v2, s[36:39], s54 offen offset:1024
  s_barrier
  ds_read_b64_tr_b16 a[0:1], v104 offset:0
  ds_read_b64_tr_b16 a[2:3], v104 offset:1024
  ds_read_b64_tr_b16 a[4:5], v105 offset:0
  ds_read_b64_tr_b16 a[6:7], v105 offset:1024
  ds_read_b64_tr_b16 a[8:9], v104 offset:2048
  ds_read_b64_tr_b16 a[10:11], v104 offset:3072
  ds_read_b64_tr_b16 a[12:13], v105 offset:2048
  ds_read_b64_tr_b16 a[14:15], v105 offset:3072
  ds_read_b64_tr_b16 a[16:17], v104 offset:4096
  ds_read_b64_tr_b16 a[18:19], v104 offset:5120
  ds_read_b64_tr_b16 a[20:21], v105 offset:4096
  ds_read_b64_tr_b16 a[22:23], v105 offset:5120
  ds_read_b64_tr_b16 a[24:25], v104 offset:6144
  ds_read_b64_tr_b16 a[26:27], v104 offset:7168
  ds_read_b64_tr_b16 a[28:29], v105 offset:6144
  ds_read_b64_tr_b16 a[30:31], v105 offset:7168
  ds_read_b64_tr_b16 a[32:33], v104 offset:8192
  ds_read_b64_tr_b16 a[34:35], v104 offset:9216
  ds_read_b64_tr_b16 a[36:37], v105 offset:8192
  ds_read_b64_tr_b16 a[38:39], v105 offset:9216
  ds_read_b64_tr_b16 a[40:41], v104 offset:10240
  ds_read_b64_tr_b16 a[42:43], v104 offset:11264
  ds_read_b64_tr_b16 a[44:45], v105 offset:10240
  ds_read_b64_tr_b16 a[46:47], v105 offset:11264
  ds_read_b64_tr_b16 a[48:49], v104 offset:12288
  ds_read_b64_tr_b16 a[50:51], v104 offset:13312
  ds_read_b64_tr_b16 a[52:53], v105 offset:12288
  ds_read_b64_tr_b16 a[54:55], v105 offset:13312
  ds_read_b64_tr_b16 a[56:57], v104 offset:14336
  ds_read_b64_tr_b16 a[58:59], v104 offset:15360
  ds_read_b64_tr_b16 a[60:61], v105 offset:14336
  ds_read_b64_tr_b16 a[62:63], v105 offset:15360
  ds_read_b64_tr_b16 a[64:65], v104 offset:16384
  ds_read_b64_tr_b16 a[66:67], v104 offset:17408
  ds_read_b64_tr_b16 a[68:69], v105 offset:16384
  ds_read_b64_tr_b16 a[70:71], v105 offset:17408
  ds_read_b64_tr_b16 a[72:73], v104 offset:18432
  ds_read_b64_tr_b16 a[74:75], v104 offset:19456
  ds_read_b64_tr_b16 a[76:77], v105 offset:18432
  ds_read_b64_tr_b16 a[78:79], v105 offset:19456
  s_waitcnt vmcnt(0)
  buffer_store_dword v18, off, s[36:39], s72 offset:0
  s_xor_b32 s26, s50, 2
  s_mul_i32 s26, s26, 229376
  s_add_u32 m0, s63, 49152
  s_add_u32 s27, s26, 27648
  buffer_load_dwordx4 v4, s[20:23], s26 offen lds
  buffer_load_dwordx4 v4, s[20:23], s27 offen offset:1024 lds
  s_xor_b32 s26, s50, 3
  s_mul_i32 s26, s26, 229376
  s_add_u32 m0, s63, 57344
  s_add_u32 s27, s26, 27648
  buffer_load_dwordx4 v4, s[20:23], s26 offen lds
  buffer_load_dwordx4 v4, s[20:23], s27 offen offset:1024 lds
  s_xor_b32 s26, s50, 4
  s_mul_i32 s26, s26, 229376
  s_add_u32 m0, s63, 65536
  s_add_u32 s27, s26, 27648
  buffer_load_dwordx4 v4, s[20:23], s26 offen lds
  buffer_load_dwordx4 v4, s[20:23], s27 offen offset:1024 lds
  s_xor_b32 s26, s50, 5
  s_mul_i32 s26, s26, 229376
  s_add_u32 m0, s63, 73728
  s_add_u32 s27, s26, 27648
  buffer_load_dwordx4 v4, s[20:23], s26 offen lds
  buffer_load_dwordx4 v4, s[20:23], s27 offen offset:1024 lds
  ds_read_b64_tr_b16 a[80:81], v104 offset:20480
  ds_read_b64_tr_b16 a[82:83], v104 offset:21504
  ds_read_b64_tr_b16 a[84:85], v105 offset:20480
  ds_read_b64_tr_b16 a[86:87], v105 offset:21504
  ds_read_b64_tr_b16 a[88:89], v104 offset:22528
  ds_read_b64_tr_b16 a[90:91], v104 offset:23552
  ds_read_b64_tr_b16 a[92:93], v105 offset:22528
  ds_read_b64_tr_b16 a[94:95], v105 offset:23552
  ds_read_b64_tr_b16 a[96:97], v104 offset:24576
  ds_read_b64_tr_b16 a[98:99], v104 offset:25600
  ds_read_b64_tr_b16 a[100:101], v105 offset:24576
  ds_read_b64_tr_b16 a[102:103], v105 offset:25600
  ds_read_b64_tr_b16 a[104:105], v104 offset:26624
  ds_read_b64_tr_b16 a[106:107], v104 offset:27648
  ds_read_b64_tr_b16 a[108:109], v105 offset:26624
  ds_read_b64_tr_b16 a[110:111], v105 offset:27648
  buffer_load_dword v31, v12, s[36:39], s51 offen sc1
  ds_read_b64_tr_b16 a[112:113], v104 offset:28672
  ds_read_b64_tr_b16 a[114:115], v104 offset:29696
  ds_read_b64_tr_b16 a[116:117], v105 offset:28672
  ds_read_b64_tr_b16 a[118:119], v105 offset:29696
  ds_read_b64_tr_b16 a[120:121], v104 offset:30720
  ds_read_b64_tr_b16 a[122:123], v104 offset:31744
  ds_read_b64_tr_b16 a[124:125], v105 offset:30720
  ds_read_b64_tr_b16 a[126:127], v105 offset:31744
  s_add_u32 s58, s62, 147456
  v_add_u32 v106, s58, v2
  v_xor_b32 v107, 0x1000, v106
  v_mov_b32 v22, 0
  v_mov_b32 v23, 0
  v_lshrrev_b32 v30, 5, v1
  v_lshl_add_u32 v108, v30, 2, v108
  s_lshl_b32 s58, s99, 1
  s_add_u32 s99, s58, s71
  s_xor_b32 s58, s99, 1
  s_lshl_b32 s58, s58, 6
  v_xor_b32 v5, s58, v5
  s_waitcnt lgkmcnt(0)
  s_barrier
  s_waitcnt vmcnt(0)
  v_cmp_gt_u32 vcc, 0x1, v31
  s_cbranch_vccnz L_spin_9
L_back_10:
  s_xor_b32 s57, s70, 0
  buffer_load_dwordx4 v[128:131], v2, s[36:39], s57 offen offset:0 sc1
  buffer_load_dwordx4 v[132:135], v2, s[36:39], s57 offen offset:1024 sc1
  s_xor_b32 s57, s70, 2048
  buffer_load_dwordx4 v[136:139], v2, s[36:39], s57 offen offset:0 sc1
  buffer_load_dwordx4 v[140:143], v2, s[36:39], s57 offen offset:1024 sc1
  s_xor_b32 s57, s70, 4096
  buffer_load_dwordx4 v[144:147], v2, s[36:39], s57 offen offset:0 sc1
  buffer_load_dwordx4 v[148:151], v2, s[36:39], s57 offen offset:1024 sc1
  s_xor_b32 s57, s70, 6144
  buffer_load_dwordx4 v[152:155], v2, s[36:39], s57 offen offset:0 sc1
  buffer_load_dwordx4 v[156:159], v2, s[36:39], s57 offen offset:1024 sc1
  s_lshl_b32 s58, s73, 2
  s_add_u32 s51, s74, s58
  s_waitcnt vmcnt(7)
  v_mfma_f32_32x32x16_bf16 v[48:63], a[4:7], v[128:131], 0
  s_xor_b32 s57, s70, 8192
  buffer_load_dwordx4 v[160:163], v2, s[36:39], s57 offen offset:0 sc1
  v_mfma_f32_32x32x16_bf16 v[32:47], a[0:3], v[128:131], v[32:47]
  s_waitcnt vmcnt(7)
  v_mfma_f32_32x32x16_bf16 v[48:63], a[12:15], v[132:135], v[48:63]
  buffer_load_dwordx4 v[164:167], v2, s[36:39], s57 offen offset:1024 sc1
  v_mfma_f32_32x32x16_bf16 v[32:47], a[8:11], v[132:135], v[32:47]
  s_waitcnt vmcnt(7)
  v_mfma_f32_32x32x16_bf16 v[48:63], a[20:23], v[136:139], v[48:63]
  s_xor_b32 s57, s70, 10240
  buffer_load_dwordx4 v[168:171], v2, s[36:39], s57 offen offset:0 sc1
  v_mfma_f32_32x32x16_bf16 v[32:47], a[16:19], v[136:139], v[32:47]
  s_waitcnt vmcnt(7)
  v_mfma_f32_32x32x16_bf16 v[48:63], a[28:31], v[140:143], v[48:63]
  buffer_load_dwordx4 v[172:175], v2, s[36:39], s57 offen offset:1024 sc1
  v_mfma_f32_32x32x16_bf16 v[32:47], a[24:27], v[140:143], v[32:47]
  s_waitcnt vmcnt(7)
  v_mfma_f32_32x32x16_bf16 v[48:63], a[36:39], v[144:147], v[48:63]
  s_xor_b32 s57, s70, 12288
  buffer_load_dwordx4 v[176:179], v2, s[36:39], s57 offen offset:0 sc1
  v_mfma_f32_32x32x16_bf16 v[32:47], a[32:35], v[144:147], v[32:47]
  s_waitcnt vmcnt(7)
  v_mfma_f32_32x32x16_bf16 v[48:63], a[44:47], v[148:151], v[48:63]
  buffer_load_dwordx4 v[180:183], v2, s[36:39], s57 offen offset:1024 sc1
  v_mfma_f32_32x32x16_bf16 v[32:47], a[40:43], v[148:151], v[32:47]
  s_waitcnt vmcnt(7)
  v_mfma_f32_32x32x16_bf16 v[48:63], a[52:55], v[152:155], v[48:63]
  s_xor_b32 s57, s70, 14336
  buffer_load_dwordx4 v[184:187], v2, s[36:39], s57 offen offset:0 sc1
  v_mfma_f32_32x32x16_bf16 v[32:47], a[48:51], v[152:155], v[32:47]
  s_waitcnt vmcnt(7)
  v_mfma_f32_32x32x16_bf16 v[48:63], a[60:63], v[156:159], v[48:63]
  buffer_load_dwordx4 v[188:191], v2, s[36:39], s57 offen offset:1024 sc1
  v_mfma_f32_32x32x16_bf16 v[32:47], a[56:59], v[156:159], v[32:47]
  s_waitcnt vmcnt(7)
  v_mfma_f32_32x32x16_bf16 v[48:63], a[68:71], v[160:163], v[48:63]
  s_xor_b32 s26, s50, 6
  s_mul_i32 s26, s26, 229376
  s_add_u32 m0, s63, 81920
  s_add_u32 s27, s26, 27648
  buffer_load_dwordx4 v4, s[20:23], s26 offen lds
  v_mfma_f32_32x32x16_bf16 v[32:47], a[64:67], v[160:163], v[32:47]
  s_waitcnt vmcnt(7)
  buffer_load_dwordx4 v4, s[20:23], s27 offen offset:1024 lds
  v_mfma_f32_32x32x16_bf16 v[48:63], a[76:79], v[164:167], v[48:63]
  s_xor_b32 s26, s50, 7
  s_mul_i32 s26, s26, 229376
  s_add_u32 m0, s63, 90112
  s_add_u32 s27, s26, 27648
  buffer_load_dwordx4 v4, s[20:23], s26 offen lds
  v_mfma_f32_32x32x16_bf16 v[32:47], a[72:75], v[164:167], v[32:47]
  s_waitcnt vmcnt(8)
  buffer_load_dwordx4 v4, s[20:23], s27 offen offset:1024 lds
  v_mfma_f32_32x32x16_bf16 v[48:63], a[84:87], v[168:171], v[48:63]
  s_xor_b32 s26, s50, 0
  s_mul_i32 s26, s26, 229376
  s_add_u32 m0, s63, 0
  s_add_u32 s27, s26, 27648
  buffer_load_dwordx4 v7, s[20:23], s26 offen lds
  v_mfma_f32_32x32x16_bf16 v[32:47], a[80:83], v[168:171], v[32:47]
  s_waitcnt vmcnt(9)
  buffer_load_dwordx4 v7, s[20:23], s27 offen offset:1024 lds
  v_mfma_f32_32x32x16_bf16 v[48:63], a[92:95], v[172:175], v[48:63]
  s_xor_b32 s26, s50, 1
  s_mul_i32 s26, s26, 229376
  s_add_u32 m0, s63, 8192
  s_add_u32 s27, s26, 27648
  buffer_load_dwordx4 v7, s[20:23], s26 offen lds
  v_mfma_f32_32x32x16_bf16 v[32:47], a[88:91], v[172:175], v[32:47]
  s_waitcnt vmcnt(10)
  buffer_load_dwordx4 v7, s[20:23], s27 offen offset:1024 lds
  v_mfma_f32_32x32x16_bf16 v[48:63], a[100:103], v[176:179], v[48:63]
  s_lshl_b32 s26, s2, 2
  s_add_u32 s26, s26, s3
  s_mul_i32 s26, s26, 1792
  v_min_u32 v0, 13, v1
  v_lshlrev_b32 v0, 7, v0
  v_mfma_f32_32x32x16_bf16 v[32:47], a[96:99], v[176:179], v[32:47]
  s_waitcnt vmcnt(10)
  buffer_load_dword a249, v0, s[16:19], s26 offen
  v_mfma_f32_32x32x16_bf16 v[48:63], a[108:111], v[180:183], v[48:63]
  s_waitcnt vmcnt(10)
  v_mfma_f32_32x32x16_bf16 v[48:63], a[116:119], v[184:187], v[48:63]
  s_waitcnt vmcnt(9)
  v_mfma_f32_32x32x16_bf16 v[48:63], a[124:127], v[188:191], v[48:63]
  v_mfma_f32_32x32x16_bf16 v[32:47], a[104:107], v[180:183], v[32:47]
  v_mfma_f32_32x32x16_bf16 v[32:47], a[112:115], v[184:187], v[32:47]
  s_nop 9
  ds_write_b128 v106, v[48:51] offset:0
  ds_write_b128 v106, v[52:55] offset:1024
  v_mfma_f32_32x32x16_bf16 v[32:47], a[120:123], v[188:191], v[32:47]
  s_waitcnt vmcnt(5)
  ds_write_b128 v106, v[56:59] offset:2048
  ds_write_b128 v106, v[60:63] offset:3072
  s_waitcnt lgkmcnt(0)
  s_barrier
  ds_read_b128 v[48:51], v107 offset:0
  ds_read_b128 v[52:55], v107 offset:1024
  ds_read_b128 v[56:59], v107 offset:2048
  ds_read_b128 v[60:63], v107 offset:3072
  s_waitcnt lgkmcnt(3)
  s_nop 1
  v_pk_add_f32 v[32:33], v[32:33], v[48:49]
  v_pk_add_f32 v[34:35], v[34:35], v[50:51]
  s_waitcnt lgkmcnt(2)
  v_pk_add_f32 v[36:37], v[36:37], v[52:53]
  v_pk_add_f32 v[38:39], v[38:39], v[54:55]
  v_cvt_pk_bf16_f32 v96, v32, v33
  v_cvt_pk_bf16_f32 v97, v34, v35
  v_cvt_pk_bf16_f32 v98, v36, v37
  v_cvt_pk_bf16_f32 v99, v38, v39
  buffer_store_dwordx4 v[96:99], v2, s[28:31], s76 offen offset:0
  s_waitcnt lgkmcnt(1)
  v_pk_add_f32 v[40:41], v[40:41], v[56:57]
  v_pk_add_f32 v[42:43], v[42:43], v[58:59]
  s_waitcnt lgkmcnt(0)
  v_pk_add_f32 v[44:45], v[44:45], v[60:61]
  v_pk_add_f32 v[46:47], v[46:47], v[62:63]
  v_cvt_pk_bf16_f32 v100, v40, v41
  v_cvt_pk_bf16_f32 v101, v42, v43
  v_cvt_pk_bf16_f32 v102, v44, v45
  v_cvt_pk_bf16_f32 v103, v46, v47
  buffer_store_dwordx4 v[100:103], v2, s[28:31], s76 offen offset:1024
  v_dot2c_f32_bf16 v22, s44, v96
  v_dot2c_f32_bf16 v23, v96, v96
  v_dot2c_f32_bf16 v22, s44, v97
  v_dot2c_f32_bf16 v23, v97, v97
  v_dot2c_f32_bf16 v22, s44, v98
  v_dot2c_f32_bf16 v23, v98, v98
  v_dot2c_f32_bf16 v22, s44, v99
  v_dot2c_f32_bf16 v23, v99, v99
  v_dot2c_f32_bf16 v22, s44, v100
  v_dot2c_f32_bf16 v23, v100, v100
  v_dot2c_f32_bf16 v22, s44, v101
  v_dot2c_f32_bf16 v23, v101, v101
  v_dot2c_f32_bf16 v22, s44, v102
  v_dot2c_f32_bf16 v23, v102, v102
  v_dot2c_f32_bf16 v22, s44, v103
  v_dot2c_f32_bf16 v23, v103, v103
  s_nop 2
  v_permlane32_swap_b32 v22, v23
  v_add_f32 v22, v22, v23
  buffer_store_dword v22, v108, s[36:39], s77 offen
  s_xor_b32 s26, s50, 2
  s_mul_i32 s26, s26, 229376
  s_add_u32 m0, s63, 16384
  s_add_u32 s27, s26, 27648
  buffer_load_dwordx4 v7, s[20:23], s26 offen lds
  buffer_load_dwordx4 v7, s[20:23], s27 offen offset:1024 lds
  s_xor_b32 s26, s50, 3
  s_mul_i32 s26, s26, 229376
  s_add_u32 m0, s63, 24576
  s_add_u32 s27, s26, 27648
  buffer_load_dwordx4 v7, s[20:23], s26 offen lds
  buffer_load_dwordx4 v7, s[20:23], s27 offen offset:1024 lds
  v_accvgpr_read_b32 v14, a133
  s_lshl_b32 s57, s64, 15
  v_add_u32 v21, s57, v2
  s_lshl_b32 s70, s64, 9
  s_add_u32 s70, s70, 65536
  v_xor_b32 v15, 64, v14
  v_add_u32 v10, 0x8000, v14
  v_add_u32 v11, 0x8000, v15
  v_add_u32 v240, s63, v14
  v_add_u32 v241, s63, v15
  v_add_u32 v242, s63, v2
  s_lshl_b32 s58, s50, 12
  s_add_u32 s58, s58, s57
  s_add_u32 s73, s58, 0
  s_waitcnt vmcnt(4)
  buffer_store_dword v18, off, s[36:39], s51 offset:64
  s_cmp_ge_u32 s2, 224
  s_cbranch_scc1 L_idle
  s_xor_b32 s26, s50, 4
  s_mul_i32 s26, s26, 229376
  s_add_u32 m0, s63, 98304
  s_add_u32 s27, s26, 27648
  buffer_load_dwordx4 v7, s[20:23], s26 offen lds
  buffer_load_dwordx4 v7, s[20:23], s27 offen offset:1024 lds
  s_xor_b32 s26, s50, 5
  s_mul_i32 s26, s26, 229376
  s_add_u32 m0, s63, 106496
  s_add_u32 s27, s26, 27648
  buffer_load_dwordx4 v7, s[20:23], s26 offen lds
  buffer_load_dwordx4 v7, s[20:23], s27 offen offset:1024 lds
  s_xor_b32 s26, s50, 6
  s_mul_i32 s26, s26, 229376
  s_add_u32 m0, s63, 114688
  s_add_u32 s27, s26, 27648
  buffer_load_dwordx4 v7, s[20:23], s26 offen lds
  buffer_load_dwordx4 v7, s[20:23], s27 offen offset:1024 lds
  s_xor_b32 s26, s50, 7
  s_mul_i32 s26, s26, 229376
  s_add_u32 m0, s63, 122880
  s_add_u32 s27, s26, 27648
  buffer_load_dwordx4 v7, s[20:23], s26 offen lds
  buffer_load_dwordx4 v7, s[20:23], s27 offen offset:1024 lds
  buffer_load_dword v17, v6, s[36:39], s70 offen offset:64 sc1
  v_add_u32 v22, 0x18000, v240
  v_add_u32 v23, 0x18000, v241
  v_add_u32 v31, 0x18000, v242
  v_add_u32 v12, 0x20000, v14
  v_add_u32 v13, 0x20000, v15
  v_add_u32 v16, 0x18000, v2
  v_min_u32 v9, 6, v1
  s_mul_i32 s57, s71, 28
  v_lshl_add_u32 v9, v9, 2, s57
  v_and_b32 v20, 0x1f0, v2
  v_lshrrev_b32 v30, 5, v1
  v_lshlrev_b32 v30, 4, v30
  v_lshl_add_u32 v19, v20, 6, v30
  s_lshl_b32 s57, s5, 11
  s_add_u32 s74, s57, 1048576
  s_mul_i32 s57, s71, -28672
  s_add_u32 s57, s57, s74
  s_add_u32 s57, s57, 14336
  s_xor_b32 s75, s74, 0x800
  s_cmp_lt_u32 s5, 14
  s_cselect_b32 s75, s57, s75
  s_mov_b32 s52, 0x3f3504f3
  s_mov_b32 s53, 0x3f3504f3
  s_mov_b64 s[32:33], s[36:37]
  v_add_u32 v3, 0x100000, v21
  v_add_u32 v4, 0x0, v21
  v_add_u32 v7, 0x100000, v21
  v_add_u32 v8, 0x0, v21
  s_bfe_u32 s8, s94, 0x40000
  s_lshl_b32 s8, s8, 11
  s_bfe_u32 s9, s94, 0x40004
  s_lshl_b32 s9, s9, 11
  s_bfe_u32 s10, s94, 0x40008
  s_lshl_b32 s10, s10, 11
  s_bfe_u32 s11, s94, 0x4000c
  s_lshl_b32 s11, s11, 11
  s_bfe_u32 s12, s94, 0x40010
  s_lshl_b32 s12, s12, 11
  s_bfe_u32 s13, s94, 0x40014
  s_lshl_b32 s13, s13, 11
  s_bfe_u32 s14, s94, 0x40018
  s_lshl_b32 s14, s14, 11
  s_lshl_b32 s57, s64, 12
  s_add_u32 s57, s57, 262144
  v_lshl_add_u32 v30, v30, 7, v20
  s_lshl_b32 s60, s5, 11
  s_add_u32 s60, s60, 98304
  ds_read_b64_tr_b16 v[96:97], v10 offset:0
  ds_read_b64_tr_b16 v[98:99], v10 offset:1024
  ds_read_b64_tr_b16 v[100:101], v11 offset:0
  ds_read_b64_tr_b16 v[102:103], v11 offset:1024
  ds_read_b64_tr_b16 v[104:105], v10 offset:2048
  ds_read_b64_tr_b16 v[106:107], v10 offset:3072
  ds_read_b64_tr_b16 v[108:109], v11 offset:2048
  ds_read_b64_tr_b16 v[110:111], v11 offset:3072
  ds_read_b64_tr_b16 v[112:113], v10 offset:4096
  ds_read_b64_tr_b16 v[114:115], v10 offset:5120
  ds_read_b64_tr_b16 v[116:117], v11 offset:4096
  ds_read_b64_tr_b16 v[118:119], v11 offset:5120
  ds_read_b64_tr_b16 v[120:121], v10 offset:6144
  ds_read_b64_tr_b16 v[122:123], v10 offset:7168
  ds_read_b64_tr_b16 v[124:125], v11 offset:6144
  ds_read_b64_tr_b16 v[126:127], v11 offset:7168
  s_waitcnt vmcnt(0)
  v_cmp_gt_u32 vcc, 0x1, v17
  s_cbranch_vccnz L_spin_12
L_back_13:
  s_xor_b32 s59, s73, 0
  buffer_load_dwordx4 a[0:3], v2, s[28:31], s59 offen offset:0 sc1
  buffer_load_dwordx4 a[4:7], v2, s[28:31], s59 offen offset:1024 sc1
  buffer_load_dwordx4 a[8:11], v2, s[28:31], s59 offen offset:2048 sc1
  buffer_load_dwordx4 a[12:15], v2, s[28:31], s59 offen offset:3072 sc1
  s_xor_b32 s59, s73, 4096
  buffer_load_dwordx4 a[16:19], v2, s[28:31], s59 offen offset:0 sc1
  buffer_load_dwordx4 a[20:23], v2, s[28:31], s59 offen offset:1024 sc1
  buffer_load_dwordx4 a[24:27], v2, s[28:31], s59 offen offset:2048 sc1
  buffer_load_dwordx4 a[28:31], v2, s[28:31], s59 offen offset:3072 sc1
  ds_read_b64_tr_b16 v[160:161], v240 offset:0
  ds_read_b64_tr_b16 v[162:163], v240 offset:1024
  ds_read_b64_tr_b16 v[164:165], v241 offset:0
  ds_read_b64_tr_b16 v[166:167], v241 offset:1024
  ds_read_b64_tr_b16 v[168:169], v240 offset:8192
  ds_read_b64_tr_b16 v[170:171], v240 offset:9216
  ds_read_b64_tr_b16 v[172:173], v241 offset:8192
  ds_read_b64_tr_b16 v[174:175], v241 offset:9216
  s_waitcnt lgkmcnt(6)
  ds_write_b128 v242, v[160:163] offset:0
  s_waitcnt lgkmcnt(5)
  ds_write_b128 v242, v[164:167] offset:1024
  s_waitcnt lgkmcnt(4)
  ds_write_b128 v242, v[168:171] offset:8192
  s_waitcnt lgkmcnt(3)
  ds_write_b128 v242, v[172:175] offset:9216
  s_waitcnt vmcnt(7)
  v_mfma_f32_32x32x16_bf16 v[32:47], v[96:99], a[0:3], 0
  ds_read_b64_tr_b16 v[96:97], v10 offset:8192
  ds_read_b64_tr_b16 v[98:99], v10 offset:9216
  s_xor_b32 s59, s73, 8192
  buffer_load_dwordx4 a[32:35], v2, s[28:31], s59 offen offset:0 sc1
  v_mfma_f32_32x32x16_bf16 v[48:63], v[100:103], a[0:3], 0
  s_waitcnt vmcnt(7)
  ds_read_b64_tr_b16 v[100:101], v11 offset:8192
  ds_read_b64_tr_b16 v[102:103], v11 offset:9216
  ds_read_b64_tr_b16 v[176:177], v240 offset:16384
  ds_read_b64_tr_b16 v[178:179], v240 offset:17408
  v_mfma_f32_32x32x16_bf16 v[32:47], v[104:107], a[4:7], v[32:47]
  ds_read_b64_tr_b16 v[104:105], v10 offset:10240
  ds_read_b64_tr_b16 v[106:107], v10 offset:11264
  buffer_load_dwordx4 a[36:39], v2, s[28:31], s59 offen offset:1024 sc1
  v_mfma_f32_32x32x16_bf16 v[48:63], v[108:111], a[4:7], v[48:63]
  s_waitcnt vmcnt(7)
  ds_read_b64_tr_b16 v[108:109], v11 offset:10240
  ds_read_b64_tr_b16 v[110:111], v11 offset:11264
  ds_read_b64_tr_b16 v[180:181], v241 offset:16384
  ds_read_b64_tr_b16 v[182:183], v241 offset:17408
  v_mfma_f32_32x32x16_bf16 v[32:47], v[112:115], a[8:11], v[32:47]
  ds_read_b64_tr_b16 v[112:113], v10 offset:12288
  ds_read_b64_tr_b16 v[114:115], v10 offset:13312
  buffer_load_dwordx4 a[40:43], v2, s[28:31], s59 offen offset:2048 sc1
  v_mfma_f32_32x32x16_bf16 v[48:63], v[116:119], a[8:11], v[48:63]
  s_waitcnt vmcnt(7)
  ds_read_b64_tr_b16 v[116:117], v11 offset:12288
  ds_read_b64_tr_b16 v[118:119], v11 offset:13312
  ds_read_b64_tr_b16 v[184:185], v240 offset:24576
  ds_read_b64_tr_b16 v[186:187], v240 offset:25600
  v_mfma_f32_32x32x16_bf16 v[32:47], v[120:123], a[12:15], v[32:47]
  ds_read_b64_tr_b16 v[120:121], v10 offset:14336
  ds_read_b64_tr_b16 v[122:123], v10 offset:15360
  buffer_load_dwordx4 a[44:47], v2, s[28:31], s59 offen offset:3072 sc1
  v_mfma_f32_32x32x16_bf16 v[48:63], v[124:127], a[12:15], v[48:63]
  s_waitcnt vmcnt(7) lgkmcnt(14)
  ds_read_b64_tr_b16 v[124:125], v11 offset:14336
  ds_read_b64_tr_b16 v[126:127], v11 offset:15360
  ds_read_b64_tr_b16 v[188:189], v241 offset:24576
  ds_read_b64_tr_b16 v[190:191], v241 offset:25600
  v_mfma_f32_32x32x16_bf16 v[32:47], v[96:99], a[16:19], v[32:47]
  ds_read_b64_tr_b16 v[96:97], v10 offset:16384
  ds_read_b64_tr_b16 v[98:99], v10 offset:17408
  s_xor_b32 s59, s73, 12288
  buffer_load_dwordx4 a[48:51], v2, s[28:31], s59 offen offset:0 sc1
  v_mfma_f32_32x32x16_bf16 v[48:63], v[100:103], a[16:19], v[48:63]
  s_waitcnt vmcnt(7) lgkmcnt(14)
  ds_read_b64_tr_b16 v[100:101], v11 offset:16384
  ds_read_b64_tr_b16 v[102:103], v11 offset:17408
  s_lshl_b32 s58, s99, 11
  s_add_u32 s58, s58, 0
  buffer_load_dwordx4 v[244:247], v21, s[28:31], s58 offen offset:0 sc1
  v_mfma_f32_32x32x16_bf16 v[32:47], v[104:107], a[20:23], v[32:47]
  ds_read_b64_tr_b16 v[104:105], v10 offset:18432
  ds_read_b64_tr_b16 v[106:107], v10 offset:19456
  buffer_load_dwordx4 a[52:55], v2, s[28:31], s59 offen offset:1024 sc1
  ds_write_b128 v242, v[176:179] offset:16384
  ds_write_b128 v242, v[180:183] offset:17408
  v_mfma_f32_32x32x16_bf16 v[48:63], v[108:111], a[20:23], v[48:63]
  s_waitcnt vmcnt(8) lgkmcnt(8)
  ds_read_b64_tr_b16 v[108:109], v11 offset:18432
  ds_read_b64_tr_b16 v[110:111], v11 offset:19456
  buffer_load_dwordx4 v[248:251], v21, s[28:31], s58 offen offset:1024 sc1
  ds_write_b128 v242, v[184:187] offset:24576
  ds_write_b128 v242, v[188:191] offset:25600
  v_mfma_f32_32x32x16_bf16 v[32:47], v[112:115], a[24:27], v[32:47]
  ds_read_b64_tr_b16 v[112:113], v10 offset:20480
  ds_read_b64_tr_b16 v[114:115], v10 offset:21504
  buffer_load_dwordx4 a[56:59], v2, s[28:31], s59 offen offset:2048 sc1
  v_mfma_f32_32x32x16_bf16 v[48:63], v[116:119], a[24:27], v[48:63]
  s_waitcnt vmcnt(9)
  ds_read_b64_tr_b16 v[116:117], v11 offset:20480
  ds_read_b64_tr_b16 v[118:119], v11 offset:21504
  ds_read_b64_tr_b16 v[192:193], v22 offset:0
  ds_read_b64_tr_b16 v[194:195], v22 offset:1024
  v_mfma_f32_32x32x16_bf16 v[32:47], v[120:123], a[28:31], v[32:47]
  ds_read_b64_tr_b16 v[120:121], v10 offset:22528
  ds_read_b64_tr_b16 v[122:123], v10 offset:23552
  buffer_load_dwordx4 a[60:63], v2, s[28:31], s59 offen offset:3072 sc1
  v_mfma_f32_32x32x16_bf16 v[48:63], v[124:127], a[28:31], v[48:63]
  s_waitcnt vmcnt(9) lgkmcnt(14)
  ds_read_b64_tr_b16 v[124:125], v11 offset:22528
  ds_read_b64_tr_b16 v[126:127], v11 offset:23552
  ds_read_b64_tr_b16 v[196:197], v23 offset:0
  ds_read_b64_tr_b16 v[198:199], v23 offset:1024
  v_mfma_f32_32x32x16_bf16 v[32:47], v[96:99], a[32:35], v[32:47]
  ds_read_b64_tr_b16 v[96:97], v10 offset:24576
  ds_read_b64_tr_b16 v[98:99], v10 offset:25600
  s_xor_b32 s59, s73, 16384
  buffer_load_dwordx4 a[64:67], v2, s[28:31], s59 offen offset:0 sc1
  v_mfma_f32_32x32x16_bf16 v[48:63], v[100:103], a[32:35], v[48:63]
  s_waitcnt vmcnt(9)
  ds_read_b64_tr_b16 v[100:101], v11 offset:24576
  ds_read_b64_tr_b16 v[102:103], v11 offset:25600
  buffer_load_dwordx4 v[128:131], v30, s[36:39], s57 offen offset:0 sc1
  ds_read_b64_tr_b16 v[200:201], v22 offset:8192
  ds_read_b64_tr_b16 v[202:203], v22 offset:9216
  v_mfma_f32_32x32x16_bf16 v[32:47], v[104:107], a[36:39], v[32:47]
  s_waitcnt lgkmcnt(14)
  ds_read_b64_tr_b16 v[104:105], v10 offset:26624
  ds_read_b64_tr_b16 v[106:107], v10 offset:27648
  buffer_load_dwordx4 a[68:71], v2, s[28:31], s59 offen offset:1024 sc1
  v_mfma_f32_32x32x16_bf16 v[48:63], v[108:111], a[36:39], v[48:63]
  s_waitcnt vmcnt(10)
  ds_read_b64_tr_b16 v[108:109], v11 offset:26624
  ds_read_b64_tr_b16 v[110:111], v11 offset:27648
  buffer_load_dwordx4 v[132:135], v30, s[36:39], s57 offen offset:512 sc1
  ds_read_b64_tr_b16 v[204:205], v23 offset:8192
  ds_read_b64_tr_b16 v[206:207], v23 offset:9216
  v_mfma_f32_32x32x16_bf16 v[32:47], v[112:115], a[40:43], v[32:47]
  ds_read_b64_tr_b16 v[112:113], v10 offset:28672
  ds_read_b64_tr_b16 v[114:115], v10 offset:29696
  buffer_load_dwordx4 a[72:75], v2, s[28:31], s59 offen offset:2048 sc1
  v_mfma_f32_32x32x16_bf16 v[48:63], v[116:119], a[40:43], v[48:63]
  s_waitcnt vmcnt(11) lgkmcnt(14)
  ds_read_b64_tr_b16 v[116:117], v11 offset:28672
  ds_read_b64_tr_b16 v[118:119], v11 offset:29696
  buffer_load_dwordx4 v[136:139], v30, s[36:39], s57 offen offset:1024 sc1
  ds_write_b128 v31, v[192:195] offset:0
  ds_write_b128 v31, v[196:199] offset:1024
  v_mfma_f32_32x32x16_bf16 v[32:47], v[120:123], a[44:47], v[32:47]
  ds_read_b64_tr_b16 v[120:121], v10 offset:30720
  ds_read_b64_tr_b16 v[122:123], v10 offset:31744
  buffer_load_dwordx4 a[76:79], v2, s[28:31], s59 offen offset:3072 sc1
  v_mfma_f32_32x32x16_bf16 v[48:63], v[124:127], a[44:47], v[48:63]
  s_waitcnt vmcnt(12) lgkmcnt(8)
  ds_read_b64_tr_b16 v[124:125], v11 offset:30720
  ds_read_b64_tr_b16 v[126:127], v11 offset:31744
  buffer_load_dwordx4 v[140:143], v30, s[36:39], s57 offen offset:1536 sc1
  ds_write_b128 v31, v[200:203] offset:8192
  ds_write_b128 v31, v[204:207] offset:9216
  v_mfma_f32_32x32x16_bf16 v[32:47], v[96:99], a[48:51], v[32:47]
  ds_read_b64_tr_b16 v[96:97], v10 offset:32768
  ds_read_b64_tr_b16 v[98:99], v10 offset:33792
  s_xor_b32 s59, s73, 20480
  buffer_load_dwordx4 a[80:83], v2, s[28:31], s59 offen offset:0 sc1
  v_mfma_f32_32x32x16_bf16 v[48:63], v[100:103], a[48:51], v[48:63]
  s_waitcnt vmcnt(12)
  ds_read_b64_tr_b16 v[100:101], v11 offset:32768
  ds_read_b64_tr_b16 v[102:103], v11 offset:33792
  ds_read_b64_tr_b16 v[208:209], v22 offset:16384
  ds_read_b64_tr_b16 v[210:211], v22 offset:17408
  v_mfma_f32_32x32x16_bf16 v[32:47], v[104:107], a[52:55], v[32:47]
  ds_read_b64_tr_b16 v[104:105], v10 offset:34816
  ds_read_b64_tr_b16 v[106:107], v10 offset:35840
  buffer_load_dwordx4 a[84:87], v2, s[28:31], s59 offen offset:1024 sc1
  v_mfma_f32_32x32x16_bf16 v[48:63], v[108:111], a[52:55], v[48:63]
  s_waitcnt vmcnt(11) lgkmcnt(14)
  ds_read_b64_tr_b16 v[108:109], v11 offset:34816
  ds_read_b64_tr_b16 v[110:111], v11 offset:35840
  ds_read_b64_tr_b16 v[212:213], v23 offset:16384
  ds_read_b64_tr_b16 v[214:215], v23 offset:17408
  v_mfma_f32_32x32x16_bf16 v[32:47], v[112:115], a[56:59], v[32:47]
  ds_read_b64_tr_b16 v[112:113], v10 offset:36864
  ds_read_b64_tr_b16 v[114:115], v10 offset:37888
  buffer_load_dwordx4 a[88:91], v2, s[28:31], s59 offen offset:2048 sc1
  v_mfma_f32_32x32x16_bf16 v[48:63], v[116:119], a[56:59], v[48:63]
  s_waitcnt vmcnt(11) lgkmcnt(14)
  ds_read_b64_tr_b16 v[116:117], v11 offset:36864
  ds_read_b64_tr_b16 v[118:119], v11 offset:37888
  ds_read_b64_tr_b16 v[216:217], v22 offset:24576
  ds_read_b64_tr_b16 v[218:219], v22 offset:25600
  v_mfma_f32_32x32x16_bf16 v[32:47], v[120:123], a[60:63], v[32:47]
  ds_read_b64_tr_b16 v[120:121], v10 offset:38912
  ds_read_b64_tr_b16 v[122:123], v10 offset:39936
  buffer_load_dwordx4 a[92:95], v2, s[28:31], s59 offen offset:3072 sc1
  v_lshlrev_b32 v224, 16, v244
  v_and_b32 v225, 0xffff0000, v244
  v_lshlrev_b32 v226, 16, v245
  v_mfma_f32_32x32x16_bf16 v[48:63], v[124:127], a[60:63], v[48:63]
  s_waitcnt vmcnt(11) lgkmcnt(14)
  ds_read_b64_tr_b16 v[124:125], v11 offset:38912
  ds_read_b64_tr_b16 v[126:127], v11 offset:39936
  ds_read_b64_tr_b16 v[220:221], v23 offset:24576
  ds_read_b64_tr_b16 v[222:223], v23 offset:25600
  v_and_b32 v227, 0xffff0000, v245
  v_lshlrev_b32 v228, 16, v246
  v_mfma_f32_32x32x16_bf16 v[32:47], v[96:99], a[64:67], v[32:47]
  ds_read_b64_tr_b16 v[96:97], v10 offset:40960
  ds_read_b64_tr_b16 v[98:99], v10 offset:41984
  s_xor_b32 s59, s73, 24576
  buffer_load_dwordx4 a[96:99], v2, s[28:31], s59 offen offset:0 sc1
  v_and_b32 v229, 0xffff0000, v246
  v_lshlrev_b32 v230, 16, v247
  v_mfma_f32_32x32x16_bf16 v[48:63], v[100:103], a[64:67], v[48:63]
  s_waitcnt vmcnt(10) lgkmcnt(14)
  ds_read_b64_tr_b16 v[100:101], v11 offset:40960
  ds_read_b64_tr_b16 v[102:103], v11 offset:41984
  ds_write_b128 v31, v[208:211] offset:16384
  ds_write_b128 v31, v[212:215] offset:17408
  v_and_b32 v231, 0xffff0000, v247
  v_lshlrev_b32 v232, 16, v248
  v_mfma_f32_32x32x16_bf16 v[32:47], v[104:107], a[68:71], v[32:47]
  ds_read_b64_tr_b16 v[104:105], v10 offset:43008
  ds_read_b64_tr_b16 v[106:107], v10 offset:44032
  buffer_load_dwordx4 a[100:103], v2, s[28:31], s59 offen offset:1024 sc1
  v_and_b32 v233, 0xffff0000, v248
  v_lshlrev_b32 v234, 16, v249
  v_and_b32 v235, 0xffff0000, v249
  v_mfma_f32_32x32x16_bf16 v[48:63], v[108:111], a[68:71], v[48:63]
  s_waitcnt vmcnt(9) lgkmcnt(8)
  ds_read_b64_tr_b16 v[108:109], v11 offset:43008
  ds_read_b64_tr_b16 v[110:111], v11 offset:44032
  ds_write_b128 v31, v[216:219] offset:24576
  ds_write_b128 v31, v[220:223] offset:25600
  v_lshlrev_b32 v236, 16, v250
  v_and_b32 v237, 0xffff0000, v250
  v_mfma_f32_32x32x16_bf16 v[32:47], v[112:115], a[72:75], v[32:47]
  ds_read_b64_tr_b16 v[112:113], v10 offset:45056
  ds_read_b64_tr_b16 v[114:115], v10 offset:46080
  buffer_load_dwordx4 a[104:107], v2, s[28:31], s59 offen offset:2048 sc1
  v_lshlrev_b32 v238, 16, v251
  v_and_b32 v239, 0xffff0000, v251
  v_mfma_f32_32x32x16_bf16 v[48:63], v[116:119], a[72:75], v[48:63]
  s_waitcnt vmcnt(8)
  ds_read_b64_tr_b16 v[116:117], v11 offset:45056
  ds_read_b64_tr_b16 v[118:119], v11 offset:46080
  v_mfma_f32_32x32x16_bf16 v[32:47], v[120:123], a[76:79], v[32:47]
  ds_read_b64_tr_b16 v[120:121], v10 offset:47104
  ds_read_b64_tr_b16 v[122:123], v10 offset:48128
  buffer_load_dwordx4 a[108:111], v2, s[28:31], s59 offen offset:3072 sc1
  v_mfma_f32_32x32x16_bf16 v[48:63], v[124:127], a[76:79], v[48:63]
  s_waitcnt vmcnt(7) lgkmcnt(14)
  ds_read_b64_tr_b16 v[124:125], v11 offset:47104
  ds_read_b64_tr_b16 v[126:127], v11 offset:48128
  v_mfma_f32_32x32x16_bf16 v[32:47], v[96:99], a[80:83], v[32:47]
  ds_read_b64_tr_b16 v[96:97], v10 offset:49152
  ds_read_b64_tr_b16 v[98:99], v10 offset:50176
  s_xor_b32 s59, s73, 28672
  buffer_load_dwordx4 a[112:115], v2, s[28:31], s59 offen offset:0 sc1
  v_add_f32 v128, v128, v130
  v_add_f32 v129, v129, v131
  v_mfma_f32_32x32x16_bf16 v[48:63], v[100:103], a[80:83], v[48:63]
  s_waitcnt vmcnt(7) lgkmcnt(14)
  ds_read_b64_tr_b16 v[100:101], v11 offset:49152
  ds_read_b64_tr_b16 v[102:103], v11 offset:50176
  v_add_f32 v132, v132, v134
  v_add_f32 v133, v133, v135
  v_add_f32 v136, v136, v138
  v_add_f32 v137, v137, v139
  v_mfma_f32_32x32x16_bf16 v[32:47], v[104:107], a[84:87], v[32:47]
  s_waitcnt lgkmcnt(14)
  ds_read_b64_tr_b16 v[104:105], v10 offset:51200
  ds_read_b64_tr_b16 v[106:107], v10 offset:52224
  buffer_load_dwordx4 a[116:119], v2, s[28:31], s59 offen offset:1024 sc1
  v_add_f32 v140, v140, v142
  v_add_f32 v141, v141, v143
  v_add_f32 v128, v128, v132
  v_mfma_f32_32x32x16_bf16 v[48:63], v[108:111], a[84:87], v[48:63]
  s_waitcnt vmcnt(7) lgkmcnt(12)
  ds_read_b64_tr_b16 v[108:109], v11 offset:51200
  ds_read_b64_tr_b16 v[110:111], v11 offset:52224
  v_add_f32 v129, v129, v133
  v_add_f32 v136, v136, v140
  v_add_f32 v137, v137, v141
  v_add_f32 v128, v128, v136
  v_mfma_f32_32x32x16_bf16 v[32:47], v[112:115], a[88:91], v[32:47]
  s_waitcnt lgkmcnt(12)
  ds_read_b64_tr_b16 v[112:113], v10 offset:53248
  ds_read_b64_tr_b16 v[114:115], v10 offset:54272
  buffer_load_dwordx4 a[120:123], v2, s[28:31], s59 offen offset:2048 sc1
  v_add_f32 v129, v129, v137
  v_mov_b32 v27, 0
  s_nop 0
  v_permlane32_swap_b32 v128, v129
  v_mfma_f32_32x32x16_bf16 v[48:63], v[116:119], a[88:91], v[48:63]
  s_waitcnt vmcnt(7) lgkmcnt(12)
  ds_read_b64_tr_b16 v[116:117], v11 offset:53248
  ds_read_b64_tr_b16 v[118:119], v11 offset:54272
  v_add_f32 v128, v128, v129
  v_mov_b32 v129, v128
  s_nop 1
  v_permlane32_swap_b32 v128, v129
  v_mul_f32 v128, 0xbb000000, v128
  v_mfma_f32_32x32x16_bf16 v[32:47], v[120:123], a[92:95], v[32:47]
  s_waitcnt lgkmcnt(12)
  ds_read_b64_tr_b16 v[120:121], v10 offset:55296
  ds_read_b64_tr_b16 v[122:123], v10 offset:56320
  buffer_load_dwordx4 a[124:127], v2, s[28:31], s59 offen offset:3072 sc1
  v_mul_f32 v129, 0x3b000000, v129
  v_fma_f32 v129, -v128, v128, v129
  v_max_f32 v129, 0, v129
  v_mfma_f32_32x32x16_bf16 v[48:63], v[124:127], a[92:95], v[48:63]
  s_waitcnt vmcnt(7) lgkmcnt(12)
  ds_read_b64_tr_b16 v[124:125], v11 offset:55296
  ds_read_b64_tr_b16 v[126:127], v11 offset:56320
  buffer_load_dwordx4 v[144:147], v20, s[36:39], s60 offen offset:0 sc1
  buffer_load_dwordx4 v[148:151], v20, s[36:39], s60 offen offset:512 sc1
  buffer_load_dwordx4 v[152:155], v20, s[36:39], s60 offen offset:1024 sc1
  buffer_load_dwordx4 v[156:159], v20, s[36:39], s60 offen offset:1536 sc1
  v_mfma_f32_32x32x16_bf16 v[32:47], v[96:99], a[96:99], v[32:47]
  s_waitcnt lgkmcnt(12)
  ds_read_b64_tr_b16 v[96:97], v10 offset:57344
  ds_read_b64_tr_b16 v[98:99], v10 offset:58368
  v_add_f32 v129, 0x3727c5ac, v129
  v_rsq_f32 v28, v129
  v_cvt_pk_bf16_f32 v130, v128, v128
  v_mfma_f32_32x32x16_bf16 v[48:63], v[100:103], a[96:99], v[48:63]
  s_waitcnt vmcnt(10) lgkmcnt(12)
  ds_read_b64_tr_b16 v[100:101], v11 offset:57344
  ds_read_b64_tr_b16 v[102:103], v11 offset:58368
  v_mul_f32 v29, 0x3fb8aa3b, v28
  v_mul_f32 v129, v129, v28
  v_lshlrev_b32 v130, 16, v130
  v_sub_f32 v130, v128, v130
  v_mfma_f32_32x32x16_bf16 v[32:47], v[104:107], a[100:103], v[32:47]
  s_waitcnt lgkmcnt(12)
  ds_read_b64_tr_b16 v[104:105], v10 offset:59392
  ds_read_b64_tr_b16 v[106:107], v10 offset:60416
  v_cvt_pk_bf16_f32 v131, v129, v129
  v_cndmask_b32 v128, v128, v130, s[46:47]
  v_lshlrev_b32 v131, 16, v131
  v_cvt_pk_bf16_f32 v24, v128, v128
  v_mfma_f32_32x32x16_bf16 v[48:63], v[108:111], a[100:103], v[48:63]
  s_waitcnt vmcnt(9) lgkmcnt(12)
  ds_read_b64_tr_b16 v[108:109], v11 offset:59392
  ds_read_b64_tr_b16 v[110:111], v11 offset:60416
  v_sub_f32 v131, v129, v131
  v_mov_b32 v26, v24
  v_cndmask_b32 v129, v129, v131, s[46:47]
  v_cvt_pk_bf16_f32 v25, v129, 0
  v_mfma_f32_32x32x16_bf16 v[32:47], v[112:115], a[104:107], v[32:47]
  s_waitcnt lgkmcnt(12)
  ds_read_b64_tr_b16 v[112:113], v10 offset:61440
  ds_read_b64_tr_b16 v[114:115], v10 offset:62464
  v_mfma_f32_32x32x16_bf16 v[48:63], v[116:119], a[104:107], v[48:63]
  s_waitcnt vmcnt(8) lgkmcnt(12)
  ds_read_b64_tr_b16 v[116:117], v11 offset:61440
  ds_read_b64_tr_b16 v[118:119], v11 offset:62464
  v_mfma_f32_32x32x16_bf16 v[32:47], v[120:123], a[108:111], v[32:47]
  s_waitcnt lgkmcnt(12)
  ds_read_b64_tr_b16 v[120:121], v10 offset:63488
  ds_read_b64_tr_b16 v[122:123], v10 offset:64512
  v_mfma_f32_32x32x16_bf16 v[48:63], v[124:127], a[108:111], v[48:63]
  s_waitcnt vmcnt(7) lgkmcnt(12)
  ds_read_b64_tr_b16 v[124:125], v11 offset:63488
  ds_read_b64_tr_b16 v[126:127], v11 offset:64512
  v_mfma_f32_32x32x16_bf16 v[32:47], v[96:99], a[112:115], v[32:47]
  s_waitcnt lgkmcnt(12)
  v_mfma_f32_32x32x16_bf16 v[48:63], v[100:103], a[112:115], v[48:63]
  s_waitcnt vmcnt(6) lgkmcnt(10)
  v_mfma_f32_32x32x16_bf16 v[32:47], v[104:107], a[116:119], v[32:47]
  s_waitcnt lgkmcnt(8)
  v_mfma_f32_32x32x16_bf16 v[48:63], v[108:111], a[116:119], v[48:63]
  s_waitcnt lgkmcnt(0)
  s_barrier
  ds_read_b128 v[108:111], v2 offset:0
  s_add_u32 m0, s63, 131072
  s_add_u32 s27, s95, 7168
  buffer_load_dwordx4 v5, s[16:19], s95 offen lds
  buffer_load_dwordx4 v5, s[16:19], s27 offen offset:1024 lds
  s_waitcnt vmcnt(7)
  v_mfma_f32_32x32x16_bf16 v[32:47], v[112:115], a[120:123], v[32:47]
  s_waitcnt vmcnt(6)
  ds_read_b128 v[112:115], v2 offset:2048
  v_mov_b32 v0, 0x200
  buffer_store_dword v0, off, s[36:39], s72
  v_mfma_f32_32x32x16_bf16 v[48:63], v[116:119], a[120:123], v[48:63]
  s_waitcnt vmcnt(3)
  ds_read_b128 v[116:119], v2 offset:4096
  v_min3_u32 v130, v145, v147, v149
  v_min3_u32 v131, v151, v153, v155
  v_min3_u32 v130, v157, v159, v130
  v_min_u32 v130, v130, v131
  v_mfma_f32_32x32x16_bf16 v[32:47], v[120:123], a[124:127], v[32:47]
  ds_read_b128 v[120:123], v2 offset:6144
  v_cmp_eq_u32 vcc, 0, v130
  s_cbranch_vccnz L_ewspin_15
L_ewback_16:
  v_mfma_f32_32x32x16_bf16 v[48:63], v[124:127], a[124:127], v[48:63]
  ds_read_b128 v[124:127], v2 offset:8192
  v_mfma_f32_32x32x16_bf16 v[32:47], v[144:147], v[24:27], v[32:47]
  ds_read_b128 v[96:99], v2 offset:10240
  s_add_u32 m0, s63, 139264
  s_add_u32 s27, s96, 7168
  buffer_load_dwordx4 v5, s[16:19], s96 offen lds
  buffer_load_dwordx4 v5, s[16:19], s27 offen offset:1024 lds
  v_mfma_f32_32x32x16_bf16 v[48:63], v[148:151], v[24:27], v[48:63]
  ds_read_b128 v[100:103], v2 offset:12288
  v_mfma_f32_32x32x16_bf16 v[64:79], v[152:155], v[24:27], 0
  ds_read_b128 v[104:107], v2 offset:14336
  s_nop 2
  v_pk_mul_f32 v[32:33], v[32:33], v[28:29] op_sel:[0,1] op_sel_hi:[1,1]
  v_pk_mul_f32 v[34:35], v[34:35], v[28:29] op_sel:[0,1] op_sel_hi:[1,1]
  v_pk_mul_f32 v[36:37], v[36:37], v[28:29] op_sel:[0,1] op_sel_hi:[1,1]
  v_pk_mul_f32 v[38:39], v[38:39], v[28:29] op_sel:[0,1] op_sel_hi:[1,1]
  v_exp_f32 v128, v32
  v_exp_f32 v129, v33
  v_exp_f32 v130, v34
  v_exp_f32 v131, v35
  v_exp_f32 v132, v36
  v_exp_f32 v133, v37
  v_exp_f32 v134, v38
  v_exp_f32 v135, v39
  v_pk_fma_f32 v[128:129], v[128:129], s[52:53], s[52:53]
  v_pk_fma_f32 v[130:131], v[130:131], s[52:53], s[52:53]
  v_pk_fma_f32 v[132:133], v[132:133], s[52:53], s[52:53]
  v_pk_fma_f32 v[134:135], v[134:135], s[52:53], s[52:53]
  s_add_u32 m0, s63, 147456
  s_add_u32 s27, s97, 7168
  buffer_load_dwordx4 v5, s[16:19], s97 offen lds
  buffer_load_dwordx4 v5, s[16:19], s27 offen offset:1024 lds
  v_pk_fma_f32 v[128:129], v[128:129], v[128:129], 0.5 op_sel_hi:[1,1,0]
  v_pk_fma_f32 v[130:131], v[130:131], v[130:131], 0.5 op_sel_hi:[1,1,0]
  v_pk_fma_f32 v[132:133], v[132:133], v[132:133], 0.5 op_sel_hi:[1,1,0]
  v_pk_fma_f32 v[134:135], v[134:135], v[134:135], 0.5 op_sel_hi:[1,1,0]
  v_rcp_f32 v128, v128
  v_rcp_f32 v129, v129
  v_rcp_f32 v130, v130
  v_rcp_f32 v131, v131
  v_rcp_f32 v132, v132
  v_rcp_f32 v133, v133
  v_rcp_f32 v134, v134
  v_rcp_f32 v135, v135
  v_pk_fma_f32 v[32:33], v[32:33], v[128:129], v[32:33] neg_lo:[1,0,0] neg_hi:[1,0,0]
  v_pk_fma_f32 v[34:35], v[34:35], v[130:131], v[34:35] neg_lo:[1,0,0] neg_hi:[1,0,0]
  v_pk_fma_f32 v[36:37], v[36:37], v[132:133], v[36:37] neg_lo:[1,0,0] neg_hi:[1,0,0]
  v_pk_fma_f32 v[38:39], v[38:39], v[134:135], v[38:39] neg_lo:[1,0,0] neg_hi:[1,0,0]
  v_cvt_pk_bf16_f32 v160, v32, v33
  v_cvt_pk_bf16_f32 v161, v34, v35
  v_cvt_pk_bf16_f32 v162, v36, v37
  v_cvt_pk_bf16_f32 v163, v38, v39
  v_pk_mul_f32 v[40:41], v[40:41], v[28:29] op_sel:[0,1] op_sel_hi:[1,1]
  v_pk_mul_f32 v[42:43], v[42:43], v[28:29] op_sel:[0,1] op_sel_hi:[1,1]
  v_pk_mul_f32 v[44:45], v[44:45], v[28:29] op_sel:[0,1] op_sel_hi:[1,1]
  v_pk_mul_f32 v[46:47], v[46:47], v[28:29] op_sel:[0,1] op_sel_hi:[1,1]
  v_exp_f32 v128, v40
  v_exp_f32 v129, v41
  v_exp_f32 v130, v42
  v_exp_f32 v131, v43
  v_exp_f32 v132, v44
  v_exp_f32 v133, v45
  buffer_store_dwordx4 v[160:163], v3, s[36:39], s8 offen offset:0
  s_add_u32 m0, s63, 155648
  s_add_u32 s27, s98, 7168
  buffer_load_dwordx4 v5, s[16:19], s98 offen lds
  buffer_load_dwordx4 v5, s[16:19], s27 offen offset:1024 lds
  v_exp_f32 v134, v46
  v_exp_f32 v135, v47
  v_pk_fma_f32 v[128:129], v[128:129], s[52:53], s[52:53]
  v_pk_fma_f32 v[130:131], v[130:131], s[52:53], s[52:53]
  v_pk_fma_f32 v[132:133], v[132:133], s[52:53], s[52:53]
  v_pk_fma_f32 v[134:135], v[134:135], s[52:53], s[52:53]
  v_pk_fma_f32 v[128:129], v[128:129], v[128:129], 0.5 op_sel_hi:[1,1,0]
  v_pk_fma_f32 v[130:131], v[130:131], v[130:131], 0.5 op_sel_hi:[1,1,0]
  v_pk_fma_f32 v[132:133], v[132:133], v[132:133], 0.5 op_sel_hi:[1,1,0]
  v_pk_fma_f32 v[134:135], v[134:135], v[134:135], 0.5 op_sel_hi:[1,1,0]
  v_rcp_f32 v128, v128
  v_rcp_f32 v129, v129
  v_rcp_f32 v130, v130
  v_rcp_f32 v131, v131
  v_rcp_f32 v132, v132
  v_rcp_f32 v133, v133
  v_rcp_f32 v134, v134
  v_rcp_f32 v135, v135
  v_pk_fma_f32 v[40:41], v[40:41], v[128:129], v[40:41] neg_lo:[1,0,0] neg_hi:[1,0,0]
  v_pk_fma_f32 v[42:43], v[42:43], v[130:131], v[42:43] neg_lo:[1,0,0] neg_hi:[1,0,0]
  v_pk_fma_f32 v[44:45], v[44:45], v[132:133], v[44:45] neg_lo:[1,0,0] neg_hi:[1,0,0]
  v_pk_fma_f32 v[46:47], v[46:47], v[134:135], v[46:47] neg_lo:[1,0,0] neg_hi:[1,0,0]
  v_cvt_pk_bf16_f32 v164, v40, v41
  v_cvt_pk_bf16_f32 v165, v42, v43
  v_cvt_pk_bf16_f32 v166, v44, v45
  v_cvt_pk_bf16_f32 v167, v46, v47
  v_mul_f32 v48, v48, v29
  v_mul_f32 v49, v49, v29
  v_exp_f32 v128, v48
  v_mul_f32 v50, v50, v29
  v_fma_f32 v128, v128, s52, s52
  s_waitcnt lgkmcnt(7)
  v_mfma_f32_32x32x16_bf16 v[64:79], v[108:111], a[0:3], v[64:79]
  s_waitcnt lgkmcnt(6)
  ds_read_b128 v[108:111], v2 offset:16384
  buffer_store_dwordx4 v[164:167], v3, s[36:39], s8 offen offset:1024
  s_add_u32 m0, s63, 32768
  s_add_u32 s26, s96, 32768
  s_add_u32 s27, s96, 39936
  buffer_load_dwordx4 v5, s[16:19], s26 offen lds
  v_mfma_f32_32x32x16_bf16 v[64:79], v[112:115], a[4:7], v[64:79]
  s_waitcnt lgkmcnt(6)
  ds_read_b128 v[112:115], v2 offset:18432
  buffer_load_dwordx4 v5, s[16:19], s27 offen offset:1024 lds
  v_exp_f32 v129, v49
  v_mul_f32 v51, v51, v29
  v_fma_f32 v129, v129, s52, s52
  v_mfma_f32_32x32x16_bf16 v[64:79], v[116:119], a[8:11], v[64:79]
  s_waitcnt lgkmcnt(6)
  ds_read_b128 v[116:119], v2 offset:20480
  v_exp_f32 v130, v50
  v_fma_f32 v128, v128, v128, 0.5
  v_mul_f32 v52, v52, v29
  v_fma_f32 v130, v130, s52, s52
  v_mfma_f32_32x32x16_bf16 v[64:79], v[120:123], a[12:15], v[64:79]
  s_waitcnt lgkmcnt(6)
  ds_read_b128 v[120:123], v2 offset:22528
  buffer_load_dword v17, v6, s[36:39], s70 offen sc1
  s_add_u32 m0, s63, 40960
  s_add_u32 s26, s97, 32768
  s_add_u32 s27, s97, 39936
  buffer_load_dwordx4 v5, s[16:19], s26 offen lds
  v_mfma_f32_32x32x16_bf16 v[64:79], v[124:127], a[16:19], v[64:79]
  s_waitcnt lgkmcnt(6)
  ds_read_b128 v[124:127], v2 offset:24576
  buffer_load_dwordx4 v5, s[16:19], s27 offen offset:1024 lds
  v_exp_f32 v131, v51
  v_fma_f32 v129, v129, v129, 0.5
  v_mul_f32 v53, v53, v29
  v_mfma_f32_32x32x16_bf16 v[64:79], v[96:99], a[20:23], v[64:79]
  s_waitcnt lgkmcnt(6)
  ds_read_b128 v[96:99], v2 offset:26624
  v_rcp_f32 v128, v128
  v_exp_f32 v132, v52
  v_fma_f32 v131, v131, s52, s52
  v_mfma_f32_32x32x16_bf16 v[64:79], v[100:103], a[24:27], v[64:79]
  s_waitcnt lgkmcnt(6)
  ds_read_b128 v[100:103], v2 offset:28672
  v_fma_f32 v130, v130, v130, 0.5
  v_rcp_f32 v129, v129
  v_fma_f32 v48, -v48, v128, v48
  v_mul_f32 v54, v54, v29
  v_mfma_f32_32x32x16_bf16 v[64:79], v[104:107], a[28:31], v[64:79]
  s_waitcnt lgkmcnt(6)
  ds_read_b128 v[104:107], v2 offset:30720
  v_exp_f32 v133, v53
  v_fma_f32 v132, v132, s52, s52
  v_fma_f32 v131, v131, v131, 0.5
  v_fma_f32 v49, -v49, v129, v49
  v_mfma_f32_32x32x16_bf16 v[64:79], v[108:111], a[32:35], v[64:79]
  s_waitcnt lgkmcnt(6)
  ds_read_b128 v[108:111], v16 offset:0
  s_add_u32 m0, s63, 49152
  s_add_u32 s26, s98, 32768
  s_add_u32 s27, s98, 39936
  buffer_load_dwordx4 v5, s[16:19], s26 offen lds
  buffer_load_dwordx4 v5, s[16:19], s27 offen offset:1024 lds
  v_mfma_f32_32x32x16_bf16 v[64:79], v[112:115], a[36:39], v[64:79]
  s_waitcnt lgkmcnt(6)
  ds_read_b128 v[112:115], v16 offset:2048
  v_rcp_f32 v130, v130
  v_mul_f32 v55, v55, v29
  v_exp_f32 v134, v54
  v_mfma_f32_32x32x16_bf16 v[64:79], v[116:119], a[40:43], v[64:79]
  s_waitcnt lgkmcnt(6)
  ds_read_b128 v[116:119], v16 offset:4096
  v_fma_f32 v133, v133, s52, s52
  v_fma_f32 v132, v132, v132, 0.5
  v_rcp_f32 v131, v131
  v_fma_f32 v50, -v50, v130, v50
  v_mfma_f32_32x32x16_bf16 v[64:79], v[120:123], a[44:47], v[64:79]
  s_waitcnt lgkmcnt(6)
  ds_read_b128 v[120:123], v16 offset:6144
  v_cvt_pk_bf16_f32 v168, v48, v49
  v_mul_f32 v56, v56, v29
  v_exp_f32 v135, v55
  v_fma_f32 v134, v134, s52, s52
  v_mfma_f32_32x32x16_bf16 v[64:79], v[124:127], a[48:51], v[64:79]
  s_waitcnt lgkmcnt(6)
  ds_read_b128 v[124:127], v16 offset:8192
  v_fma_f32 v133, v133, v133, 0.5
  v_rcp_f32 v132, v132
  v_fma_f32 v51, -v51, v131, v51
  v_mul_f32 v57, v57, v29
  v_mfma_f32_32x32x16_bf16 v[64:79], v[96:99], a[52:55], v[64:79]
  s_waitcnt vmcnt(7) lgkmcnt(6)
  ds_read_b128 v[96:99], v16 offset:10240
  buffer_store_dword v18, off, s[36:39], s72 offset:128
  s_add_u32 m0, s63, 57344
  s_add_u32 s26, s95, 65536
  s_add_u32 s27, s95, 72704
  buffer_load_dwordx4 v5, s[16:19], s26 offen lds
  v_mfma_f32_32x32x16_bf16 v[64:79], v[100:103], a[56:59], v[64:79]
  s_waitcnt vmcnt(6)
  ds_read_b128 v[100:103], v16 offset:12288
  v_cmp_gt_u32 vcc, 0x200, v17
  s_cbranch_vccnz L_spin_18
L_back_19:
  buffer_load_dwordx4 v5, s[16:19], s27 offen offset:1024 lds
  v_exp_f32 v128, v56
  s_waitcnt lgkmcnt(7)
  v_mfma_f32_32x32x16_bf16 v[64:79], v[104:107], a[60:63], v[64:79]
  s_waitcnt lgkmcnt(6)
  ds_read_b128 v[104:107], v16 offset:14336
  v_fma_f32 v135, v135, s52, s52
  v_fma_f32 v134, v134, v134, 0.5
  v_rcp_f32 v133, v133
  v_fma_f32 v52, -v52, v132, v52
  v_mfma_f32_32x32x16_bf16 v[64:79], v[108:111], a[64:67], v[64:79]
  s_waitcnt lgkmcnt(6)
  ds_read_b128 v[108:111], v16 offset:16384
  v_cvt_pk_bf16_f32 v169, v50, v51
  v_mul_f32 v58, v58, v29
  v_exp_f32 v129, v57
  v_fma_f32 v128, v128, s52, s52
  v_mfma_f32_32x32x16_bf16 v[64:79], v[112:115], a[68:71], v[64:79]
  s_waitcnt lgkmcnt(6)
  ds_read_b128 v[112:115], v16 offset:18432
  v_fma_f32 v135, v135, v135, 0.5
  v_rcp_f32 v134, v134
  v_fma_f32 v53, -v53, v133, v53
  v_mul_f32 v59, v59, v29
  v_mfma_f32_32x32x16_bf16 v[64:79], v[116:119], a[72:75], v[64:79]
  s_waitcnt lgkmcnt(6)
  ds_read_b128 v[116:119], v16 offset:20480
  s_add_u32 m0, s63, 65536
  s_add_u32 s26, s96, 65536
  s_add_u32 s27, s96, 72704
  buffer_load_dwordx4 v5, s[16:19], s26 offen lds
  buffer_load_dwordx4 v5, s[16:19], s27 offen offset:1024 lds
  v_mfma_f32_32x32x16_bf16 v[64:79], v[120:123], a[76:79], v[64:79]
  s_waitcnt lgkmcnt(6)
  ds_read_b128 v[120:123], v16 offset:22528
  v_exp_f32 v130, v58
  v_fma_f32 v129, v129, s52, s52
  v_fma_f32 v128, v128, v128, 0.5
  v_fma_f32 v54, -v54, v134, v54
  v_mfma_f32_32x32x16_bf16 v[64:79], v[124:127], a[80:83], v[64:79]
  s_waitcnt lgkmcnt(6)
  ds_read_b128 v[124:127], v16 offset:24576
  v_rcp_f32 v135, v135
  v_cvt_pk_bf16_f32 v170, v52, v53
  v_mul_f32 v60, v60, v29
  v_fma_f32 v130, v130, s52, s52
  v_mfma_f32_32x32x16_bf16 v[64:79], v[96:99], a[84:87], v[64:79]
  s_waitcnt lgkmcnt(6)
  ds_read_b128 v[96:99], v16 offset:26624
  v_exp_f32 v131, v59
  v_fma_f32 v129, v129, v129, 0.5
  v_rcp_f32 v128, v128
  v_mfma_f32_32x32x16_bf16 v[64:79], v[100:103], a[88:91], v[64:79]
  s_waitcnt lgkmcnt(6)
  ds_read_b128 v[100:103], v16 offset:28672
  v_fma_f32 v55, -v55, v135, v55
  v_mul_f32 v61, v61, v29
  v_exp_f32 v132, v60
  v_fma_f32 v131, v131, s52, s52
  v_mfma_f32_32x32x16_bf16 v[64:79], v[104:107], a[92:95], v[64:79]
  s_waitcnt lgkmcnt(6)
  ds_read_b128 v[104:107], v16 offset:30720
  s_add_u32 m0, s63, 73728
  s_add_u32 s26, s97, 65536
  s_add_u32 s27, s97, 72704
  buffer_load_dwordx4 v5, s[16:19], s26 offen lds
  buffer_load_dwordx4 v5, s[16:19], s27 offen offset:1024 lds
  v_mfma_f32_32x32x16_bf16 v[64:79], v[108:111], a[96:99], v[64:79]
  s_waitcnt lgkmcnt(6)
  v_fma_f32 v130, v130, v130, 0.5
  v_rcp_f32 v129, v129
  v_fma_f32 v56, -v56, v128, v56
  v_cvt_pk_bf16_f32 v171, v54, v55
  v_mul_f32 v62, v62, v29
  v_mfma_f32_32x32x16_bf16 v[64:79], v[112:115], a[100:103], v[64:79]
  s_waitcnt lgkmcnt(5)
  ds_read_b128 v[112:115], v2 offset:1024
  buffer_store_dwordx4 v[168:171], v4, s[28:31], s8 offen offset:0
  v_exp_f32 v133, v61
  v_fma_f32 v132, v132, s52, s52
  v_fma_f32 v131, v131, v131, 0.5
  v_mfma_f32_32x32x16_bf16 v[64:79], v[116:119], a[104:107], v[64:79]
  s_waitcnt lgkmcnt(5)
  ds_read_b128 v[116:119], v2 offset:3072
  v_rcp_f32 v130, v130
  v_fma_f32 v57, -v57, v129, v57
  v_mul_f32 v63, v63, v29
  v_fma_f32 v133, v133, s52, s52
  v_mfma_f32_32x32x16_bf16 v[64:79], v[120:123], a[108:111], v[64:79]
  s_waitcnt lgkmcnt(5)
  ds_read_b128 v[120:123], v2 offset:5120
  v_exp_f32 v134, v62
  v_fma_f32 v132, v132, v132, 0.5
  v_rcp_f32 v131, v131
  v_mfma_f32_32x32x16_bf16 v[64:79], v[124:127], a[112:115], v[64:79]
  s_waitcnt lgkmcnt(5)
  ds_read_b128 v[124:127], v2 offset:7168
  s_add_u32 m0, s63, 81920
  s_add_u32 s26, s98, 65536
  s_add_u32 s27, s98, 72704
  buffer_load_dwordx4 v5, s[16:19], s26 offen lds
  buffer_load_dwordx4 v5, s[16:19], s27 offen offset:1024 lds
  v_mfma_f32_32x32x16_bf16 v[64:79], v[96:99], a[116:119], v[64:79]
  s_waitcnt lgkmcnt(5)
  ds_read_b128 v[96:99], v2 offset:9216
  buffer_load_dword v252, v6, s[36:39], s70 offen offset:128 sc1
  v_fma_f32 v58, -v58, v130, v58
  v_cvt_pk_bf16_f32 v172, v56, v57
  v_exp_f32 v135, v63
  v_mfma_f32_32x32x16_bf16 v[64:79], v[100:103], a[120:123], v[64:79]
  s_waitcnt lgkmcnt(5)
  ds_read_b128 v[100:103], v2 offset:11264
  v_fma_f32 v134, v134, s52, s52
  v_fma_f32 v133, v133, v133, 0.5
  v_rcp_f32 v132, v132
  v_fma_f32 v59, -v59, v131, v59
  v_mfma_f32_32x32x16_bf16 v[64:79], v[104:107], a[124:127], v[64:79]
  ds_read_b128 v[104:107], v2 offset:13312
  v_fma_f32 v135, v135, s52, s52
  v_fma_f32 v134, v134, v134, 0.5
  v_rcp_f32 v133, v133
  v_fma_f32 v60, -v60, v132, v60
  v_mfma_f32_32x32x16_bf16 v[80:95], v[156:159], v[24:27], 0
  s_waitcnt lgkmcnt(6)
  ds_read_b128 v[108:111], v2 offset:15360
  v_cvt_pk_bf16_f32 v173, v58, v59
  v_fma_f32 v135, v135, v135, 0.5
  v_rcp_f32 v134, v134
  v_fma_f32 v61, -v61, v133, v61
  v_mfma_f32_32x32x16_bf16 v[80:95], v[112:115], a[0:3], v[80:95]
  s_waitcnt lgkmcnt(6)
  ds_read_b128 v[112:115], v2 offset:17408
  s_add_u32 m0, s63, 90112
  s_add_u32 s26, s96, 98304
  s_add_u32 s27, s96, 105472
  buffer_load_dwordx4 v5, s[16:19], s26 offen lds
  buffer_load_dwordx4 v5, s[16:19], s27 offen offset:1024 lds
  v_mfma_f32_32x32x16_bf16 v[80:95], v[116:119], a[4:7], v[80:95]
  s_waitcnt lgkmcnt(6)
  ds_read_b128 v[116:119], v2 offset:19456
  v_rcp_f32 v135, v135
  v_fma_f32 v62, -v62, v134, v62
  v_cvt_pk_bf16_f32 v174, v60, v61
  v_fma_f32 v63, -v63, v135, v63
  v_mfma_f32_32x32x16_bf16 v[80:95], v[120:123], a[8:11], v[80:95]
  s_waitcnt lgkmcnt(6)
  ds_read_b128 v[120:123], v2 offset:21504
  v_cvt_pk_bf16_f32 v175, v62, v63
  v_mul_f32 v64, v64, v29
  v_mul_f32 v65, v65, v29
  v_exp_f32 v128, v64
  v_mfma_f32_32x32x16_bf16 v[80:95], v[124:127], a[12:15], v[80:95]
  s_waitcnt lgkmcnt(6)
  ds_read_b128 v[124:127], v2 offset:23552
  buffer_store_dwordx4 v[172:175], v4, s[28:31], s8 offen offset:1024
  v_mul_f32 v66, v66, v29
  v_exp_f32 v129, v65
  v_fma_f32 v128, v128, s52, s52
  v_mfma_f32_32x32x16_bf16 v[80:95], v[96:99], a[16:19], v[80:95]
  s_waitcnt lgkmcnt(6)
  ds_read_b128 v[96:99], v2 offset:25600
  v_mul_f32 v67, v67, v29
  v_exp_f32 v130, v66
  v_fma_f32 v129, v129, s52, s52
  v_fma_f32 v128, v128, v128, 0.5
  v_mfma_f32_32x32x16_bf16 v[80:95], v[100:103], a[20:23], v[80:95]
  s_waitcnt lgkmcnt(6)
  ds_read_b128 v[100:103], v2 offset:27648
  v_mul_f32 v68, v68, v29
  v_exp_f32 v131, v67
  v_fma_f32 v130, v130, s52, s52
  v_fma_f32 v129, v129, v129, 0.5
  v_mfma_f32_32x32x16_bf16 v[80:95], v[104:107], a[24:27], v[80:95]
  s_waitcnt lgkmcnt(6)
  ds_read_b128 v[104:107], v2 offset:29696
  v_rcp_f32 v128, v128
  v_mul_f32 v69, v69, v29
  v_exp_f32 v132, v68
  v_mfma_f32_32x32x16_bf16 v[80:95], v[108:111], a[28:31], v[80:95]
  s_waitcnt vmcnt(3) lgkmcnt(6)
  ds_read_b128 v[108:111], v2 offset:31744
  v_cmp_eq_u32 vcc, 0, v252
  s_nop 0
  s_cmp_eq_u64 vcc, 0
  s_cselect_b32 s34, s38, 0
  s_mov_b64 s[32:33], s[36:37]
  s_cselect_b32 s55, 1, 0
  v_mfma_f32_32x32x16_bf16 v[80:95], v[112:115], a[32:35], v[80:95]
  s_waitcnt lgkmcnt(6)
  ds_read_b128 v[112:115], v16 offset:1024
  buffer_load_dwordx4 a[128:131], v3, s[32:35], s9 offen offset:0 sc1
  buffer_load_dwordx4 a[132:135], v3, s[32:35], s9 offen offset:1024 sc1
  buffer_load_dwordx4 a[136:139], v3, s[32:35], s10 offen offset:0 sc1
  buffer_load_dwordx4 a[140:143], v3, s[32:35], s10 offen offset:1024 sc1
  buffer_load_dwordx4 a[144:147], v3, s[32:35], s11 offen offset:0 sc1
  v_mfma_f32_32x32x16_bf16 v[80:95], v[116:119], a[36:39], v[80:95]
  s_waitcnt lgkmcnt(6)
  ds_read_b128 v[116:119], v16 offset:3072
  v_fma_f32 v131, v131, s52, s52
  v_fma_f32 v130, v130, v130, 0.5
  v_rcp_f32 v129, v129
  v_fma_f32 v64, -v64, v128, v64
  v_mfma_f32_32x32x16_bf16 v[80:95], v[120:123], a[40:43], v[80:95]
  s_waitcnt lgkmcnt(6)
  ds_read_b128 v[120:123], v16 offset:5120
  v_mul_f32 v70, v70, v29
  v_exp_f32 v133, v69
  v_fma_f32 v132, v132, s52, s52
  v_fma_f32 v131, v131, v131, 0.5
  v_mfma_f32_32x32x16_bf16 v[80:95], v[124:127], a[44:47], v[80:95]
  s_waitcnt lgkmcnt(6)
  ds_read_b128 v[124:127], v16 offset:7168
  buffer_load_dwordx4 a[148:151], v3, s[32:35], s11 offen offset:1024 sc1
  v_rcp_f32 v130, v130
  v_fma_f32 v65, -v65, v129, v65
  v_mul_f32 v71, v71, v29
  v_mfma_f32_32x32x16_bf16 v[80:95], v[96:99], a[48:51], v[80:95]
  s_waitcnt lgkmcnt(6)
  ds_read_b128 v[96:99], v16 offset:9216
  v_exp_f32 v134, v70
  v_fma_f32 v133, v133, s52, s52
  v_fma_f32 v132, v132, v132, 0.5
  v_fma_f32 v66, -v66, v130, v66
  v_mfma_f32_32x32x16_bf16 v[80:95], v[100:103], a[52:55], v[80:95]
  s_waitcnt vmcnt(6) lgkmcnt(6)
  ds_read_b128 v[100:103], v16 offset:11264
  buffer_store_dword v18, off, s[36:39], s72 offset:192
  buffer_load_dwordx4 a[152:155], v3, s[32:35], s12 offen offset:0 sc1
  v_rcp_f32 v131, v131
  v_cvt_pk_bf16_f32 v176, v64, v65
  v_mfma_f32_32x32x16_bf16 v[80:95], v[104:107], a[56:59], v[80:95]
  s_waitcnt lgkmcnt(6)
  ds_read_b128 v[104:107], v16 offset:13312
  v_mul_f32 v72, v72, v29
  v_exp_f32 v135, v71
  v_fma_f32 v134, v134, s52, s52
  v_fma_f32 v133, v133, v133, 0.5
  v_mfma_f32_32x32x16_bf16 v[80:95], v[108:111], a[60:63], v[80:95]
  s_waitcnt lgkmcnt(6)
  ds_read_b128 v[108:111], v16 offset:15360
  buffer_load_dwordx4 a[156:159], v3, s[32:35], s12 offen offset:1024 sc1
  v_rcp_f32 v132, v132
  v_fma_f32 v67, -v67, v131, v67
  v_mul_f32 v73, v73, v29
  v_mfma_f32_32x32x16_bf16 v[80:95], v[112:115], a[64:67], v[80:95]
  s_waitcnt lgkmcnt(6)
  ds_read_b128 v[112:115], v16 offset:17408
  v_exp_f32 v128, v72
  v_fma_f32 v135, v135, s52, s52
  v_fma_f32 v134, v134, v134, 0.5
  v_fma_f32 v68, -v68, v132, v68
  v_mfma_f32_32x32x16_bf16 v[80:95], v[116:119], a[68:71], v[80:95]
  s_waitcnt lgkmcnt(6)
  ds_read_b128 v[116:119], v16 offset:19456
  buffer_load_dwordx4 a[160:163], v3, s[32:35], s13 offen offset:0 sc1
  v_rcp_f32 v133, v133
  v_cvt_pk_bf16_f32 v177, v66, v67
  v_and_b32 v176, -2, v176
  v_mfma_f32_32x32x16_bf16 v[80:95], v[120:123], a[72:75], v[80:95]
  s_waitcnt lgkmcnt(6)
  ds_read_b128 v[120:123], v16 offset:21504
  v_mul_f32 v74, v74, v29
  v_exp_f32 v129, v73
  v_fma_f32 v128, v128, s52, s52
  v_fma_f32 v135, v135, v135, 0.5
  v_mfma_f32_32x32x16_bf16 v[80:95], v[124:127], a[76:79], v[80:95]
  s_waitcnt lgkmcnt(6)
  ds_read_b128 v[124:127], v16 offset:23552
  buffer_load_dwordx4 a[164:167], v3, s[32:35], s13 offen offset:1024 sc1
  v_rcp_f32 v134, v134
  v_fma_f32 v69, -v69, v133, v69
  v_mul_f32 v75, v75, v29
  v_mfma_f32_32x32x16_bf16 v[80:95], v[96:99], a[80:83], v[80:95]
  s_waitcnt lgkmcnt(6)
  ds_read_b128 v[96:99], v16 offset:25600
  v_exp_f32 v130, v74
  v_fma_f32 v129, v129, s52, s52
  v_fma_f32 v128, v128, v128, 0.5
  v_fma_f32 v70, -v70, v134, v70
  v_mfma_f32_32x32x16_bf16 v[80:95], v[100:103], a[84:87], v[80:95]
  s_waitcnt lgkmcnt(6)
  ds_read_b128 v[100:103], v16 offset:27648
  buffer_load_dwordx4 a[168:171], v3, s[32:35], s14 offen offset:0 sc1
  v_rcp_f32 v135, v135
  v_cvt_pk_bf16_f32 v178, v68, v69
  v_mul_f32 v76, v76, v29
  v_mfma_f32_32x32x16_bf16 v[80:95], v[104:107], a[88:91], v[80:95]
  s_waitcnt lgkmcnt(6)
  ds_read_b128 v[104:107], v16 offset:29696
  v_exp_f32 v131, v75
  v_fma_f32 v130, v130, s52, s52
  v_fma_f32 v129, v129, v129, 0.5
  v_fma_f32 v71, -v71, v135, v71
  v_mfma_f32_32x32x16_bf16 v[80:95], v[108:111], a[92:95], v[80:95]
  s_waitcnt lgkmcnt(6)
  ds_read_b128 v[108:111], v16 offset:31744
  buffer_load_dwordx4 a[172:175], v3, s[32:35], s14 offen offset:1024 sc1
  v_rcp_f32 v128, v128
  v_mul_f32 v77, v77, v29
  v_fma_f32 v131, v131, s52, s52
  v_mfma_f32_32x32x16_bf16 v[80:95], v[112:115], a[96:99], v[80:95]
  s_barrier
  ds_read_b64_tr_b16 v[112:113], v12 offset:0
  ds_read_b64_tr_b16 v[114:115], v12 offset:1024
  v_exp_f32 v132, v76
  v_fma_f32 v130, v130, v130, 0.5
  s_waitcnt lgkmcnt(8)
  v_mfma_f32_32x32x16_bf16 v[80:95], v[116:119], a[100:103], v[80:95]
  s_waitcnt lgkmcnt(7)
  ds_read_b64_tr_b16 v[116:117], v12 offset:2048
  ds_read_b64_tr_b16 v[118:119], v12 offset:3072
  v_rcp_f32 v129, v129
  v_fma_f32 v72, -v72, v128, v72
  v_cvt_pk_bf16_f32 v179, v70, v71
  v_mfma_f32_32x32x16_bf16 v[80:95], v[120:123], a[104:107], v[80:95]
  s_waitcnt lgkmcnt(8)
  ds_read_b64_tr_b16 v[120:121], v12 offset:4096
  ds_read_b64_tr_b16 v[122:123], v12 offset:5120
  s_add_u32 m0, s63, 0
  s_add_u32 s26, s97, 98304
  s_add_u32 s27, s97, 105472
  buffer_load_dwordx4 v5, s[16:19], s26 offen lds
  v_mfma_f32_32x32x16_bf16 v[80:95], v[124:127], a[108:111], v[80:95]
  s_waitcnt lgkmcnt(9)
  ds_read_b64_tr_b16 v[124:125], v12 offset:6144
  ds_read_b64_tr_b16 v[126:127], v12 offset:7168
  v_mul_f32 v78, v78, v29
  v_exp_f32 v133, v77
  v_fma_f32 v132, v132, s52, s52
  v_mfma_f32_32x32x16_bf16 v[80:95], v[96:99], a[112:115], v[80:95]
  s_waitcnt lgkmcnt(10)
  ds_read_b64_tr_b16 v[96:97], v12 offset:8192
  ds_read_b64_tr_b16 v[98:99], v12 offset:9216
  buffer_load_dwordx4 v5, s[16:19], s27 offen offset:1024 lds
  v_fma_f32 v131, v131, v131, 0.5
  v_rcp_f32 v130, v130
  v_mfma_f32_32x32x16_bf16 v[80:95], v[100:103], a[116:119], v[80:95]
  s_waitcnt lgkmcnt(11)
  ds_read_b64_tr_b16 v[100:101], v12 offset:10240
  ds_read_b64_tr_b16 v[102:103], v12 offset:11264
  v_fma_f32 v73, -v73, v129, v73
  v_mul_f32 v79, v79, v29
  v_exp_f32 v134, v78
  v_mfma_f32_32x32x16_bf16 v[80:95], v[104:107], a[120:123], v[80:95]
  s_waitcnt lgkmcnt(12)
  ds_read_b64_tr_b16 v[104:105], v12 offset:12288
  ds_read_b64_tr_b16 v[106:107], v12 offset:13312
  buffer_load_dword v253, v9, s[36:39], s70 offen offset:192 sc1
  v_fma_f32 v133, v133, s52, s52
  v_fma_f32 v132, v132, v132, 0.5
  v_fma_f32 v74, -v74, v130, v74
  v_mfma_f32_32x32x16_bf16 v[80:95], v[108:111], a[124:127], v[80:95]
  s_waitcnt lgkmcnt(12)
  ds_read_b64_tr_b16 v[108:109], v12 offset:14336
  ds_read_b64_tr_b16 v[110:111], v12 offset:15360
  s_add_u32 m0, s63, 8192
  s_add_u32 s26, s98, 98304
  s_add_u32 s27, s98, 105472
  buffer_load_dwordx4 v5, s[16:19], s26 offen lds
  v_mfma_f32_32x32x16_bf16 v[192:207], v[112:115], v[160:163], 0
  s_waitcnt lgkmcnt(12)
  ds_read_b64_tr_b16 v[112:113], v12 offset:16384
  ds_read_b64_tr_b16 v[114:115], v12 offset:17408
  buffer_load_dwordx4 v5, s[16:19], s27 offen offset:1024 lds
  s_lshl_b32 s60, s99, 2
  s_add_u32 s60, s60, s70
  s_xor_b32 s59, s60, 4
  v_mfma_f32_32x32x16_bf16 v[192:207], v[116:119], v[164:167], v[192:207]
  s_waitcnt lgkmcnt(12)
  ds_read_b64_tr_b16 v[116:117], v12 offset:18432
  ds_read_b64_tr_b16 v[118:119], v12 offset:19456
  v_rcp_f32 v131, v131
  v_cvt_pk_bf16_f32 v180, v72, v73
  v_fma_f32 v134, v134, s52, s52
  v_mfma_f32_32x32x16_bf16 v[192:207], v[120:123], v[168:171], v[192:207]
  s_waitcnt lgkmcnt(12)
  ds_read_b64_tr_b16 v[120:121], v12 offset:20480
  ds_read_b64_tr_b16 v[122:123], v12 offset:21504
  v_exp_f32 v135, v79
  v_fma_f32 v133, v133, v133, 0.5
  v_fma_f32 v75, -v75, v131, v75
  v_mfma_f32_32x32x16_bf16 v[192:207], v[124:127], v[172:175], v[192:207]
  ds_read_b64_tr_b16 v[124:125], v12 offset:22528
  ds_read_b64_tr_b16 v[126:127], v12 offset:23552
  v_rcp_f32 v132, v132
  v_fma_f32 v135, v135, s52, s52
  v_fma_f32 v134, v134, v134, 0.5
  s_cmp_eq_u32 s55, 0
  s_cbranch_scc1 L_catch_21
L_cback_22:
  s_waitcnt vmcnt(17) lgkmcnt(14)
  v_mfma_f32_32x32x16_bf16 v[192:207], v[96:99], a[128:131], v[192:207]
  s_waitcnt vmcnt(16) lgkmcnt(12)
  ds_read_b64_tr_b16 v[96:97], v12 offset:24576
  ds_read_b64_tr_b16 v[98:99], v12 offset:25600
  v_rcp_f32 v133, v133
  v_fma_f32 v76, -v76, v132, v76
  v_mfma_f32_32x32x16_bf16 v[192:207], v[100:103], a[132:135], v[192:207]
  s_waitcnt vmcnt(15) lgkmcnt(12)
  ds_read_b64_tr_b16 v[100:101], v12 offset:26624
  ds_read_b64_tr_b16 v[102:103], v12 offset:27648
  v_cvt_pk_bf16_f32 v181, v74, v75
  v_and_b32 v180, -2, v180
  v_fma_f32 v135, v135, v135, 0.5
  v_fma_f32 v77, -v77, v133, v77
  v_mfma_f32_32x32x16_bf16 v[192:207], v[104:107], a[136:139], v[192:207]
  s_waitcnt vmcnt(14) lgkmcnt(12)
  ds_read_b64_tr_b16 v[104:105], v12 offset:28672
  ds_read_b64_tr_b16 v[106:107], v12 offset:29696
  v_rcp_f32 v134, v134
  v_rcp_f32 v135, v135
  v_mfma_f32_32x32x16_bf16 v[192:207], v[108:111], a[140:143], v[192:207]
  s_waitcnt vmcnt(5) lgkmcnt(12)
  ds_read_b64_tr_b16 v[108:109], v12 offset:30720
  ds_read_b64_tr_b16 v[110:111], v12 offset:31744
  v_mov_b32 v0, 0x300
  buffer_store_dword v0, off, s[36:39], s72
  v_fma_f32 v78, -v78, v134, v78
  v_cvt_pk_bf16_f32 v182, v76, v77
  v_mfma_f32_32x32x16_bf16 v[192:207], v[112:115], a[144:147], v[192:207]
  s_waitcnt lgkmcnt(12)
  ds_read_b64_tr_b16 v[112:113], v10 offset:24576
  ds_read_b64_tr_b16 v[114:115], v10 offset:25600
  v_fma_f32 v79, -v79, v135, v79
  v_cvt_pk_bf16_f32 v183, v78, v79
  v_mul_f32 v80, v80, v29
  v_mul_f32 v81, v81, v29
  v_mfma_f32_32x32x16_bf16 v[192:207], v[116:119], a[148:151], v[192:207]
  s_waitcnt vmcnt(3) lgkmcnt(12)
  ds_read_b64_tr_b16 v[116:117], v10 offset:26624
  ds_read_b64_tr_b16 v[118:119], v10 offset:27648
  v_cmp_eq_u32 vcc, 0, v253
  s_nop 0
  s_cmp_eq_u64 vcc, 0
  s_cselect_b32 s34, s30, 0
  s_mov_b64 s[32:33], s[28:29]
  s_cselect_b32 s56, 1, 0
  v_mfma_f32_32x32x16_bf16 v[192:207], v[120:123], a[152:155], v[192:207]
  s_waitcnt lgkmcnt(12)
  ds_read_b64_tr_b16 v[120:121], v13 offset:0
  ds_read_b64_tr_b16 v[122:123], v13 offset:1024
  buffer_load_dwordx4 a[176:179], v4, s[32:35], s9 offen offset:0 sc1
  buffer_load_dwordx4 a[180:183], v4, s[32:35], s9 offen offset:1024 sc1
  buffer_load_dwordx4 a[184:187], v4, s[32:35], s10 offen offset:0 sc1
  buffer_load_dwordx4 a[188:191], v4, s[32:35], s10 offen offset:1024 sc1
  v_mfma_f32_32x32x16_bf16 v[192:207], v[124:127], a[156:159], v[192:207]
  s_waitcnt lgkmcnt(12)
  ds_read_b64_tr_b16 v[124:125], v13 offset:2048
  ds_read_b64_tr_b16 v[126:127], v13 offset:3072
  buffer_load_dwordx4 a[192:195], v4, s[32:35], s11 offen offset:0 sc1
  v_exp_f32 v128, v80
  v_mul_f32 v82, v82, v29
  v_mfma_f32_32x32x16_bf16 v[192:207], v[96:99], a[160:163], v[192:207]
  s_waitcnt lgkmcnt(12)
  ds_read_b64_tr_b16 v[96:97], v13 offset:4096
  ds_read_b64_tr_b16 v[98:99], v13 offset:5120
  v_exp_f32 v129, v81
  v_fma_f32 v128, v128, s52, s52
  v_mul_f32 v83, v83, v29
  v_mfma_f32_32x32x16_bf16 v[192:207], v[100:103], a[164:167], v[192:207]
  s_waitcnt lgkmcnt(12)
  ds_read_b64_tr_b16 v[100:101], v13 offset:6144
  ds_read_b64_tr_b16 v[102:103], v13 offset:7168
  buffer_load_dword v17, v6, s[36:39], s70 offen sc1
  buffer_load_dwordx4 a[196:199], v4, s[32:35], s11 offen offset:1024 sc1
  v_exp_f32 v130, v82
  v_mfma_f32_32x32x16_bf16 v[192:207], v[104:107], a[168:171], v[192:207]
  s_waitcnt lgkmcnt(12)
  ds_read_b64_tr_b16 v[104:105], v13 offset:8192
  ds_read_b64_tr_b16 v[106:107], v13 offset:9216
  v_fma_f32 v129, v129, s52, s52
  v_fma_f32 v128, v128, v128, 0.5
  v_mul_f32 v84, v84, v29
  v_fma_f32 v130, v130, s52, s52
  v_mfma_f32_32x32x16_bf16 v[192:207], v[108:111], a[172:175], v[192:207]
  s_waitcnt lgkmcnt(12)
  ds_read_b64_tr_b16 v[108:109], v13 offset:10240
  ds_read_b64_tr_b16 v[110:111], v13 offset:11264
  buffer_load_dwordx4 a[200:203], v4, s[32:35], s12 offen offset:0 sc1
  v_exp_f32 v131, v83
  v_fma_f32 v129, v129, v129, 0.5
  v_mfma_f32_32x32x16_bf16 v[192:207], v[112:115], v[176:179], v[192:207]
  s_waitcnt lgkmcnt(12)
  ds_read_b64_tr_b16 v[112:113], v13 offset:12288
  ds_read_b64_tr_b16 v[114:115], v13 offset:13312
  v_rcp_f32 v128, v128
  v_mul_f32 v85, v85, v29
  v_fma_f32 v131, v131, s52, s52
  v_mfma_f32_32x32x16_bf16 v[192:207], v[116:119], v[180:183], v[192:207]
  s_waitcnt lgkmcnt(12)
  ds_read_b64_tr_b16 v[116:117], v13 offset:14336
  ds_read_b64_tr_b16 v[118:119], v13 offset:15360
  buffer_load_dwordx4 a[204:207], v4, s[32:35], s12 offen offset:1024 sc1
  v_exp_f32 v132, v84
  v_fma_f32 v130, v130, v130, 0.5
  v_mfma_f32_32x32x16_bf16 v[208:223], v[120:123], v[160:163], 0
  s_waitcnt lgkmcnt(12)
  ds_read_b64_tr_b16 v[120:121], v10 offset:0
  ds_read_b64_tr_b16 v[122:123], v10 offset:1024
  v_rcp_f32 v129, v129
  v_fma_f32 v80, -v80, v128, v80
  v_mul_f32 v86, v86, v29
  v_mfma_f32_32x32x16_bf16 v[208:223], v[124:127], v[164:167], v[208:223]
  s_waitcnt lgkmcnt(12)
  ds_read_b64_tr_b16 v[124:125], v10 offset:2048
  ds_read_b64_tr_b16 v[126:127], v10 offset:3072
  buffer_load_dwordx4 a[208:211], v4, s[32:35], s13 offen offset:0 sc1
  v_exp_f32 v133, v85
  v_fma_f32 v132, v132, s52, s52
  v_mfma_f32_32x32x16_bf16 v[208:223], v[96:99], v[168:171], v[208:223]
  s_waitcnt lgkmcnt(12)
  ds_read_b64_tr_b16 v[96:97], v10 offset:4096
  ds_read_b64_tr_b16 v[98:99], v10 offset:5120
  v_fma_f32 v131, v131, v131, 0.5
  v_rcp_f32 v130, v130
  v_fma_f32 v81, -v81, v129, v81
  v_mfma_f32_32x32x16_bf16 v[208:223], v[100:103], v[172:175], v[208:223]
  s_waitcnt lgkmcnt(12)
  ds_read_b64_tr_b16 v[100:101], v10 offset:6144
  ds_read_b64_tr_b16 v[102:103], v10 offset:7168
  buffer_load_dwordx4 a[212:215], v4, s[32:35], s13 offen offset:1024 sc1
  v_mul_f32 v87, v87, v29
  v_exp_f32 v134, v86
  v_mfma_f32_32x32x16_bf16 v[208:223], v[104:107], a[128:131], v[208:223]
  s_waitcnt lgkmcnt(12)
  ds_read_b64_tr_b16 v[104:105], v10 offset:8192
  ds_read_b64_tr_b16 v[106:107], v10 offset:9216
  v_fma_f32 v133, v133, s52, s52
  v_fma_f32 v132, v132, v132, 0.5
  v_rcp_f32 v131, v131
  v_mfma_f32_32x32x16_bf16 v[208:223], v[108:111], a[132:135], v[208:223]
  s_waitcnt lgkmcnt(12)
  ds_read_b64_tr_b16 v[108:109], v10 offset:10240
  ds_read_b64_tr_b16 v[110:111], v10 offset:11264
  buffer_load_dwordx4 a[216:219], v4, s[32:35], s14 offen offset:0 sc1
  v_fma_f32 v82, -v82, v130, v82
  v_cvt_pk_bf16_f32 v184, v80, v81
  v_mul_f32 v88, v88, v29
  v_mfma_f32_32x32x16_bf16 v[208:223], v[112:115], a[136:139], v[208:223]
  s_waitcnt vmcnt(6)
  ds_read_b64_tr_b16 v[112:113], v10 offset:12288
  ds_read_b64_tr_b16 v[114:115], v10 offset:13312
  v_cmp_gt_u32 vcc, 0x300, v17
  s_cbranch_vccnz L_spin_29
L_back_30:
  v_exp_f32 v135, v87
  s_waitcnt lgkmcnt(14)
  v_mfma_f32_32x32x16_bf16 v[208:223], v[116:119], a[140:143], v[208:223]
  ds_read_b64_tr_b16 v[116:117], v10 offset:14336
  ds_read_b64_tr_b16 v[118:119], v10 offset:15360
  buffer_load_dwordx4 a[220:223], v4, s[32:35], s14 offen offset:1024 sc1
  buffer_store_dwordx4 v[176:179], v7, s[36:39], s8 offen offset:0
  buffer_store_dwordx4 v[180:183], v7, s[36:39], s8 offen offset:1024
  v_fma_f32 v134, v134, s52, s52
  s_cmp_eq_u32 s56, 0
  s_cbranch_scc1 L_catch_25
L_cback_26:
  s_waitcnt lgkmcnt(14)
  v_mfma_f32_32x32x16_bf16 v[192:207], v[120:123], a[176:179], v[192:207]
  s_waitcnt lgkmcnt(12)
  ds_read_b64_tr_b16 v[120:121], v13 offset:16384
  ds_read_b64_tr_b16 v[122:123], v13 offset:17408
  v_fma_f32 v133, v133, v133, 0.5
  v_rcp_f32 v132, v132
  v_fma_f32 v83, -v83, v131, v83
  v_mfma_f32_32x32x16_bf16 v[192:207], v[124:127], a[180:183], v[192:207]
  s_waitcnt lgkmcnt(12)
  ds_read_b64_tr_b16 v[124:125], v10 offset:16384
  ds_read_b64_tr_b16 v[126:127], v10 offset:17408
  v_mul_f32 v89, v89, v29
  v_exp_f32 v128, v88
  v_fma_f32 v135, v135, s52, s52
  v_mfma_f32_32x32x16_bf16 v[192:207], v[96:99], a[184:187], v[192:207]
  s_waitcnt lgkmcnt(12)
  ds_read_b64_tr_b16 v[96:97], v13 offset:18432
  ds_read_b64_tr_b16 v[98:99], v13 offset:19456
  v_fma_f32 v134, v134, v134, 0.5
  v_rcp_f32 v133, v133
  v_fma_f32 v84, -v84, v132, v84
  v_mfma_f32_32x32x16_bf16 v[192:207], v[100:103], a[188:191], v[192:207]
  s_waitcnt lgkmcnt(12)
  ds_read_b64_tr_b16 v[100:101], v10 offset:18432
  ds_read_b64_tr_b16 v[102:103], v10 offset:19456
  v_cvt_pk_bf16_f32 v185, v82, v83
  v_mul_f32 v90, v90, v29
  v_exp_f32 v129, v89
  v_mfma_f32_32x32x16_bf16 v[192:207], v[104:107], a[192:195], v[192:207]
  s_waitcnt vmcnt(8) lgkmcnt(12)
  ds_read_b64_tr_b16 v[104:105], v13 offset:20480
  ds_read_b64_tr_b16 v[106:107], v13 offset:21504
  v_fma_f32 v128, v128, s52, s52
  v_fma_f32 v135, v135, v135, 0.5
  v_rcp_f32 v134, v134
  v_mfma_f32_32x32x16_bf16 v[192:207], v[108:111], a[196:199], v[192:207]
  s_waitcnt vmcnt(7) lgkmcnt(12)
  ds_read_b64_tr_b16 v[108:109], v10 offset:20480
  ds_read_b64_tr_b16 v[110:111], v10 offset:21504
  v_fma_f32 v85, -v85, v133, v85
  v_mul_f32 v91, v91, v29
  v_exp_f32 v130, v90
  v_mfma_f32_32x32x16_bf16 v[192:207], v[112:115], a[200:203], v[192:207]
  s_waitcnt vmcnt(6) lgkmcnt(12)
  ds_read_b64_tr_b16 v[112:113], v13 offset:22528
  ds_read_b64_tr_b16 v[114:115], v13 offset:23552
  v_fma_f32 v129, v129, s52, s52
  v_fma_f32 v128, v128, v128, 0.5
  v_rcp_f32 v135, v135
  v_mfma_f32_32x32x16_bf16 v[192:207], v[116:119], a[204:207], v[192:207]
  s_waitcnt lgkmcnt(12)
  ds_read_b64_tr_b16 v[116:117], v10 offset:22528
  ds_read_b64_tr_b16 v[118:119], v10 offset:23552
  v_fma_f32 v86, -v86, v134, v86
  v_cvt_pk_bf16_f32 v186, v84, v85
  v_mul_f32 v92, v92, v29
  v_fma_f32 v130, v130, s52, s52
  v_mfma_f32_32x32x16_bf16 v[208:223], v[120:123], a[144:147], v[208:223]
  s_waitcnt vmcnt(5) lgkmcnt(12)
  ds_read_b64_tr_b16 v[120:121], v10 offset:28672
  ds_read_b64_tr_b16 v[122:123], v10 offset:29696
  v_exp_f32 v131, v91
  v_fma_f32 v129, v129, v129, 0.5
  v_fma_f32 v87, -v87, v135, v87
  v_mfma_f32_32x32x16_bf16 v[192:207], v[124:127], a[208:211], v[192:207]
  s_waitcnt vmcnt(0) lgkmcnt(12)
  ds_read_b64_tr_b16 v[124:125], v13 offset:24576
  ds_read_b64_tr_b16 v[126:127], v13 offset:25600
  buffer_store_dword v18, off, s[36:39], s72 offset:256
  v_rcp_f32 v128, v128
  v_mul_f32 v93, v93, v29
  v_mfma_f32_32x32x16_bf16 v[208:223], v[96:99], a[148:151], v[208:223]
  s_waitcnt lgkmcnt(12)
  ds_read_b64_tr_b16 v[96:97], v13 offset:26624
  ds_read_b64_tr_b16 v[98:99], v13 offset:27648
  v_exp_f32 v132, v92
  v_fma_f32 v131, v131, s52, s52
  v_fma_f32 v130, v130, v130, 0.5
  v_mfma_f32_32x32x16_bf16 v[192:207], v[100:103], a[212:215], v[192:207]
  s_waitcnt lgkmcnt(12)
  ds_read_b64_tr_b16 v[100:101], v13 offset:28672
  ds_read_b64_tr_b16 v[102:103], v13 offset:29696
  v_rcp_f32 v129, v129
  v_fma_f32 v88, -v88, v128, v88
  v_cvt_pk_bf16_f32 v187, v86, v87
  v_mfma_f32_32x32x16_bf16 v[208:223], v[104:107], a[152:155], v[208:223]
  s_waitcnt lgkmcnt(12)
  ds_read_b64_tr_b16 v[104:105], v13 offset:30720
  ds_read_b64_tr_b16 v[106:107], v13 offset:31744
  v_mul_f32 v94, v94, v29
  v_exp_f32 v133, v93
  v_fma_f32 v132, v132, s52, s52
  v_mfma_f32_32x32x16_bf16 v[192:207], v[108:111], a[216:219], v[192:207]
  s_waitcnt lgkmcnt(12)
  ds_read_b64_tr_b16 v[108:109], v11 offset:24576
  ds_read_b64_tr_b16 v[110:111], v11 offset:25600
  v_fma_f32 v131, v131, v131, 0.5
  v_rcp_f32 v130, v130
  v_fma_f32 v89, -v89, v129, v89
  v_mfma_f32_32x32x16_bf16 v[208:223], v[112:115], a[156:159], v[208:223]
  s_waitcnt lgkmcnt(12)
  ds_read_b64_tr_b16 v[112:113], v11 offset:26624
  ds_read_b64_tr_b16 v[114:115], v11 offset:27648
  v_mul_f32 v95, v95, v29
  v_exp_f32 v134, v94
  v_fma_f32 v133, v133, s52, s52
  v_mfma_f32_32x32x16_bf16 v[192:207], v[116:119], a[220:223], v[192:207]
  s_waitcnt lgkmcnt(12)
  ds_read_b64_tr_b16 v[116:117], v10 offset:30720
  ds_read_b64_tr_b16 v[118:119], v10 offset:31744
  v_mov_b32 v0, 0x400
  buffer_store_dword v0, off, s[36:39], s72
  v_fma_f32 v132, v132, v132, 0.5
  v_fma_f32 v90, -v90, v130, v90
  v_mfma_f32_32x32x16_bf16 v[192:207], v[120:123], v[184:187], v[192:207]
  s_waitcnt lgkmcnt(12)
  ds_read_b64_tr_b16 v[120:121], v11 offset:0
  ds_read_b64_tr_b16 v[122:123], v11 offset:1024
  v_rcp_f32 v131, v131
  v_cvt_pk_bf16_f32 v188, v88, v89
  v_fma_f32 v134, v134, s52, s52
  v_mfma_f32_32x32x16_bf16 v[208:223], v[124:127], a[160:163], v[208:223]
  s_waitcnt lgkmcnt(12)
  ds_read_b64_tr_b16 v[124:125], v11 offset:2048
  ds_read_b64_tr_b16 v[126:127], v11 offset:3072
  v_exp_f32 v135, v95
  v_fma_f32 v133, v133, v133, 0.5
  v_fma_f32 v91, -v91, v131, v91
  v_mfma_f32_32x32x16_bf16 v[208:223], v[96:99], a[164:167], v[208:223]
  s_waitcnt lgkmcnt(12)
  ds_read_b64_tr_b16 v[96:97], v11 offset:4096
  ds_read_b64_tr_b16 v[98:99], v11 offset:5120
  v_rcp_f32 v132, v132
  v_fma_f32 v135, v135, s52, s52
  v_fma_f32 v134, v134, v134, 0.5
  v_mfma_f32_32x32x16_bf16 v[208:223], v[100:103], a[168:171], v[208:223]
  s_waitcnt lgkmcnt(12)
  ds_read_b64_tr_b16 v[100:101], v11 offset:6144
  ds_read_b64_tr_b16 v[102:103], v11 offset:7168
  buffer_load_dword v254, v9, s[36:39], s70 offen offset:256 sc1
  v_rcp_f32 v133, v133
  v_fma_f32 v92, -v92, v132, v92
  v_mfma_f32_32x32x16_bf16 v[208:223], v[104:107], a[172:175], v[208:223]
  s_waitcnt lgkmcnt(12)
  ds_read_b64_tr_b16 v[104:105], v11 offset:8192
  ds_read_b64_tr_b16 v[106:107], v11 offset:9216
  v_cvt_pk_bf16_f32 v189, v90, v91
  v_fma_f32 v135, v135, v135, 0.5
  v_rcp_f32 v134, v134
  v_mfma_f32_32x32x16_bf16 v[208:223], v[108:111], v[176:179], v[208:223]
  s_waitcnt lgkmcnt(12)
  ds_read_b64_tr_b16 v[108:109], v11 offset:10240
  ds_read_b64_tr_b16 v[110:111], v11 offset:11264
  buffer_load_dword v17, v6, s[36:39], s70 offen sc1
  v_fma_f32 v93, -v93, v133, v93
  v_rcp_f32 v135, v135
  v_mfma_f32_32x32x16_bf16 v[208:223], v[112:115], v[180:183], v[208:223]
  s_waitcnt lgkmcnt(12)
  ds_read_b64_tr_b16 v[112:113], v11 offset:12288
  ds_read_b64_tr_b16 v[114:115], v11 offset:13312
  v_fma_f32 v94, -v94, v134, v94
  v_cvt_pk_bf16_f32 v190, v92, v93
  v_fma_f32 v95, -v95, v135, v95
  v_cvt_pk_bf16_f32 v191, v94, v95
  s_nop 1
  v_mfma_f32_32x32x16_bf16 v[192:207], v[116:119], v[188:191], v[192:207]
  s_waitcnt lgkmcnt(12)
  ds_read_b64_tr_b16 v[116:117], v11 offset:14336
  ds_read_b64_tr_b16 v[118:119], v11 offset:15360
  v_mfma_f32_32x32x16_bf16 v[208:223], v[120:123], a[176:179], v[208:223]
  s_waitcnt lgkmcnt(12)
  ds_read_b64_tr_b16 v[120:121], v11 offset:16384
  ds_read_b64_tr_b16 v[122:123], v11 offset:17408
  v_mfma_f32_32x32x16_bf16 v[208:223], v[124:127], a[180:183], v[208:223]
  s_waitcnt lgkmcnt(12)
  ds_read_b64_tr_b16 v[124:125], v11 offset:18432
  ds_read_b64_tr_b16 v[126:127], v11 offset:19456
  v_mfma_f32_32x32x16_bf16 v[208:223], v[96:99], a[184:187], v[208:223]
  s_waitcnt lgkmcnt(12)
  ds_read_b64_tr_b16 v[96:97], v11 offset:20480
  ds_read_b64_tr_b16 v[98:99], v11 offset:21504
  v_mfma_f32_32x32x16_bf16 v[208:223], v[100:103], a[188:191], v[208:223]
  s_waitcnt lgkmcnt(12)
  ds_read_b64_tr_b16 v[100:101], v11 offset:22528
  ds_read_b64_tr_b16 v[102:103], v11 offset:23552
  v_mfma_f32_32x32x16_bf16 v[208:223], v[104:107], a[192:195], v[208:223]
  s_waitcnt lgkmcnt(12)
  ds_read_b64_tr_b16 v[104:105], v11 offset:28672
  ds_read_b64_tr_b16 v[106:107], v11 offset:29696
  v_mfma_f32_32x32x16_bf16 v[208:223], v[108:111], a[196:199], v[208:223]
  s_waitcnt lgkmcnt(12)
  ds_read_b64_tr_b16 v[108:109], v11 offset:30720
  ds_read_b64_tr_b16 v[110:111], v11 offset:31744
  v_mfma_f32_32x32x16_bf16 v[208:223], v[112:115], a[200:203], v[208:223]
  s_waitcnt vmcnt(1)
  ds_read_b64_tr_b16 v[112:113], v10 offset:32768
  ds_read_b64_tr_b16 v[114:115], v10 offset:33792
  v_cmp_gt_u32 vcc, 0x1, v254
  s_cbranch_vccnz L_spin_32
L_back_33:
  buffer_load_dwordx4 a[0:3], v7, s[36:39], s9 offen offset:0 sc1
  buffer_load_dwordx4 a[4:7], v7, s[36:39], s9 offen offset:1024 sc1
  s_waitcnt lgkmcnt(14)
  v_mfma_f32_32x32x16_bf16 v[208:223], v[116:119], a[204:207], v[208:223]
  s_waitcnt lgkmcnt(12)
  ds_read_b64_tr_b16 v[116:117], v11 offset:32768
  ds_read_b64_tr_b16 v[118:119], v11 offset:33792
  buffer_load_dwordx4 a[8:11], v7, s[36:39], s10 offen offset:0 sc1
  buffer_load_dwordx4 a[12:15], v7, s[36:39], s10 offen offset:1024 sc1
  buffer_load_dwordx4 a[16:19], v7, s[36:39], s11 offen offset:0 sc1
  v_mfma_f32_32x32x16_bf16 v[208:223], v[120:123], a[208:211], v[208:223]
  s_waitcnt vmcnt(5)
  ds_read_b64_tr_b16 v[120:121], v10 offset:34816
  ds_read_b64_tr_b16 v[122:123], v10 offset:35840
  v_cmp_gt_u32 vcc, 0x400, v17
  s_cbranch_vccnz L_spin_35
L_back_36:
  s_waitcnt lgkmcnt(14)
  v_mfma_f32_32x32x16_bf16 v[208:223], v[124:127], a[212:215], v[208:223]
  s_waitcnt lgkmcnt(12)
  ds_read_b64_tr_b16 v[124:125], v11 offset:34816
  ds_read_b64_tr_b16 v[126:127], v11 offset:35840
  buffer_load_dwordx4 a[20:23], v7, s[36:39], s11 offen offset:1024 sc1
  buffer_store_dwordx4 v[184:187], v8, s[28:31], s8 offen offset:0
  buffer_store_dwordx4 v[188:191], v8, s[28:31], s8 offen offset:1024
  v_mfma_f32_32x32x16_bf16 v[208:223], v[96:99], a[216:219], v[208:223]
  s_waitcnt lgkmcnt(12)
  ds_read_b64_tr_b16 v[96:97], v10 offset:36864
  ds_read_b64_tr_b16 v[98:99], v10 offset:37888
  v_mfma_f32_32x32x16_bf16 v[208:223], v[100:103], a[220:223], v[208:223]
  s_waitcnt lgkmcnt(12)
  ds_read_b64_tr_b16 v[100:101], v11 offset:36864
  ds_read_b64_tr_b16 v[102:103], v11 offset:37888
  buffer_load_dwordx4 a[24:27], v7, s[36:39], s12 offen offset:0 sc1
  v_mfma_f32_32x32x16_bf16 v[208:223], v[104:107], v[184:187], v[208:223]
  s_waitcnt lgkmcnt(12)
  ds_read_b64_tr_b16 v[104:105], v10 offset:38912
  ds_read_b64_tr_b16 v[106:107], v10 offset:39936
  v_mfma_f32_32x32x16_bf16 v[208:223], v[108:111], v[188:191], v[208:223]
  s_waitcnt vmcnt(8) lgkmcnt(12)
  ds_read_b64_tr_b16 v[108:109], v11 offset:38912
  ds_read_b64_tr_b16 v[110:111], v11 offset:39936
  buffer_load_dwordx4 a[28:31], v7, s[36:39], s12 offen offset:1024 sc1
  v_mfma_f32_32x32x16_bf16 v[192:207], v[112:115], a[0:3], v[192:207]
  s_waitcnt lgkmcnt(12)
  ds_read_b64_tr_b16 v[112:113], v10 offset:40960
  ds_read_b64_tr_b16 v[114:115], v10 offset:41984
  v_mfma_f32_32x32x16_bf16 v[208:223], v[116:119], a[0:3], v[208:223]
  s_waitcnt vmcnt(8) lgkmcnt(12)
  ds_read_b64_tr_b16 v[116:117], v11 offset:40960
  ds_read_b64_tr_b16 v[118:119], v11 offset:41984
  buffer_load_dwordx4 a[32:35], v7, s[36:39], s13 offen offset:0 sc1
  v_mfma_f32_32x32x16_bf16 v[192:207], v[120:123], a[4:7], v[192:207]
  s_waitcnt lgkmcnt(12)
  ds_read_b64_tr_b16 v[120:121], v10 offset:43008
  ds_read_b64_tr_b16 v[122:123], v10 offset:44032
  v_mfma_f32_32x32x16_bf16 v[208:223], v[124:127], a[4:7], v[208:223]
  s_waitcnt vmcnt(8) lgkmcnt(12)
  ds_read_b64_tr_b16 v[124:125], v11 offset:43008
  ds_read_b64_tr_b16 v[126:127], v11 offset:44032
  buffer_load_dwordx4 a[36:39], v7, s[36:39], s13 offen offset:1024 sc1
  v_mfma_f32_32x32x16_bf16 v[192:207], v[96:99], a[8:11], v[192:207]
  s_waitcnt lgkmcnt(12)
  ds_read_b64_tr_b16 v[96:97], v10 offset:45056
  ds_read_b64_tr_b16 v[98:99], v10 offset:46080
  v_mfma_f32_32x32x16_bf16 v[208:223], v[100:103], a[8:11], v[208:223]
  s_waitcnt vmcnt(4) lgkmcnt(12)
  ds_read_b64_tr_b16 v[100:101], v11 offset:45056
  ds_read_b64_tr_b16 v[102:103], v11 offset:46080
  buffer_load_dwordx4 a[40:43], v7, s[36:39], s14 offen offset:0 sc1
  buffer_store_dword v18, off, s[36:39], s72 offset:320
  v_mfma_f32_32x32x16_bf16 v[192:207], v[104:107], a[12:15], v[192:207]
  s_waitcnt lgkmcnt(12)
  ds_read_b64_tr_b16 v[104:105], v10 offset:47104
  ds_read_b64_tr_b16 v[106:107], v10 offset:48128
  v_mfma_f32_32x32x16_bf16 v[208:223], v[108:111], a[12:15], v[208:223]
  s_waitcnt lgkmcnt(12)
  ds_read_b64_tr_b16 v[108:109], v11 offset:47104
  ds_read_b64_tr_b16 v[110:111], v11 offset:48128
  buffer_load_dwordx4 a[44:47], v7, s[36:39], s14 offen offset:1024 sc1
  v_mfma_f32_32x32x16_bf16 v[192:207], v[112:115], a[16:19], v[192:207]
  s_waitcnt lgkmcnt(12)
  ds_read_b64_tr_b16 v[112:113], v10 offset:49152
  ds_read_b64_tr_b16 v[114:115], v10 offset:50176
  v_mfma_f32_32x32x16_bf16 v[208:223], v[116:119], a[16:19], v[208:223]
  s_waitcnt lgkmcnt(12)
  ds_read_b64_tr_b16 v[116:117], v11 offset:49152
  ds_read_b64_tr_b16 v[118:119], v11 offset:50176
  v_mfma_f32_32x32x16_bf16 v[192:207], v[120:123], a[20:23], v[192:207]
  s_waitcnt lgkmcnt(12)
  ds_read_b64_tr_b16 v[120:121], v10 offset:51200
  ds_read_b64_tr_b16 v[122:123], v10 offset:52224
  v_mfma_f32_32x32x16_bf16 v[208:223], v[124:127], a[20:23], v[208:223]
  s_waitcnt vmcnt(6) lgkmcnt(12)
  ds_read_b64_tr_b16 v[124:125], v11 offset:51200
  ds_read_b64_tr_b16 v[126:127], v11 offset:52224
  v_mfma_f32_32x32x16_bf16 v[192:207], v[96:99], a[24:27], v[192:207]
  s_waitcnt lgkmcnt(12)
  ds_read_b64_tr_b16 v[96:97], v10 offset:53248
  ds_read_b64_tr_b16 v[98:99], v10 offset:54272
  v_mfma_f32_32x32x16_bf16 v[208:223], v[100:103], a[24:27], v[208:223]
  s_waitcnt vmcnt(5) lgkmcnt(12)
  ds_read_b64_tr_b16 v[100:101], v11 offset:53248
  ds_read_b64_tr_b16 v[102:103], v11 offset:54272
  v_mfma_f32_32x32x16_bf16 v[192:207], v[104:107], a[28:31], v[192:207]
  s_waitcnt lgkmcnt(12)
  ds_read_b64_tr_b16 v[104:105], v10 offset:55296
  ds_read_b64_tr_b16 v[106:107], v10 offset:56320
  buffer_load_dword v255, v9, s[36:39], s70 offen offset:320 sc1
  v_mfma_f32_32x32x16_bf16 v[208:223], v[108:111], a[28:31], v[208:223]
  s_waitcnt vmcnt(5) lgkmcnt(12)
  ds_read_b64_tr_b16 v[108:109], v11 offset:55296
  ds_read_b64_tr_b16 v[110:111], v11 offset:56320
  v_mfma_f32_32x32x16_bf16 v[192:207], v[112:115], a[32:35], v[192:207]
  s_waitcnt lgkmcnt(12)
  ds_read_b64_tr_b16 v[112:113], v10 offset:57344
  ds_read_b64_tr_b16 v[114:115], v10 offset:58368
  v_mfma_f32_32x32x16_bf16 v[208:223], v[116:119], a[32:35], v[208:223]
  s_waitcnt vmcnt(4) lgkmcnt(12)
  ds_read_b64_tr_b16 v[116:117], v11 offset:57344
  ds_read_b64_tr_b16 v[118:119], v11 offset:58368
  v_mfma_f32_32x32x16_bf16 v[192:207], v[120:123], a[36:39], v[192:207]
  s_waitcnt lgkmcnt(12)
  ds_read_b64_tr_b16 v[120:121], v10 offset:59392
  ds_read_b64_tr_b16 v[122:123], v10 offset:60416
  v_mfma_f32_32x32x16_bf16 v[208:223], v[124:127], a[36:39], v[208:223]
  s_waitcnt vmcnt(3) lgkmcnt(12)
  ds_read_b64_tr_b16 v[124:125], v11 offset:59392
  ds_read_b64_tr_b16 v[126:127], v11 offset:60416
  v_mfma_f32_32x32x16_bf16 v[192:207], v[96:99], a[40:43], v[192:207]
  s_waitcnt lgkmcnt(12)
  ds_read_b64_tr_b16 v[96:97], v10 offset:61440
  ds_read_b64_tr_b16 v[98:99], v10 offset:62464
  v_mfma_f32_32x32x16_bf16 v[208:223], v[100:103], a[40:43], v[208:223]
  s_waitcnt vmcnt(1) lgkmcnt(12)
  ds_read_b64_tr_b16 v[100:101], v11 offset:61440
  ds_read_b64_tr_b16 v[102:103], v11 offset:62464
  v_mfma_f32_32x32x16_bf16 v[192:207], v[104:107], a[44:47], v[192:207]
  s_waitcnt lgkmcnt(12)
  ds_read_b64_tr_b16 v[104:105], v10 offset:63488
  ds_read_b64_tr_b16 v[106:107], v10 offset:64512
  v_mov_b32 v0, 0x500
  buffer_store_dword v0, off, s[36:39], s72
  v_mfma_f32_32x32x16_bf16 v[208:223], v[108:111], a[44:47], v[208:223]
  s_waitcnt vmcnt(1)
  ds_read_b64_tr_b16 v[108:109], v11 offset:63488
  ds_read_b64_tr_b16 v[110:111], v11 offset:64512
  v_cmp_gt_u32 vcc, 0x1, v255
  s_cbranch_vccnz L_spin_38
L_back_39:
  buffer_load_dwordx4 a[48:51], v8, s[28:31], s9 offen offset:0 sc1
  buffer_load_dwordx4 a[52:55], v8, s[28:31], s9 offen offset:1024 sc1
  buffer_load_dwordx4 a[56:59], v8, s[28:31], s10 offen offset:0 sc1
  buffer_load_dwordx4 a[60:63], v8, s[28:31], s10 offen offset:1024 sc1
  buffer_load_dwordx4 a[64:67], v8, s[28:31], s11 offen offset:0 sc1
  buffer_load_dwordx4 a[68:71], v8, s[28:31], s11 offen offset:1024 sc1
  buffer_load_dwordx4 a[72:75], v8, s[28:31], s12 offen offset:0 sc1
  buffer_load_dwordx4 a[76:79], v8, s[28:31], s12 offen offset:1024 sc1
  s_waitcnt vmcnt(7) lgkmcnt(14)
  v_mfma_f32_32x32x16_bf16 v[192:207], v[112:115], a[48:51], v[192:207]
  s_barrier
  ds_read_b64_tr_b16 v[112:113], v14 offset:0
  ds_read_b64_tr_b16 v[114:115], v14 offset:1024
  s_waitcnt lgkmcnt(14)
  v_mfma_f32_32x32x16_bf16 v[208:223], v[116:119], a[48:51], v[208:223]
  s_waitcnt vmcnt(6) lgkmcnt(12)
  ds_read_b64_tr_b16 v[116:117], v15 offset:0
  ds_read_b64_tr_b16 v[118:119], v15 offset:1024
  buffer_load_dwordx4 a[80:83], v8, s[28:31], s13 offen offset:0 sc1
  v_mfma_f32_32x32x16_bf16 v[192:207], v[120:123], a[52:55], v[192:207]
  s_waitcnt lgkmcnt(12)
  ds_read_b64_tr_b16 v[120:121], v14 offset:2048
  ds_read_b64_tr_b16 v[122:123], v14 offset:3072
  v_mfma_f32_32x32x16_bf16 v[208:223], v[124:127], a[52:55], v[208:223]
  s_waitcnt vmcnt(6) lgkmcnt(12)
  ds_read_b64_tr_b16 v[124:125], v15 offset:2048
  ds_read_b64_tr_b16 v[126:127], v15 offset:3072
  buffer_load_dwordx4 a[84:87], v8, s[28:31], s13 offen offset:1024 sc1
  v_mfma_f32_32x32x16_bf16 v[192:207], v[96:99], a[56:59], v[192:207]
  s_waitcnt lgkmcnt(12)
  ds_read_b64_tr_b16 v[96:97], v14 offset:4096
  ds_read_b64_tr_b16 v[98:99], v14 offset:5120
  v_mfma_f32_32x32x16_bf16 v[208:223], v[100:103], a[56:59], v[208:223]
  s_waitcnt vmcnt(6) lgkmcnt(12)
  ds_read_b64_tr_b16 v[100:101], v15 offset:4096
  ds_read_b64_tr_b16 v[102:103], v15 offset:5120
  buffer_load_dword v17, v6, s[36:39], s70 offen sc1
  buffer_load_dwordx4 a[88:91], v8, s[28:31], s14 offen offset:0 sc1
  v_mfma_f32_32x32x16_bf16 v[192:207], v[104:107], a[60:63], v[192:207]
  s_waitcnt lgkmcnt(12)
  ds_read_b64_tr_b16 v[104:105], v14 offset:6144
  ds_read_b64_tr_b16 v[106:107], v14 offset:7168
  v_mfma_f32_32x32x16_bf16 v[208:223], v[108:111], a[60:63], v[208:223]
  s_waitcnt vmcnt(7) lgkmcnt(12)
  ds_read_b64_tr_b16 v[108:109], v15 offset:6144
  ds_read_b64_tr_b16 v[110:111], v15 offset:7168
  buffer_load_dwordx4 a[92:95], v8, s[28:31], s14 offen offset:1024 sc1
  v_mfma_f32_32x32x16_bf16 v[192:207], v[112:115], a[64:67], v[192:207]
  s_waitcnt lgkmcnt(12)
  ds_read_b64_tr_b16 v[112:113], v14 offset:8192
  ds_read_b64_tr_b16 v[114:115], v14 offset:9216
  v_mfma_f32_32x32x16_bf16 v[208:223], v[116:119], a[64:67], v[208:223]
  s_waitcnt vmcnt(7) lgkmcnt(12)
  ds_read_b64_tr_b16 v[116:117], v15 offset:8192
  ds_read_b64_tr_b16 v[118:119], v15 offset:9216
  v_mfma_f32_32x32x16_bf16 v[192:207], v[120:123], a[68:71], v[192:207]
  s_waitcnt lgkmcnt(12)
  ds_read_b64_tr_b16 v[120:121], v14 offset:10240
  ds_read_b64_tr_b16 v[122:123], v14 offset:11264
  v_mfma_f32_32x32x16_bf16 v[208:223], v[124:127], a[68:71], v[208:223]
  s_waitcnt vmcnt(6) lgkmcnt(12)
  ds_read_b64_tr_b16 v[124:125], v15 offset:10240
  ds_read_b64_tr_b16 v[126:127], v15 offset:11264
  v_mfma_f32_32x32x16_bf16 v[192:207], v[96:99], a[72:75], v[192:207]
  s_waitcnt lgkmcnt(12)
  ds_read_b64_tr_b16 v[96:97], v14 offset:12288
  ds_read_b64_tr_b16 v[98:99], v14 offset:13312
  v_mfma_f32_32x32x16_bf16 v[208:223], v[100:103], a[72:75], v[208:223]
  s_waitcnt vmcnt(5) lgkmcnt(12)
  ds_read_b64_tr_b16 v[100:101], v15 offset:12288
  ds_read_b64_tr_b16 v[102:103], v15 offset:13312
  v_mfma_f32_32x32x16_bf16 v[192:207], v[104:107], a[76:79], v[192:207]
  s_waitcnt lgkmcnt(12)
  ds_read_b64_tr_b16 v[104:105], v14 offset:14336
  ds_read_b64_tr_b16 v[106:107], v14 offset:15360
  v_mfma_f32_32x32x16_bf16 v[208:223], v[108:111], a[76:79], v[208:223]
  s_waitcnt vmcnt(2)
  ds_read_b64_tr_b16 v[108:109], v15 offset:14336
  ds_read_b64_tr_b16 v[110:111], v15 offset:15360
  v_cmp_gt_u32 vcc, 0x500, v17
  s_cbranch_vccnz L_spin_41
L_back_42:
  s_waitcnt lgkmcnt(14)
  v_mfma_f32_32x32x16_bf16 v[192:207], v[112:115], a[80:83], v[192:207]
  s_waitcnt lgkmcnt(12)
  v_mfma_f32_32x32x16_bf16 v[208:223], v[116:119], a[80:83], v[208:223]
  s_waitcnt lgkmcnt(10)
  v_mfma_f32_32x32x16_bf16 v[192:207], v[120:123], a[84:87], v[192:207]
  s_waitcnt lgkmcnt(8)
  v_mfma_f32_32x32x16_bf16 v[208:223], v[124:127], a[84:87], v[208:223]
  s_waitcnt vmcnt(1) lgkmcnt(6)
  v_mfma_f32_32x32x16_bf16 v[192:207], v[96:99], a[88:91], v[192:207]
  s_waitcnt lgkmcnt(4)
  v_mfma_f32_32x32x16_bf16 v[208:223], v[100:103], a[88:91], v[208:223]
  s_waitcnt vmcnt(0) lgkmcnt(2)
  v_mfma_f32_32x32x16_bf16 v[192:207], v[104:107], a[92:95], v[192:207]
  s_waitcnt lgkmcnt(0)
  v_mov_b32 v0, 0x600
  buffer_store_dword v0, off, s[36:39], s72
  v_mfma_f32_32x32x16_bf16 v[208:223], v[108:111], a[92:95], v[208:223]
  s_nop 7
  v_cvt_pk_bf16_f32 v128, v192, v193
  v_cvt_pk_bf16_f32 v129, v194, v195
  v_or_b32 v128, 1, v128
  v_cvt_pk_bf16_f32 v130, v196, v197
  v_cvt_pk_bf16_f32 v131, v198, v199
  v_cvt_pk_bf16_f32 v132, v200, v201
  v_cvt_pk_bf16_f32 v133, v202, v203
  v_or_b32 v132, 1, v132
  v_cvt_pk_bf16_f32 v134, v204, v205
  v_cvt_pk_bf16_f32 v135, v206, v207
  v_pk_fma_f32 v[224:225], v[208:209], s[24:25], v[224:225]
  v_pk_fma_f32 v[226:227], v[210:211], s[24:25], v[226:227]
  v_pk_fma_f32 v[228:229], v[212:213], s[24:25], v[228:229]
  v_pk_fma_f32 v[230:231], v[214:215], s[24:25], v[230:231]
  v_pk_fma_f32 v[232:233], v[216:217], s[24:25], v[232:233]
  v_pk_fma_f32 v[234:235], v[218:219], s[24:25], v[234:235]
  buffer_store_dwordx4 v[128:131], v21, s[36:39], s74 offen offset:0
  buffer_store_dwordx4 v[132:135], v21, s[36:39], s74 offen offset:1024
  buffer_load_dwordx4 v[244:247], v21, s[36:39], s75 offen offset:0 sc1
  buffer_load_dwordx4 v[248:251], v21, s[36:39], s75 offen offset:1024 sc1
  buffer_load_dword v252, v6, s[36:39], s70 offen sc1
  v_pk_fma_f32 v[236:237], v[220:221], s[24:25], v[236:237]
  v_pk_fma_f32 v[238:239], v[222:223], s[24:25], v[238:239]
  s_lshl_b32 s57, s64, 15
  s_lshl_b32 s58, s99, 6
  s_add_u32 s57, s57, s58
  s_add_u32 s58, s57, 0x4000
  v_and_b32 v253, 31, v1
  v_lshrrev_b32 v254, 2, v253
  v_lshrrev_b32 v255, 5, v1
  v_xor_b32 v254, v254, v255
  v_and_b32 v254, 3, v254
  v_lshlrev_b32 v254, 4, v254
  v_lshl_add_u32 v253, v253, 6, v254
  v_add_u32 v253, s63, v253
  v_xor_b32 v254, 32, v253
  v_add_u32 v255, s63, v2
  v_lshrrev_b32 v0, 4, v1
  v_xor_b32 v0, v0, v1
  v_and_b32 v0, 3, v0
  v_lshlrev_b32 v0, 4, v0
  v_lshrrev_b32 v19, 2, v1
  v_lshl_add_u32 v19, v19, 10, v0
  s_waitcnt vmcnt(1)
  v_and_b32 v0, v244, v248
  v_lshlrev_b32 v0, 31, v0
  s_waitcnt vmcnt(0)
  v_min_u32 v0, v0, v252
  v_cmp_gt_u32 vcc, 0x600, v0
  s_cbranch_vccnz L_xspin_44
L_xback_45:
  v_lshlrev_b32 v128, 16, v244
  v_and_b32 v129, 0xffff0000, v244
  v_lshlrev_b32 v130, 16, v245
  v_and_b32 v131, 0xffff0000, v245
  v_lshlrev_b32 v132, 16, v246
  v_and_b32 v133, 0xffff0000, v246
  v_lshlrev_b32 v134, 16, v247
  v_and_b32 v135, 0xffff0000, v247
  v_pk_fma_f32 v[224:225], v[128:129], s[24:25], v[224:225]
  v_pk_fma_f32 v[226:227], v[130:131], s[24:25], v[226:227]
  v_pk_fma_f32 v[228:229], v[132:133], s[24:25], v[228:229]
  v_pk_fma_f32 v[230:231], v[134:135], s[24:25], v[230:231]
  v_cvt_pk_bf16_f32 v244, v224, v225
  v_cvt_pk_bf16_f32 v245, v226, v227
  v_cvt_pk_bf16_f32 v246, v228, v229
  v_cvt_pk_bf16_f32 v247, v230, v231
  s_nop 0
  v_permlane32_swap_b32 v244, v246
  v_permlane32_swap_b32 v245, v247
  ds_write_b128 v253, v[244:247] offset:16384
  v_lshlrev_b32 v136, 16, v248
  v_and_b32 v137, 0xffff0000, v248
  v_lshlrev_b32 v138, 16, v249
  v_and_b32 v139, 0xffff0000, v249
  v_lshlrev_b32 v140, 16, v250
  v_and_b32 v141, 0xffff0000, v250
  v_lshlrev_b32 v142, 16, v251
  v_and_b32 v143, 0xffff0000, v251
  v_pk_fma_f32 v[232:233], v[136:137], s[24:25], v[232:233]
  v_pk_fma_f32 v[234:235], v[138:139], s[24:25], v[234:235]
  v_pk_fma_f32 v[236:237], v[140:141], s[24:25], v[236:237]
  v_pk_fma_f32 v[238:239], v[142:143], s[24:25], v[238:239]
  v_cvt_pk_bf16_f32 v248, v232, v233
  v_cvt_pk_bf16_f32 v249, v234, v235
  v_cvt_pk_bf16_f32 v250, v236, v237
  v_cvt_pk_bf16_f32 v251, v238, v239
  s_nop 0
  v_permlane32_swap_b32 v248, v250
  v_permlane32_swap_b32 v249, v251
  ds_write_b128 v254, v[248:251] offset:16384
  ds_read_b128 v[244:247], v255 offset:16384
  ds_read_b128 v[248:251], v255 offset:17408
  s_waitcnt lgkmcnt(1)
  buffer_store_dwordx4 v[244:247], v19, s[28:31], s57 offen
  s_waitcnt lgkmcnt(0)
  buffer_store_dwordx4 v[248:251], v19, s[28:31], s58 offen
  s_endpgm
L_idle:
  s_waitcnt vmcnt(0) lgkmcnt(0)
  s_barrier
  s_and_b32 s57, s2, 31
  s_lshl_b32 s57, s57, 1
  s_and_b32 s58, s3, 1
  s_add_u32 s57, s57, s58
  s_lshl_b32 s59, s57, 6
  v_and_b32 v30, 31, v1
  v_lshlrev_b32 v30, 1, v30
  buffer_load_ushort v31, v30, s[40:43], s59 offen
  s_lshl_b32 s58, s58, 6
  s_lshr_b32 s59, s3, 1
  s_lshl_b32 s60, s59, 15
  v_xor_b32 v240, s58, v10
  v_add_u32 v240, s60, v240
  s_lshl_b32 s57, s57, 9
  s_lshl_b32 s58, s59, 3
  s_add_u32 s57, s57, s58
  s_add_u32 s60, s57, 98304
  s_sub_u32 s59, s59, 1
  v_mov_b32 v22, 0
  v_mov_b32 v23, 0
  ds_read_b64_tr_b16 v[160:161], v240 offset:0
  ds_read_b64_tr_b16 v[162:163], v240 offset:1024
  ds_read_b64_tr_b16 v[164:165], v240 offset:2048
  ds_read_b64_tr_b16 v[166:167], v240 offset:3072
  ds_read_b64_tr_b16 v[168:169], v240 offset:4096
  ds_read_b64_tr_b16 v[170:171], v240 offset:5120
  ds_read_b64_tr_b16 v[172:173], v240 offset:6144
  ds_read_b64_tr_b16 v[174:175], v240 offset:7168
  ds_read_b64_tr_b16 v[176:177], v240 offset:8192
  ds_read_b64_tr_b16 v[178:179], v240 offset:9216
  ds_read_b64_tr_b16 v[180:181], v240 offset:10240
  ds_read_b64_tr_b16 v[182:183], v240 offset:11264
  ds_read_b64_tr_b16 v[184:185], v240 offset:12288
  ds_read_b64_tr_b16 v[186:187], v240 offset:13312
  ds_read_b64_tr_b16 v[188:189], v240 offset:14336
  ds_read_b64_tr_b16 v[190:191], v240 offset:15360
  ds_read_b64_tr_b16 v[192:193], v240 offset:16384
  ds_read_b64_tr_b16 v[194:195], v240 offset:17408
  ds_read_b64_tr_b16 v[196:197], v240 offset:18432
  ds_read_b64_tr_b16 v[198:199], v240 offset:19456
  ds_read_b64_tr_b16 v[200:201], v240 offset:20480
  ds_read_b64_tr_b16 v[202:203], v240 offset:21504
  ds_read_b64_tr_b16 v[204:205], v240 offset:22528
  ds_read_b64_tr_b16 v[206:207], v240 offset:23552
  ds_read_b64_tr_b16 v[208:209], v240 offset:24576
  ds_read_b64_tr_b16 v[210:211], v240 offset:25600
  ds_read_b64_tr_b16 v[212:213], v240 offset:26624
  ds_read_b64_tr_b16 v[214:215], v240 offset:27648
  ds_read_b64_tr_b16 v[216:217], v240 offset:28672
  ds_read_b64_tr_b16 v[218:219], v240 offset:29696
  ds_read_b64_tr_b16 v[220:221], v240 offset:30720
  ds_read_b64_tr_b16 v[222:223], v240 offset:31744
  s_waitcnt lgkmcnt(14)
  v_dot2c_f32_bf16 v23, s44, v160
  v_dot2c_f32_bf16 v22, s44, v161
  v_dot2c_f32_bf16 v23, s44, v162
  v_dot2c_f32_bf16 v22, s44, v163
  v_dot2c_f32_bf16 v23, s44, v164
  v_dot2c_f32_bf16 v22, s44, v165
  v_dot2c_f32_bf16 v23, s44, v166
  v_dot2c_f32_bf16 v22, s44, v167
  v_dot2c_f32_bf16 v23, s44, v168
  v_dot2c_f32_bf16 v22, s44, v169
  v_dot2c_f32_bf16 v23, s44, v170
  v_dot2c_f32_bf16 v22, s44, v171
  v_dot2c_f32_bf16 v23, s44, v172
  v_dot2c_f32_bf16 v22, s44, v173
  v_dot2c_f32_bf16 v23, s44, v174
  v_dot2c_f32_bf16 v22, s44, v175
  v_dot2c_f32_bf16 v23, s44, v176
  v_dot2c_f32_bf16 v22, s44, v177
  v_dot2c_f32_bf16 v23, s44, v178
  v_dot2c_f32_bf16 v22, s44, v179
  v_dot2c_f32_bf16 v23, s44, v180
  v_dot2c_f32_bf16 v22, s44, v181
  v_dot2c_f32_bf16 v23, s44, v182
  v_dot2c_f32_bf16 v22, s44, v183
  v_dot2c_f32_bf16 v23, s44, v184
  v_dot2c_f32_bf16 v22, s44, v185
  v_dot2c_f32_bf16 v23, s44, v186
  v_dot2c_f32_bf16 v22, s44, v187
  v_dot2c_f32_bf16 v23, s44, v188
  v_dot2c_f32_bf16 v22, s44, v189
  v_dot2c_f32_bf16 v23, s44, v190
  v_dot2c_f32_bf16 v22, s44, v191
  v_dot2c_f32_bf16 v23, s44, v192
  v_dot2c_f32_bf16 v22, s44, v193
  v_dot2c_f32_bf16 v23, s44, v194
  v_dot2c_f32_bf16 v22, s44, v195
  s_waitcnt lgkmcnt(13)
  v_dot2c_f32_bf16 v23, s44, v196
  v_dot2c_f32_bf16 v22, s44, v197
  s_waitcnt lgkmcnt(12)
  v_dot2c_f32_bf16 v23, s44, v198
  v_dot2c_f32_bf16 v22, s44, v199
  s_waitcnt lgkmcnt(11)
  v_dot2c_f32_bf16 v23, s44, v200
  v_dot2c_f32_bf16 v22, s44, v201
  s_waitcnt lgkmcnt(10)
  v_dot2c_f32_bf16 v23, s44, v202
  v_dot2c_f32_bf16 v22, s44, v203
  s_waitcnt lgkmcnt(9)
  v_dot2c_f32_bf16 v23, s44, v204
  v_dot2c_f32_bf16 v22, s44, v205
  s_waitcnt lgkmcnt(8)
  v_dot2c_f32_bf16 v23, s44, v206
  v_dot2c_f32_bf16 v22, s44, v207
  s_waitcnt lgkmcnt(7)
  v_dot2c_f32_bf16 v23, s44, v208
  v_dot2c_f32_bf16 v22, s44, v209
  s_waitcnt lgkmcnt(6)
  v_dot2c_f32_bf16 v23, s44, v210
  v_dot2c_f32_bf16 v22, s44, v211
  s_waitcnt lgkmcnt(5)
  v_dot2c_f32_bf16 v23, s44, v212
  v_dot2c_f32_bf16 v22, s44, v213
  s_waitcnt lgkmcnt(4)
  v_dot2c_f32_bf16 v23, s44, v214
  v_dot2c_f32_bf16 v22, s44, v215
  s_waitcnt lgkmcnt(3)
  v_dot2c_f32_bf16 v23, s44, v216
  v_dot2c_f32_bf16 v22, s44, v217
  s_waitcnt lgkmcnt(2)
  v_dot2c_f32_bf16 v23, s44, v218
  v_dot2c_f32_bf16 v22, s44, v219
  s_waitcnt lgkmcnt(1)
  v_dot2c_f32_bf16 v23, s44, v220
  v_dot2c_f32_bf16 v22, s44, v221
  s_waitcnt lgkmcnt(0)
  v_dot2c_f32_bf16 v23, s44, v222
  v_dot2c_f32_bf16 v22, s44, v223
  s_barrier
  s_nop 1
  v_add_f32 v22, v22, v23
  s_waitcnt vmcnt(0)
  v_and_b32 v31, s59, v31
  v_mov_b32 v23, v22
  v_or_b32 v129, 0x3f800000, v31
  s_nop 0
  v_permlane32_swap_b32 v22, v23
  v_add_f32 v22, v22, v23
  v_cvt_pk_bf16_f32 v30, v22, v22
  v_lshlrev_b32 v30, 16, v30
  v_sub_f32 v30, v22, v30
  v_cvt_pk_bf16_f32 v128, v22, v30
  s_mov_b64 exec, 0xffffffff
  buffer_store_dwordx2 v[128:129], v2, s[36:39], s60 offen sc1
  s_mov_b64 exec, -1
  v_add_u32 v12, 0x20000, v14
  v_add_u32 v13, 0x20000, v15
  v_add_u32 v16, 0x18000, v2
  v_min_u32 v9, 6, v1
  s_mul_i32 s57, s71, 28
  v_lshl_add_u32 v9, v9, 2, s57
  v_and_b32 v20, 0x1f0, v2
  v_lshrrev_b32 v30, 5, v1
  v_lshlrev_b32 v30, 4, v30
  v_lshl_add_u32 v19, v20, 6, v30
  s_lshl_b32 s57, s5, 11
  s_add_u32 s74, s57, 1048576
  s_mul_i32 s57, s71, -28672
  s_add_u32 s57, s57, s74
  s_add_u32 s57, s57, 14336
  s_xor_b32 s75, s74, 0x800
  s_cmp_lt_u32 s5, 14
  s_cselect_b32 s75, s57, s75
  s_mov_b32 s52, 0x3f3504f3
  s_mov_b32 s53, 0x3f3504f3
  s_mov_b64 s[32:33], s[36:37]
  v_add_u32 v3, 0x100000, v21
  v_add_u32 v4, 0x0, v21
  v_add_u32 v7, 0x100000, v21
  v_add_u32 v8, 0x0, v21
  s_bfe_u32 s8, s94, 0x40000
  s_lshl_b32 s8, s8, 11
  s_bfe_u32 s9, s94, 0x40004
  s_lshl_b32 s9, s9, 11
  s_bfe_u32 s10, s94, 0x40008
  s_lshl_b32 s10, s10, 11
  s_bfe_u32 s11, s94, 0x4000c
  s_lshl_b32 s11, s11, 11
  s_bfe_u32 s12, s94, 0x40010
  s_lshl_b32 s12, s12, 11
  s_bfe_u32 s13, s94, 0x40014
  s_lshl_b32 s13, s13, 11
  s_bfe_u32 s14, s94, 0x40018
  s_lshl_b32 s14, s14, 11
  buffer_load_dword v17, v6, s[36:39], s70 offen offset:64 sc1
  s_add_u32 m0, s63, 131072
  s_add_u32 s27, s95, 7168
  buffer_load_dwordx4 v5, s[16:19], s95 offen lds
  buffer_load_dwordx4 v5, s[16:19], s27 offen offset:1024 lds
  s_add_u32 m0, s63, 139264
  s_add_u32 s27, s96, 7168
  buffer_load_dwordx4 v5, s[16:19], s96 offen lds
  buffer_load_dwordx4 v5, s[16:19], s27 offen offset:1024 lds
  s_add_u32 m0, s63, 147456
  s_add_u32 s27, s97, 7168
  buffer_load_dwordx4 v5, s[16:19], s97 offen lds
  buffer_load_dwordx4 v5, s[16:19], s27 offen offset:1024 lds
  s_add_u32 m0, s63, 155648
  s_add_u32 s27, s98, 7168
  buffer_load_dwordx4 v5, s[16:19], s98 offen lds
  buffer_load_dwordx4 v5, s[16:19], s27 offen offset:1024 lds
  s_waitcnt vmcnt(8)
  v_cmp_gt_u32 vcc, 0x1, v17
  s_cbranch_vccnz L_spin_47
L_back_48:
  s_lshl_b32 s58, s99, 11
  s_add_u32 s58, s58, 0
  buffer_load_dwordx4 v[244:247], v21, s[28:31], s58 offen offset:0 sc1
  buffer_load_dwordx4 v[248:251], v21, s[28:31], s58 offen offset:1024 sc1
  v_mov_b32 v132, 0
  v_mov_b32 v133, 0
  v_mov_b32 v134, 0
  v_mov_b32 v135, 0
  buffer_store_dwordx4 v[132:135], v21, s[36:39], s74 offen offset:0
  buffer_store_dwordx4 v[132:135], v21, s[36:39], s74 offen offset:1024
  s_add_u32 m0, s63, 32768
  s_add_u32 s26, s96, 32768
  s_add_u32 s27, s96, 39936
  buffer_load_dwordx4 v5, s[16:19], s26 offen lds
  buffer_load_dwordx4 v5, s[16:19], s27 offen offset:1024 lds
  s_add_u32 m0, s63, 40960
  s_add_u32 s26, s97, 32768
  s_add_u32 s27, s97, 39936
  buffer_load_dwordx4 v5, s[16:19], s26 offen lds
  buffer_load_dwordx4 v5, s[16:19], s27 offen offset:1024 lds
  s_add_u32 m0, s63, 49152
  s_add_u32 s26, s98, 32768
  s_add_u32 s27, s98, 39936
  buffer_load_dwordx4 v5, s[16:19], s26 offen lds
  buffer_load_dwordx4 v5, s[16:19], s27 offen offset:1024 lds
  s_add_u32 m0, s63, 57344
  s_add_u32 s26, s95, 65536
  s_add_u32 s27, s95, 72704
  buffer_load_dwordx4 v5, s[16:19], s26 offen lds
  buffer_load_dwordx4 v5, s[16:19], s27 offen offset:1024 lds
  s_waitcnt vmcnt(8)
  buffer_store_dword v18, off, s[36:39], s72 offset:128
  v_mov_b32 v0, 0x200
  buffer_store_dword v0, off, s[36:39], s72
  v_lshlrev_b32 v224, 16, v244
  v_and_b32 v225, 0xffff0000, v244
  v_lshlrev_b32 v226, 16, v245
  v_and_b32 v227, 0xffff0000, v245
  v_lshlrev_b32 v228, 16, v246
  v_and_b32 v229, 0xffff0000, v246
  v_lshlrev_b32 v230, 16, v247
  v_and_b32 v231, 0xffff0000, v247
  v_lshlrev_b32 v232, 16, v248
  v_and_b32 v233, 0xffff0000, v248
  v_lshlrev_b32 v234, 16, v249
  v_and_b32 v235, 0xffff0000, v249
  v_lshlrev_b32 v236, 16, v250
  v_and_b32 v237, 0xffff0000, v250
  v_lshlrev_b32 v238, 16, v251
  v_and_b32 v239, 0xffff0000, v251
  s_add_u32 m0, s63, 65536
  s_add_u32 s26, s96, 65536
  s_add_u32 s27, s96, 72704
  buffer_load_dwordx4 v5, s[16:19], s26 offen lds
  buffer_load_dwordx4 v5, s[16:19], s27 offen offset:1024 lds
  s_add_u32 m0, s63, 73728
  s_add_u32 s26, s97, 65536
  s_add_u32 s27, s97, 72704
  buffer_load_dwordx4 v5, s[16:19], s26 offen lds
  buffer_load_dwordx4 v5, s[16:19], s27 offen offset:1024 lds
  s_add_u32 m0, s63, 81920
  s_add_u32 s26, s98, 65536
  s_add_u32 s27, s98, 72704
  buffer_load_dwordx4 v5, s[16:19], s26 offen lds
  buffer_load_dwordx4 v5, s[16:19], s27 offen offset:1024 lds
  s_add_u32 m0, s63, 90112
  s_add_u32 s26, s96, 98304
  s_add_u32 s27, s96, 105472
  buffer_load_dwordx4 v5, s[16:19], s26 offen lds
  buffer_load_dwordx4 v5, s[16:19], s27 offen offset:1024 lds
  s_add_u32 m0, s63, 0
  s_add_u32 s26, s97, 98304
  s_add_u32 s27, s97, 105472
  buffer_load_dwordx4 v5, s[16:19], s26 offen lds
  buffer_load_dwordx4 v5, s[16:19], s27 offen offset:1024 lds
  s_add_u32 m0, s63, 8192
  s_add_u32 s26, s98, 98304
  s_add_u32 s27, s98, 105472
  buffer_load_dwordx4 v5, s[16:19], s26 offen lds
  buffer_load_dwordx4 v5, s[16:19], s27 offen offset:1024 lds
  s_waitcnt vmcnt(0)
  s_barrier
  ds_read_b64_tr_b16 v[96:97], v12 offset:0
  ds_read_b64_tr_b16 v[98:99], v12 offset:1024
  ds_read_b64_tr_b16 v[100:101], v13 offset:0
  ds_read_b64_tr_b16 v[102:103], v13 offset:1024
  ds_read_b64_tr_b16 v[104:105], v12 offset:2048
  ds_read_b64_tr_b16 v[106:107], v12 offset:3072
  ds_read_b64_tr_b16 v[108:109], v13 offset:2048
  ds_read_b64_tr_b16 v[110:111], v13 offset:3072
  ds_read_b64_tr_b16 v[112:113], v12 offset:8192
  ds_read_b64_tr_b16 v[114:115], v12 offset:9216
  ds_read_b64_tr_b16 v[116:117], v13 offset:8192
  ds_read_b64_tr_b16 v[118:119], v13 offset:9216
  ds_read_b64_tr_b16 v[120:121], v12 offset:10240
  ds_read_b64_tr_b16 v[122:123], v12 offset:11264
  ds_read_b64_tr_b16 v[124:125], v13 offset:10240
  ds_read_b64_tr_b16 v[126:127], v13 offset:11264
  buffer_load_dword v252, v6, s[36:39], s70 offen offset:128 sc1
  s_lshl_b32 s60, s99, 2
  s_add_u32 s60, s60, s70
  s_xor_b32 s59, s60, 4
  s_waitcnt vmcnt(0)
  v_cmp_gt_u32 vcc, 0x1, v252
  s_cbranch_vccnz L_spin_50
L_back_51:
  buffer_load_dwordx4 v[160:163], v3, s[36:39], s8 offen offset:0 sc1
  buffer_load_dwordx4 v[164:167], v3, s[36:39], s8 offen offset:1024 sc1
  buffer_load_dwordx4 a[128:131], v3, s[36:39], s9 offen offset:0 sc1
  buffer_load_dwordx4 a[132:135], v3, s[36:39], s9 offen offset:1024 sc1
  buffer_load_dwordx4 a[136:139], v3, s[36:39], s10 offen offset:0 sc1
  buffer_load_dwordx4 a[140:143], v3, s[36:39], s10 offen offset:1024 sc1
  buffer_load_dwordx4 a[144:147], v3, s[36:39], s11 offen offset:0 sc1
  buffer_load_dwordx4 a[148:151], v3, s[36:39], s11 offen offset:1024 sc1
  s_waitcnt vmcnt(7) lgkmcnt(14)
  v_mfma_f32_32x32x16_bf16 v[192:207], v[96:99], v[160:163], 0
  s_waitcnt lgkmcnt(12)
  ds_read_b64_tr_b16 v[96:97], v12 offset:12288
  ds_read_b64_tr_b16 v[98:99], v12 offset:13312
  v_mfma_f32_32x32x16_bf16 v[208:223], v[100:103], v[160:163], 0
  s_waitcnt vmcnt(6) lgkmcnt(12)
  ds_read_b64_tr_b16 v[100:101], v13 offset:12288
  ds_read_b64_tr_b16 v[102:103], v13 offset:13312
  buffer_load_dwordx4 a[152:155], v3, s[36:39], s12 offen offset:0 sc1
  v_mfma_f32_32x32x16_bf16 v[192:207], v[104:107], v[164:167], v[192:207]
  s_waitcnt lgkmcnt(12)
  ds_read_b64_tr_b16 v[104:105], v12 offset:14336
  ds_read_b64_tr_b16 v[106:107], v12 offset:15360
  v_mfma_f32_32x32x16_bf16 v[208:223], v[108:111], v[164:167], v[208:223]
  s_waitcnt vmcnt(6) lgkmcnt(12)
  ds_read_b64_tr_b16 v[108:109], v13 offset:14336
  ds_read_b64_tr_b16 v[110:111], v13 offset:15360
  buffer_load_dwordx4 a[156:159], v3, s[36:39], s12 offen offset:1024 sc1
  v_mfma_f32_32x32x16_bf16 v[192:207], v[112:115], a[128:131], v[192:207]
  s_waitcnt lgkmcnt(12)
  ds_read_b64_tr_b16 v[112:113], v12 offset:16384
  ds_read_b64_tr_b16 v[114:115], v12 offset:17408
  v_mfma_f32_32x32x16_bf16 v[208:223], v[116:119], a[128:131], v[208:223]
  s_waitcnt vmcnt(6) lgkmcnt(12)
  ds_read_b64_tr_b16 v[116:117], v13 offset:16384
  ds_read_b64_tr_b16 v[118:119], v13 offset:17408
  buffer_load_dwordx4 a[160:163], v3, s[36:39], s13 offen offset:0 sc1
  v_mfma_f32_32x32x16_bf16 v[192:207], v[120:123], a[132:135], v[192:207]
  s_waitcnt lgkmcnt(12)
  ds_read_b64_tr_b16 v[120:121], v12 offset:18432
  ds_read_b64_tr_b16 v[122:123], v12 offset:19456
  v_mfma_f32_32x32x16_bf16 v[208:223], v[124:127], a[132:135], v[208:223]
  s_waitcnt vmcnt(6) lgkmcnt(12)
  ds_read_b64_tr_b16 v[124:125], v13 offset:18432
  ds_read_b64_tr_b16 v[126:127], v13 offset:19456
  buffer_load_dwordx4 a[164:167], v3, s[36:39], s13 offen offset:1024 sc1
  v_mfma_f32_32x32x16_bf16 v[192:207], v[96:99], a[136:139], v[192:207]
  s_waitcnt lgkmcnt(12)
  ds_read_b64_tr_b16 v[96:97], v12 offset:20480
  ds_read_b64_tr_b16 v[98:99], v12 offset:21504
  v_mfma_f32_32x32x16_bf16 v[208:223], v[100:103], a[136:139], v[208:223]
  s_waitcnt vmcnt(6) lgkmcnt(12)
  ds_read_b64_tr_b16 v[100:101], v13 offset:20480
  ds_read_b64_tr_b16 v[102:103], v13 offset:21504
  buffer_load_dwordx4 a[168:171], v3, s[36:39], s14 offen offset:0 sc1
  v_mfma_f32_32x32x16_bf16 v[192:207], v[104:107], a[140:143], v[192:207]
  s_waitcnt lgkmcnt(12)
  ds_read_b64_tr_b16 v[104:105], v12 offset:22528
  ds_read_b64_tr_b16 v[106:107], v12 offset:23552
  v_mfma_f32_32x32x16_bf16 v[208:223], v[108:111], a[140:143], v[208:223]
  s_waitcnt vmcnt(6) lgkmcnt(12)
  ds_read_b64_tr_b16 v[108:109], v13 offset:22528
  ds_read_b64_tr_b16 v[110:111], v13 offset:23552
  buffer_load_dwordx4 a[172:175], v3, s[36:39], s14 offen offset:1024 sc1
  v_mfma_f32_32x32x16_bf16 v[192:207], v[112:115], a[144:147], v[192:207]
  s_waitcnt lgkmcnt(12)
  ds_read_b64_tr_b16 v[112:113], v12 offset:24576
  ds_read_b64_tr_b16 v[114:115], v12 offset:25600
  v_mfma_f32_32x32x16_bf16 v[208:223], v[116:119], a[144:147], v[208:223]
  s_waitcnt vmcnt(6) lgkmcnt(12)
  ds_read_b64_tr_b16 v[116:117], v13 offset:24576
  ds_read_b64_tr_b16 v[118:119], v13 offset:25600
  v_mfma_f32_32x32x16_bf16 v[192:207], v[120:123], a[148:151], v[192:207]
  s_waitcnt lgkmcnt(12)
  ds_read_b64_tr_b16 v[120:121], v12 offset:26624
  ds_read_b64_tr_b16 v[122:123], v12 offset:27648
  v_mfma_f32_32x32x16_bf16 v[208:223], v[124:127], a[148:151], v[208:223]
  s_waitcnt vmcnt(5) lgkmcnt(12)
  ds_read_b64_tr_b16 v[124:125], v13 offset:26624
  ds_read_b64_tr_b16 v[126:127], v13 offset:27648
  v_mfma_f32_32x32x16_bf16 v[192:207], v[96:99], a[152:155], v[192:207]
  s_waitcnt lgkmcnt(12)
  ds_read_b64_tr_b16 v[96:97], v12 offset:28672
  ds_read_b64_tr_b16 v[98:99], v12 offset:29696
  v_mfma_f32_32x32x16_bf16 v[208:223], v[100:103], a[152:155], v[208:223]
  s_waitcnt vmcnt(4) lgkmcnt(12)
  ds_read_b64_tr_b16 v[100:101], v13 offset:28672
  ds_read_b64_tr_b16 v[102:103], v13 offset:29696
  v_mfma_f32_32x32x16_bf16 v[192:207], v[104:107], a[156:159], v[192:207]
  s_waitcnt lgkmcnt(12)
  ds_read_b64_tr_b16 v[104:105], v12 offset:30720
  ds_read_b64_tr_b16 v[106:107], v12 offset:31744
  v_mfma_f32_32x32x16_bf16 v[208:223], v[108:111], a[156:159], v[208:223]
  s_waitcnt vmcnt(3) lgkmcnt(12)
  ds_read_b64_tr_b16 v[108:109], v13 offset:30720
  ds_read_b64_tr_b16 v[110:111], v13 offset:31744
  v_mfma_f32_32x32x16_bf16 v[192:207], v[112:115], a[160:163], v[192:207]
  s_waitcnt lgkmcnt(12)
  ds_read_b64_tr_b16 v[112:113], v12 offset:4096
  ds_read_b64_tr_b16 v[114:115], v12 offset:5120
  v_mfma_f32_32x32x16_bf16 v[208:223], v[116:119], a[160:163], v[208:223]
  s_waitcnt vmcnt(2) lgkmcnt(12)
  ds_read_b64_tr_b16 v[116:117], v13 offset:4096
  ds_read_b64_tr_b16 v[118:119], v13 offset:5120
  v_mfma_f32_32x32x16_bf16 v[192:207], v[120:123], a[164:167], v[192:207]
  s_waitcnt lgkmcnt(12)
  ds_read_b64_tr_b16 v[120:121], v12 offset:6144
  ds_read_b64_tr_b16 v[122:123], v12 offset:7168
  v_mfma_f32_32x32x16_bf16 v[208:223], v[124:127], a[164:167], v[208:223]
  s_waitcnt vmcnt(1) lgkmcnt(12)
  ds_read_b64_tr_b16 v[124:125], v13 offset:6144
  ds_read_b64_tr_b16 v[126:127], v13 offset:7168
  v_mfma_f32_32x32x16_bf16 v[192:207], v[96:99], a[168:171], v[192:207]
  s_waitcnt lgkmcnt(12)
  ds_read_b64_tr_b16 v[96:97], v10 offset:0
  ds_read_b64_tr_b16 v[98:99], v10 offset:1024
  v_mfma_f32_32x32x16_bf16 v[208:223], v[100:103], a[168:171], v[208:223]
  s_waitcnt vmcnt(0) lgkmcnt(12)
  ds_read_b64_tr_b16 v[100:101], v11 offset:0
  ds_read_b64_tr_b16 v[102:103], v11 offset:1024
  v_mfma_f32_32x32x16_bf16 v[192:207], v[104:107], a[172:175], v[192:207]
  s_waitcnt lgkmcnt(12)
  ds_read_b64_tr_b16 v[104:105], v10 offset:2048
  ds_read_b64_tr_b16 v[106:107], v10 offset:3072
  v_mov_b32 v0, 0x300
  buffer_store_dword v0, off, s[36:39], s72
  v_mfma_f32_32x32x16_bf16 v[208:223], v[108:111], a[172:175], v[208:223]
  ds_read_b64_tr_b16 v[108:109], v11 offset:2048
  ds_read_b64_tr_b16 v[110:111], v11 offset:3072
  buffer_load_dword v253, v9, s[36:39], s70 offen offset:192 sc1
  s_waitcnt vmcnt(0)
  v_cmp_gt_u32 vcc, 0x1, v253
  s_cbranch_vccnz L_spin_53
L_back_54:
  buffer_load_dwordx4 v[168:171], v4, s[28:31], s8 offen offset:0 sc1
  buffer_load_dwordx4 v[172:175], v4, s[28:31], s8 offen offset:1024 sc1
  buffer_load_dwordx4 a[176:179], v4, s[28:31], s9 offen offset:0 sc1
  buffer_load_dwordx4 a[180:183], v4, s[28:31], s9 offen offset:1024 sc1
  buffer_load_dwordx4 a[184:187], v4, s[28:31], s10 offen offset:0 sc1
  buffer_load_dwordx4 a[188:191], v4, s[28:31], s10 offen offset:1024 sc1
  buffer_load_dwordx4 a[192:195], v4, s[28:31], s11 offen offset:0 sc1
  buffer_load_dwordx4 a[196:199], v4, s[28:31], s11 offen offset:1024 sc1
  s_waitcnt vmcnt(7) lgkmcnt(14)
  v_mfma_f32_32x32x16_bf16 v[192:207], v[112:115], v[168:171], v[192:207]
  s_waitcnt lgkmcnt(12)
  ds_read_b64_tr_b16 v[112:113], v10 offset:4096
  ds_read_b64_tr_b16 v[114:115], v10 offset:5120
  v_mfma_f32_32x32x16_bf16 v[208:223], v[116:119], v[168:171], v[208:223]
  s_waitcnt vmcnt(6) lgkmcnt(12)
  ds_read_b64_tr_b16 v[116:117], v11 offset:4096
  ds_read_b64_tr_b16 v[118:119], v11 offset:5120
  buffer_load_dwordx4 a[200:203], v4, s[28:31], s12 offen offset:0 sc1
  v_mfma_f32_32x32x16_bf16 v[192:207], v[120:123], v[172:175], v[192:207]
  s_waitcnt lgkmcnt(12)
  ds_read_b64_tr_b16 v[120:121], v10 offset:6144
  ds_read_b64_tr_b16 v[122:123], v10 offset:7168
  v_mfma_f32_32x32x16_bf16 v[208:223], v[124:127], v[172:175], v[208:223]
  s_waitcnt vmcnt(6) lgkmcnt(12)
  ds_read_b64_tr_b16 v[124:125], v11 offset:6144
  ds_read_b64_tr_b16 v[126:127], v11 offset:7168
  buffer_load_dwordx4 a[204:207], v4, s[28:31], s12 offen offset:1024 sc1
  v_mfma_f32_32x32x16_bf16 v[192:207], v[96:99], a[176:179], v[192:207]
  s_waitcnt lgkmcnt(12)
  ds_read_b64_tr_b16 v[96:97], v10 offset:8192
  ds_read_b64_tr_b16 v[98:99], v10 offset:9216
  v_mfma_f32_32x32x16_bf16 v[208:223], v[100:103], a[176:179], v[208:223]
  s_waitcnt vmcnt(6) lgkmcnt(12)
  ds_read_b64_tr_b16 v[100:101], v11 offset:8192
  ds_read_b64_tr_b16 v[102:103], v11 offset:9216
  buffer_load_dwordx4 a[208:211], v4, s[28:31], s13 offen offset:0 sc1
  v_mfma_f32_32x32x16_bf16 v[192:207], v[104:107], a[180:183], v[192:207]
  s_waitcnt lgkmcnt(12)
  ds_read_b64_tr_b16 v[104:105], v10 offset:10240
  ds_read_b64_tr_b16 v[106:107], v10 offset:11264
  v_mfma_f32_32x32x16_bf16 v[208:223], v[108:111], a[180:183], v[208:223]
  s_waitcnt vmcnt(6) lgkmcnt(12)
  ds_read_b64_tr_b16 v[108:109], v11 offset:10240
  ds_read_b64_tr_b16 v[110:111], v11 offset:11264
  buffer_load_dwordx4 a[212:215], v4, s[28:31], s13 offen offset:1024 sc1
  v_mfma_f32_32x32x16_bf16 v[192:207], v[112:115], a[184:187], v[192:207]
  s_waitcnt lgkmcnt(12)
  ds_read_b64_tr_b16 v[112:113], v10 offset:12288
  ds_read_b64_tr_b16 v[114:115], v10 offset:13312
  v_mfma_f32_32x32x16_bf16 v[208:223], v[116:119], a[184:187], v[208:223]
  s_waitcnt vmcnt(6) lgkmcnt(12)
  ds_read_b64_tr_b16 v[116:117], v11 offset:12288
  ds_read_b64_tr_b16 v[118:119], v11 offset:13312
  buffer_load_dwordx4 a[216:219], v4, s[28:31], s14 offen offset:0 sc1
  v_mfma_f32_32x32x16_bf16 v[192:207], v[120:123], a[188:191], v[192:207]
  s_waitcnt lgkmcnt(12)
  ds_read_b64_tr_b16 v[120:121], v10 offset:14336
  ds_read_b64_tr_b16 v[122:123], v10 offset:15360
  v_mfma_f32_32x32x16_bf16 v[208:223], v[124:127], a[188:191], v[208:223]
  s_waitcnt vmcnt(6) lgkmcnt(12)
  ds_read_b64_tr_b16 v[124:125], v11 offset:14336
  ds_read_b64_tr_b16 v[126:127], v11 offset:15360
  buffer_load_dwordx4 a[220:223], v4, s[28:31], s14 offen offset:1024 sc1
  v_mfma_f32_32x32x16_bf16 v[192:207], v[96:99], a[192:195], v[192:207]
  s_waitcnt lgkmcnt(12)
  ds_read_b64_tr_b16 v[96:97], v10 offset:16384
  ds_read_b64_tr_b16 v[98:99], v10 offset:17408
  v_mfma_f32_32x32x16_bf16 v[208:223], v[100:103], a[192:195], v[208:223]
  s_waitcnt vmcnt(6) lgkmcnt(12)
  ds_read_b64_tr_b16 v[100:101], v11 offset:16384
  ds_read_b64_tr_b16 v[102:103], v11 offset:17408
  v_mfma_f32_32x32x16_bf16 v[192:207], v[104:107], a[196:199], v[192:207]
  s_waitcnt lgkmcnt(12)
  ds_read_b64_tr_b16 v[104:105], v10 offset:18432
  ds_read_b64_tr_b16 v[106:107], v10 offset:19456
  v_mfma_f32_32x32x16_bf16 v[208:223], v[108:111], a[196:199], v[208:223]
  s_waitcnt vmcnt(5) lgkmcnt(12)
  ds_read_b64_tr_b16 v[108:109], v11 offset:18432
  ds_read_b64_tr_b16 v[110:111], v11 offset:19456
  v_mfma_f32_32x32x16_bf16 v[192:207], v[112:115], a[200:203], v[192:207]
  s_waitcnt lgkmcnt(12)
  ds_read_b64_tr_b16 v[112:113], v10 offset:20480
  ds_read_b64_tr_b16 v[114:115], v10 offset:21504
  v_mfma_f32_32x32x16_bf16 v[208:223], v[116:119], a[200:203], v[208:223]
  s_waitcnt vmcnt(4) lgkmcnt(12)
  ds_read_b64_tr_b16 v[116:117], v11 offset:20480
  ds_read_b64_tr_b16 v[118:119], v11 offset:21504
  v_mfma_f32_32x32x16_bf16 v[192:207], v[120:123], a[204:207], v[192:207]
  s_waitcnt lgkmcnt(12)
  ds_read_b64_tr_b16 v[120:121], v10 offset:22528
  ds_read_b64_tr_b16 v[122:123], v10 offset:23552
  v_mfma_f32_32x32x16_bf16 v[208:223], v[124:127], a[204:207], v[208:223]
  s_waitcnt vmcnt(3) lgkmcnt(12)
  ds_read_b64_tr_b16 v[124:125], v11 offset:22528
  ds_read_b64_tr_b16 v[126:127], v11 offset:23552
  v_mfma_f32_32x32x16_bf16 v[192:207], v[96:99], a[208:211], v[192:207]
  s_waitcnt lgkmcnt(12)
  ds_read_b64_tr_b16 v[96:97], v10 offset:24576
  ds_read_b64_tr_b16 v[98:99], v10 offset:25600
  v_mfma_f32_32x32x16_bf16 v[208:223], v[100:103], a[208:211], v[208:223]
  s_waitcnt vmcnt(2) lgkmcnt(12)
  ds_read_b64_tr_b16 v[100:101], v11 offset:24576
  ds_read_b64_tr_b16 v[102:103], v11 offset:25600
  v_mfma_f32_32x32x16_bf16 v[192:207], v[104:107], a[212:215], v[192:207]
  s_waitcnt lgkmcnt(12)
  ds_read_b64_tr_b16 v[104:105], v10 offset:26624
  ds_read_b64_tr_b16 v[106:107], v10 offset:27648
  v_mfma_f32_32x32x16_bf16 v[208:223], v[108:111], a[212:215], v[208:223]
  s_waitcnt vmcnt(1) lgkmcnt(12)
  ds_read_b64_tr_b16 v[108:109], v11 offset:26624
  ds_read_b64_tr_b16 v[110:111], v11 offset:27648
  v_mfma_f32_32x32x16_bf16 v[192:207], v[112:115], a[216:219], v[192:207]
  s_waitcnt lgkmcnt(12)
  ds_read_b64_tr_b16 v[112:113], v10 offset:32768
  ds_read_b64_tr_b16 v[114:115], v10 offset:33792
  v_mfma_f32_32x32x16_bf16 v[208:223], v[116:119], a[216:219], v[208:223]
  s_waitcnt vmcnt(0) lgkmcnt(12)
  ds_read_b64_tr_b16 v[116:117], v11 offset:32768
  ds_read_b64_tr_b16 v[118:119], v11 offset:33792
  v_mfma_f32_32x32x16_bf16 v[192:207], v[120:123], a[220:223], v[192:207]
  s_waitcnt lgkmcnt(12)
  ds_read_b64_tr_b16 v[120:121], v10 offset:34816
  ds_read_b64_tr_b16 v[122:123], v10 offset:35840
  v_mov_b32 v0, 0x400
  buffer_store_dword v0, off, s[36:39], s72
  v_mfma_f32_32x32x16_bf16 v[208:223], v[124:127], a[220:223], v[208:223]
  ds_read_b64_tr_b16 v[124:125], v11 offset:34816
  ds_read_b64_tr_b16 v[126:127], v11 offset:35840
  buffer_load_dword v254, v9, s[36:39], s70 offen offset:256 sc1
  s_waitcnt vmcnt(0)
  v_cmp_gt_u32 vcc, 0x1, v254
  s_cbranch_vccnz L_spin_56
L_back_57:
  buffer_load_dwordx4 v[176:179], v7, s[36:39], s8 offen offset:0 sc1
  buffer_load_dwordx4 v[180:183], v7, s[36:39], s8 offen offset:1024 sc1
  buffer_load_dwordx4 a[0:3], v7, s[36:39], s9 offen offset:0 sc1
  buffer_load_dwordx4 a[4:7], v7, s[36:39], s9 offen offset:1024 sc1
  buffer_load_dwordx4 a[8:11], v7, s[36:39], s10 offen offset:0 sc1
  buffer_load_dwordx4 a[12:15], v7, s[36:39], s10 offen offset:1024 sc1
  buffer_load_dwordx4 a[16:19], v7, s[36:39], s11 offen offset:0 sc1
  buffer_load_dwordx4 a[20:23], v7, s[36:39], s11 offen offset:1024 sc1
  s_waitcnt vmcnt(7) lgkmcnt(14)
  v_mfma_f32_32x32x16_bf16 v[192:207], v[96:99], v[176:179], v[192:207]
  s_waitcnt lgkmcnt(12)
  ds_read_b64_tr_b16 v[96:97], v10 offset:36864
  ds_read_b64_tr_b16 v[98:99], v10 offset:37888
  v_mfma_f32_32x32x16_bf16 v[208:223], v[100:103], v[176:179], v[208:223]
  s_waitcnt vmcnt(6) lgkmcnt(12)
  ds_read_b64_tr_b16 v[100:101], v11 offset:36864
  ds_read_b64_tr_b16 v[102:103], v11 offset:37888
  buffer_load_dwordx4 a[24:27], v7, s[36:39], s12 offen offset:0 sc1
  v_mfma_f32_32x32x16_bf16 v[192:207], v[104:107], v[180:183], v[192:207]
  s_waitcnt lgkmcnt(12)
  ds_read_b64_tr_b16 v[104:105], v10 offset:38912
  ds_read_b64_tr_b16 v[106:107], v10 offset:39936
  v_mfma_f32_32x32x16_bf16 v[208:223], v[108:111], v[180:183], v[208:223]
  s_waitcnt vmcnt(6) lgkmcnt(12)
  ds_read_b64_tr_b16 v[108:109], v11 offset:38912
  ds_read_b64_tr_b16 v[110:111], v11 offset:39936
  buffer_load_dwordx4 a[28:31], v7, s[36:39], s12 offen offset:1024 sc1
  v_mfma_f32_32x32x16_bf16 v[192:207], v[112:115], a[0:3], v[192:207]
  s_waitcnt lgkmcnt(12)
  ds_read_b64_tr_b16 v[112:113], v10 offset:40960
  ds_read_b64_tr_b16 v[114:115], v10 offset:41984
  v_mfma_f32_32x32x16_bf16 v[208:223], v[116:119], a[0:3], v[208:223]
  s_waitcnt vmcnt(6) lgkmcnt(12)
  ds_read_b64_tr_b16 v[116:117], v11 offset:40960
  ds_read_b64_tr_b16 v[118:119], v11 offset:41984
  buffer_load_dwordx4 a[32:35], v7, s[36:39], s13 offen offset:0 sc1
  v_mfma_f32_32x32x16_bf16 v[192:207], v[120:123], a[4:7], v[192:207]
  s_waitcnt lgkmcnt(12)
  ds_read_b64_tr_b16 v[120:121], v10 offset:43008
  ds_read_b64_tr_b16 v[122:123], v10 offset:44032
  v_mfma_f32_32x32x16_bf16 v[208:223], v[124:127], a[4:7], v[208:223]
  s_waitcnt vmcnt(6) lgkmcnt(12)
  ds_read_b64_tr_b16 v[124:125], v11 offset:43008
  ds_read_b64_tr_b16 v[126:127], v11 offset:44032
  buffer_load_dwordx4 a[36:39], v7, s[36:39], s13 offen offset:1024 sc1
  v_mfma_f32_32x32x16_bf16 v[192:207], v[96:99], a[8:11], v[192:207]
  s_waitcnt lgkmcnt(12)
  ds_read_b64_tr_b16 v[96:97], v10 offset:45056
  ds_read_b64_tr_b16 v[98:99], v10 offset:46080
  v_mfma_f32_32x32x16_bf16 v[208:223], v[100:103], a[8:11], v[208:223]
  s_waitcnt vmcnt(6) lgkmcnt(12)
  ds_read_b64_tr_b16 v[100:101], v11 offset:45056
  ds_read_b64_tr_b16 v[102:103], v11 offset:46080
  buffer_load_dwordx4 a[40:43], v7, s[36:39], s14 offen offset:0 sc1
  v_mfma_f32_32x32x16_bf16 v[192:207], v[104:107], a[12:15], v[192:207]
  s_waitcnt lgkmcnt(12)
  ds_read_b64_tr_b16 v[104:105], v10 offset:47104
  ds_read_b64_tr_b16 v[106:107], v10 offset:48128
  v_mfma_f32_32x32x16_bf16 v[208:223], v[108:111], a[12:15], v[208:223]
  s_waitcnt vmcnt(6) lgkmcnt(12)
  ds_read_b64_tr_b16 v[108:109], v11 offset:47104
  ds_read_b64_tr_b16 v[110:111], v11 offset:48128
  buffer_load_dwordx4 a[44:47], v7, s[36:39], s14 offen offset:1024 sc1
  v_mfma_f32_32x32x16_bf16 v[192:207], v[112:115], a[16:19], v[192:207]
  s_waitcnt lgkmcnt(12)
  ds_read_b64_tr_b16 v[112:113], v10 offset:49152
  ds_read_b64_tr_b16 v[114:115], v10 offset:50176
  v_mfma_f32_32x32x16_bf16 v[208:223], v[116:119], a[16:19], v[208:223]
  s_waitcnt vmcnt(6) lgkmcnt(12)
  ds_read_b64_tr_b16 v[116:117], v11 offset:49152
  ds_read_b64_tr_b16 v[118:119], v11 offset:50176
  v_mfma_f32_32x32x16_bf16 v[192:207], v[120:123], a[20:23], v[192:207]
  s_waitcnt lgkmcnt(12)
  ds_read_b64_tr_b16 v[120:121], v10 offset:51200
  ds_read_b64_tr_b16 v[122:123], v10 offset:52224
  v_mfma_f32_32x32x16_bf16 v[208:223], v[124:127], a[20:23], v[208:223]
  s_waitcnt vmcnt(5) lgkmcnt(12)
  ds_read_b64_tr_b16 v[124:125], v11 offset:51200
  ds_read_b64_tr_b16 v[126:127], v11 offset:52224
  v_mfma_f32_32x32x16_bf16 v[192:207], v[96:99], a[24:27], v[192:207]
  s_waitcnt lgkmcnt(12)
  ds_read_b64_tr_b16 v[96:97], v10 offset:53248
  ds_read_b64_tr_b16 v[98:99], v10 offset:54272
  v_mfma_f32_32x32x16_bf16 v[208:223], v[100:103], a[24:27], v[208:223]
  s_waitcnt vmcnt(4) lgkmcnt(12)
  ds_read_b64_tr_b16 v[100:101], v11 offset:53248
  ds_read_b64_tr_b16 v[102:103], v11 offset:54272
  v_mfma_f32_32x32x16_bf16 v[192:207], v[104:107], a[28:31], v[192:207]
  s_waitcnt lgkmcnt(12)
  ds_read_b64_tr_b16 v[104:105], v10 offset:55296
  ds_read_b64_tr_b16 v[106:107], v10 offset:56320
  v_mfma_f32_32x32x16_bf16 v[208:223], v[108:111], a[28:31], v[208:223]
  s_waitcnt vmcnt(3) lgkmcnt(12)
  ds_read_b64_tr_b16 v[108:109], v11 offset:55296
  ds_read_b64_tr_b16 v[110:111], v11 offset:56320
  v_mfma_f32_32x32x16_bf16 v[192:207], v[112:115], a[32:35], v[192:207]
  s_waitcnt lgkmcnt(12)
  ds_read_b64_tr_b16 v[112:113], v10 offset:28672
  ds_read_b64_tr_b16 v[114:115], v10 offset:29696
  v_mfma_f32_32x32x16_bf16 v[208:223], v[116:119], a[32:35], v[208:223]
  s_waitcnt vmcnt(2) lgkmcnt(12)
  ds_read_b64_tr_b16 v[116:117], v11 offset:28672
  ds_read_b64_tr_b16 v[118:119], v11 offset:29696
  v_mfma_f32_32x32x16_bf16 v[192:207], v[120:123], a[36:39], v[192:207]
  s_waitcnt lgkmcnt(12)
  ds_read_b64_tr_b16 v[120:121], v10 offset:30720
  ds_read_b64_tr_b16 v[122:123], v10 offset:31744
  v_mfma_f32_32x32x16_bf16 v[208:223], v[124:127], a[36:39], v[208:223]
  s_waitcnt vmcnt(1) lgkmcnt(12)
  ds_read_b64_tr_b16 v[124:125], v11 offset:30720
  ds_read_b64_tr_b16 v[126:127], v11 offset:31744
  v_mfma_f32_32x32x16_bf16 v[192:207], v[96:99], a[40:43], v[192:207]
  s_waitcnt lgkmcnt(12)
  ds_read_b64_tr_b16 v[96:97], v10 offset:57344
  ds_read_b64_tr_b16 v[98:99], v10 offset:58368
  v_mfma_f32_32x32x16_bf16 v[208:223], v[100:103], a[40:43], v[208:223]
  s_waitcnt vmcnt(0) lgkmcnt(12)
  ds_read_b64_tr_b16 v[100:101], v11 offset:57344
  ds_read_b64_tr_b16 v[102:103], v11 offset:58368
  v_mfma_f32_32x32x16_bf16 v[192:207], v[104:107], a[44:47], v[192:207]
  s_waitcnt lgkmcnt(12)
  ds_read_b64_tr_b16 v[104:105], v10 offset:59392
  ds_read_b64_tr_b16 v[106:107], v10 offset:60416
  v_mov_b32 v0, 0x500
  buffer_store_dword v0, off, s[36:39], s72
  v_mfma_f32_32x32x16_bf16 v[208:223], v[108:111], a[44:47], v[208:223]
  ds_read_b64_tr_b16 v[108:109], v11 offset:59392
  ds_read_b64_tr_b16 v[110:111], v11 offset:60416
  buffer_load_dword v255, v9, s[36:39], s70 offen offset:320 sc1
  s_waitcnt vmcnt(0)
  v_cmp_gt_u32 vcc, 0x1, v255
  s_cbranch_vccnz L_spin_59
L_back_60:
  buffer_load_dwordx4 v[184:187], v8, s[28:31], s8 offen offset:0 sc1
  buffer_load_dwordx4 v[188:191], v8, s[28:31], s8 offen offset:1024 sc1
  buffer_load_dwordx4 a[48:51], v8, s[28:31], s9 offen offset:0 sc1
  buffer_load_dwordx4 a[52:55], v8, s[28:31], s9 offen offset:1024 sc1
  buffer_load_dwordx4 a[56:59], v8, s[28:31], s10 offen offset:0 sc1
  buffer_load_dwordx4 a[60:63], v8, s[28:31], s10 offen offset:1024 sc1
  buffer_load_dwordx4 a[64:67], v8, s[28:31], s11 offen offset:0 sc1
  buffer_load_dwordx4 a[68:71], v8, s[28:31], s11 offen offset:1024 sc1
  s_waitcnt vmcnt(7) lgkmcnt(14)
  v_mfma_f32_32x32x16_bf16 v[192:207], v[112:115], v[184:187], v[192:207]
  s_waitcnt lgkmcnt(12)
  ds_read_b64_tr_b16 v[112:113], v10 offset:61440
  ds_read_b64_tr_b16 v[114:115], v10 offset:62464
  v_mfma_f32_32x32x16_bf16 v[208:223], v[116:119], v[184:187], v[208:223]
  s_waitcnt vmcnt(6) lgkmcnt(12)
  ds_read_b64_tr_b16 v[116:117], v11 offset:61440
  ds_read_b64_tr_b16 v[118:119], v11 offset:62464
  buffer_load_dwordx4 a[72:75], v8, s[28:31], s12 offen offset:0 sc1
  v_mfma_f32_32x32x16_bf16 v[192:207], v[120:123], v[188:191], v[192:207]
  s_waitcnt lgkmcnt(12)
  ds_read_b64_tr_b16 v[120:121], v10 offset:63488
  ds_read_b64_tr_b16 v[122:123], v10 offset:64512
  v_mfma_f32_32x32x16_bf16 v[208:223], v[124:127], v[188:191], v[208:223]
  s_waitcnt vmcnt(6) lgkmcnt(12)
  ds_read_b64_tr_b16 v[124:125], v11 offset:63488
  ds_read_b64_tr_b16 v[126:127], v11 offset:64512
  buffer_load_dwordx4 a[76:79], v8, s[28:31], s12 offen offset:1024 sc1
  v_mfma_f32_32x32x16_bf16 v[192:207], v[96:99], a[48:51], v[192:207]
  s_waitcnt lgkmcnt(12)
  ds_read_b64_tr_b16 v[96:97], v14 offset:0
  ds_read_b64_tr_b16 v[98:99], v14 offset:1024
  v_mfma_f32_32x32x16_bf16 v[208:223], v[100:103], a[48:51], v[208:223]
  s_waitcnt vmcnt(6) lgkmcnt(12)
  ds_read_b64_tr_b16 v[100:101], v15 offset:0
  ds_read_b64_tr_b16 v[102:103], v15 offset:1024
  buffer_load_dwordx4 a[80:83], v8, s[28:31], s13 offen offset:0 sc1
  v_mfma_f32_32x32x16_bf16 v[192:207], v[104:107], a[52:55], v[192:207]
  s_waitcnt lgkmcnt(12)
  ds_read_b64_tr_b16 v[104:105], v14 offset:2048
  ds_read_b64_tr_b16 v[106:107], v14 offset:3072
  v_mfma_f32_32x32x16_bf16 v[208:223], v[108:111], a[52:55], v[208:223]
  s_waitcnt vmcnt(6) lgkmcnt(12)
  ds_read_b64_tr_b16 v[108:109], v15 offset:2048
  ds_read_b64_tr_b16 v[110:111], v15 offset:3072
  buffer_load_dwordx4 a[84:87], v8, s[28:31], s13 offen offset:1024 sc1
  v_mfma_f32_32x32x16_bf16 v[192:207], v[112:115], a[56:59], v[192:207]
  s_waitcnt lgkmcnt(12)
  ds_read_b64_tr_b16 v[112:113], v14 offset:4096
  ds_read_b64_tr_b16 v[114:115], v14 offset:5120
  v_mfma_f32_32x32x16_bf16 v[208:223], v[116:119], a[56:59], v[208:223]
  s_waitcnt vmcnt(6) lgkmcnt(12)
  ds_read_b64_tr_b16 v[116:117], v15 offset:4096
  ds_read_b64_tr_b16 v[118:119], v15 offset:5120
  buffer_load_dwordx4 a[88:91], v8, s[28:31], s14 offen offset:0 sc1
  v_mfma_f32_32x32x16_bf16 v[192:207], v[120:123], a[60:63], v[192:207]
  s_waitcnt lgkmcnt(12)
  ds_read_b64_tr_b16 v[120:121], v14 offset:6144
  ds_read_b64_tr_b16 v[122:123], v14 offset:7168
  v_mfma_f32_32x32x16_bf16 v[208:223], v[124:127], a[60:63], v[208:223]
  s_waitcnt vmcnt(6) lgkmcnt(12)
  ds_read_b64_tr_b16 v[124:125], v15 offset:6144
  ds_read_b64_tr_b16 v[126:127], v15 offset:7168
  buffer_load_dwordx4 a[92:95], v8, s[28:31], s14 offen offset:1024 sc1
  v_mfma_f32_32x32x16_bf16 v[192:207], v[96:99], a[64:67], v[192:207]
  s_waitcnt lgkmcnt(12)
  ds_read_b64_tr_b16 v[96:97], v14 offset:8192
  ds_read_b64_tr_b16 v[98:99], v14 offset:9216
  v_mfma_f32_32x32x16_bf16 v[208:223], v[100:103], a[64:67], v[208:223]
  s_waitcnt vmcnt(6) lgkmcnt(12)
  ds_read_b64_tr_b16 v[100:101], v15 offset:8192
  ds_read_b64_tr_b16 v[102:103], v15 offset:9216
  v_mfma_f32_32x32x16_bf16 v[192:207], v[104:107], a[68:71], v[192:207]
  s_waitcnt lgkmcnt(12)
  ds_read_b64_tr_b16 v[104:105], v14 offset:10240
  ds_read_b64_tr_b16 v[106:107], v14 offset:11264
  v_mfma_f32_32x32x16_bf16 v[208:223], v[108:111], a[68:71], v[208:223]
  s_waitcnt vmcnt(5) lgkmcnt(12)
  ds_read_b64_tr_b16 v[108:109], v15 offset:10240
  ds_read_b64_tr_b16 v[110:111], v15 offset:11264
  v_mfma_f32_32x32x16_bf16 v[192:207], v[112:115], a[72:75], v[192:207]
  s_waitcnt lgkmcnt(12)
  ds_read_b64_tr_b16 v[112:113], v14 offset:12288
  ds_read_b64_tr_b16 v[114:115], v14 offset:13312
  v_mfma_f32_32x32x16_bf16 v[208:223], v[116:119], a[72:75], v[208:223]
  s_waitcnt vmcnt(4) lgkmcnt(12)
  ds_read_b64_tr_b16 v[116:117], v15 offset:12288
  ds_read_b64_tr_b16 v[118:119], v15 offset:13312
  v_mfma_f32_32x32x16_bf16 v[192:207], v[120:123], a[76:79], v[192:207]
  s_waitcnt lgkmcnt(12)
  ds_read_b64_tr_b16 v[120:121], v14 offset:14336
  ds_read_b64_tr_b16 v[122:123], v14 offset:15360
  v_mfma_f32_32x32x16_bf16 v[208:223], v[124:127], a[76:79], v[208:223]
  s_waitcnt vmcnt(3) lgkmcnt(12)
  ds_read_b64_tr_b16 v[124:125], v15 offset:14336
  ds_read_b64_tr_b16 v[126:127], v15 offset:15360
  v_mfma_f32_32x32x16_bf16 v[192:207], v[96:99], a[80:83], v[192:207]
  s_waitcnt lgkmcnt(12)
  v_mfma_f32_32x32x16_bf16 v[208:223], v[100:103], a[80:83], v[208:223]
  s_waitcnt vmcnt(2) lgkmcnt(10)
  v_mfma_f32_32x32x16_bf16 v[192:207], v[104:107], a[84:87], v[192:207]
  s_waitcnt lgkmcnt(8)
  v_mfma_f32_32x32x16_bf16 v[208:223], v[108:111], a[84:87], v[208:223]
  s_waitcnt vmcnt(1) lgkmcnt(6)
  v_mfma_f32_32x32x16_bf16 v[192:207], v[112:115], a[88:91], v[192:207]
  s_waitcnt lgkmcnt(4)
  v_mfma_f32_32x32x16_bf16 v[208:223], v[116:119], a[88:91], v[208:223]
  s_waitcnt vmcnt(0) lgkmcnt(2)
  v_mfma_f32_32x32x16_bf16 v[192:207], v[120:123], a[92:95], v[192:207]
  s_waitcnt lgkmcnt(0)
  v_mov_b32 v0, 0x600
  buffer_store_dword v0, off, s[36:39], s72
  v_mfma_f32_32x32x16_bf16 v[208:223], v[124:127], a[92:95], v[208:223]
  s_nop 7
  v_cvt_pk_bf16_f32 v128, v192, v193
  v_cvt_pk_bf16_f32 v129, v194, v195
  v_or_b32 v128, 1, v128
  v_cvt_pk_bf16_f32 v130, v196, v197
  v_cvt_pk_bf16_f32 v131, v198, v199
  v_cvt_pk_bf16_f32 v132, v200, v201
  v_cvt_pk_bf16_f32 v133, v202, v203
  v_or_b32 v132, 1, v132
  v_cvt_pk_bf16_f32 v134, v204, v205
  v_cvt_pk_bf16_f32 v135, v206, v207
  v_pk_fma_f32 v[224:225], v[208:209], s[24:25], v[224:225]
  v_pk_fma_f32 v[226:227], v[210:211], s[24:25], v[226:227]
  v_pk_fma_f32 v[228:229], v[212:213], s[24:25], v[228:229]
  v_pk_fma_f32 v[230:231], v[214:215], s[24:25], v[230:231]
  v_pk_fma_f32 v[232:233], v[216:217], s[24:25], v[232:233]
  v_pk_fma_f32 v[234:235], v[218:219], s[24:25], v[234:235]
  buffer_store_dwordx4 v[128:131], v21, s[36:39], s74 offen offset:0
  buffer_store_dwordx4 v[132:135], v21, s[36:39], s74 offen offset:1024
  buffer_load_dwordx4 v[244:247], v21, s[36:39], s75 offen offset:0 sc1
  buffer_load_dwordx4 v[248:251], v21, s[36:39], s75 offen offset:1024 sc1
  buffer_load_dword v252, v6, s[36:39], s70 offen sc1
  v_pk_fma_f32 v[236:237], v[220:221], s[24:25], v[236:237]
  v_pk_fma_f32 v[238:239], v[222:223], s[24:25], v[238:239]
  s_lshl_b32 s57, s64, 15
  s_lshl_b32 s58, s99, 6
  s_add_u32 s57, s57, s58
  s_add_u32 s58, s57, 0x4000
  v_and_b32 v253, 31, v1
  v_lshrrev_b32 v254, 2, v253
  v_lshrrev_b32 v255, 5, v1
  v_xor_b32 v254, v254, v255
  v_and_b32 v254, 3, v254
  v_lshlrev_b32 v254, 4, v254
  v_lshl_add_u32 v253, v253, 6, v254
  v_add_u32 v253, s63, v253
  v_xor_b32 v254, 32, v253
  v_add_u32 v255, s63, v2
  v_lshrrev_b32 v0, 4, v1
  v_xor_b32 v0, v0, v1
  v_and_b32 v0, 3, v0
  v_lshlrev_b32 v0, 4, v0
  v_lshrrev_b32 v19, 2, v1
  v_lshl_add_u32 v19, v19, 10, v0
  s_waitcnt vmcnt(1)
  v_and_b32 v0, v244, v248
  v_lshlrev_b32 v0, 31, v0
  s_waitcnt vmcnt(0)
  v_min_u32 v0, v0, v252
  v_cmp_gt_u32 vcc, 0x600, v0
  s_cbranch_vccnz L_xspin_62
L_xback_63:
  v_lshlrev_b32 v128, 16, v244
  v_and_b32 v129, 0xffff0000, v244
  v_lshlrev_b32 v130, 16, v245
  v_and_b32 v131, 0xffff0000, v245
  v_lshlrev_b32 v132, 16, v246
  v_and_b32 v133, 0xffff0000, v246
  v_lshlrev_b32 v134, 16, v247
  v_and_b32 v135, 0xffff0000, v247
  v_pk_fma_f32 v[224:225], v[128:129], s[24:25], v[224:225]
  v_pk_fma_f32 v[226:227], v[130:131], s[24:25], v[226:227]
  v_pk_fma_f32 v[228:229], v[132:133], s[24:25], v[228:229]
  v_pk_fma_f32 v[230:231], v[134:135], s[24:25], v[230:231]
  v_cvt_pk_bf16_f32 v244, v224, v225
  v_cvt_pk_bf16_f32 v245, v226, v227
  v_cvt_pk_bf16_f32 v246, v228, v229
  v_cvt_pk_bf16_f32 v247, v230, v231
  s_nop 0
  v_permlane32_swap_b32 v244, v246
  v_permlane32_swap_b32 v245, v247
  ds_write_b128 v253, v[244:247] offset:16384
  v_lshlrev_b32 v136, 16, v248
  v_and_b32 v137, 0xffff0000, v248
  v_lshlrev_b32 v138, 16, v249
  v_and_b32 v139, 0xffff0000, v249
  v_lshlrev_b32 v140, 16, v250
  v_and_b32 v141, 0xffff0000, v250
  v_lshlrev_b32 v142, 16, v251
  v_and_b32 v143, 0xffff0000, v251
  v_pk_fma_f32 v[232:233], v[136:137], s[24:25], v[232:233]
  v_pk_fma_f32 v[234:235], v[138:139], s[24:25], v[234:235]
  v_pk_fma_f32 v[236:237], v[140:141], s[24:25], v[236:237]
  v_pk_fma_f32 v[238:239], v[142:143], s[24:25], v[238:239]
  v_cvt_pk_bf16_f32 v248, v232, v233
  v_cvt_pk_bf16_f32 v249, v234, v235
  v_cvt_pk_bf16_f32 v250, v236, v237
  v_cvt_pk_bf16_f32 v251, v238, v239
  s_nop 0
  v_permlane32_swap_b32 v248, v250
  v_permlane32_swap_b32 v249, v251
  ds_write_b128 v254, v[248:251] offset:16384
  ds_read_b128 v[244:247], v255 offset:16384
  ds_read_b128 v[248:251], v255 offset:17408
  s_waitcnt lgkmcnt(1)
  buffer_store_dwordx4 v[244:247], v19, s[28:31], s57 offen
  s_waitcnt lgkmcnt(0)
  buffer_store_dwordx4 v[248:251], v19, s[28:31], s58 offen
L_fin:
L_end:
  s_endpgm
  s_waitcnt vmcnt(0) lgkmcnt(0)
L_spin_9:
  s_movk_i32 s61, 0x3fff
L_spin_11:
  buffer_load_dword v31, v12, s[36:39], s51 offen offset:0 sc1
  s_waitcnt vmcnt(0)
  v_cmp_gt_u32 vcc, 0x1, v31
  s_cbranch_vccz L_back_10
  s_sub_u32 s61, s61, 1
  s_cbranch_scc0 L_spin_11
  s_branch L_back_10
L_spin_12:
  s_movk_i32 s61, 0x3fff
L_spin_14:
  buffer_load_dword v17, v6, s[36:39], s70 offen offset:64 sc1
  s_waitcnt vmcnt(0)
  v_cmp_gt_u32 vcc, 0x1, v17
  s_cbranch_vccz L_back_13
  s_sub_u32 s61, s61, 1
  s_cbranch_scc0 L_spin_14
  s_branch L_back_13
L_ewspin_15:
  s_movk_i32 s61, 0x3fff
L_ewspin_17:
  buffer_load_dwordx4 v[144:147], v20, s[36:39], s60 offen offset:0 sc1
  buffer_load_dwordx4 v[148:151], v20, s[36:39], s60 offen offset:512 sc1
  buffer_load_dwordx4 v[152:155], v20, s[36:39], s60 offen offset:1024 sc1
  buffer_load_dwordx4 v[156:159], v20, s[36:39], s60 offen offset:1536 sc1
  s_waitcnt vmcnt(0)
  v_min3_u32 v130, v145, v147, v149
  v_min3_u32 v131, v151, v153, v155
  v_min3_u32 v130, v157, v159, v130
  v_min_u32 v130, v130, v131
  v_cmp_eq_u32 vcc, 0, v130
  s_cbranch_vccz L_ewback_16
  s_sub_u32 s61, s61, 1
  s_cbranch_scc0 L_ewspin_17
  s_branch L_ewback_16
L_spin_18:
  s_movk_i32 s61, 0x3fff
L_spin_20:
  buffer_load_dword v17, v6, s[36:39], s70 offen offset:0 sc1
  s_waitcnt vmcnt(0)
  v_cmp_gt_u32 vcc, 0x200, v17
  s_cbranch_vccz L_back_19
  s_sub_u32 s61, s61, 1
  s_cbranch_scc0 L_spin_20
  s_branch L_back_19
L_catch_21:
  s_movk_i32 s61, 0x3fff
L_cspin_23:
  buffer_load_dword v252, v6, s[36:39], s70 offen offset:128 sc1
  s_waitcnt vmcnt(0)
  v_cmp_eq_u32 vcc, 0, v252
  s_cbranch_vccz L_cgo_24
  s_sub_u32 s61, s61, 1
  s_cbranch_scc0 L_cspin_23
L_cgo_24:
  buffer_load_dwordx4 a[128:131], v3, s[36:39], s9 offen offset:0 sc1
  buffer_load_dwordx4 a[132:135], v3, s[36:39], s9 offen offset:1024 sc1
  buffer_load_dwordx4 a[136:139], v3, s[36:39], s10 offen offset:0 sc1
  buffer_load_dwordx4 a[140:143], v3, s[36:39], s10 offen offset:1024 sc1
  buffer_load_dwordx4 a[144:147], v3, s[36:39], s11 offen offset:0 sc1
  buffer_load_dwordx4 a[148:151], v3, s[36:39], s11 offen offset:1024 sc1
  buffer_load_dwordx4 a[152:155], v3, s[36:39], s12 offen offset:0 sc1
  buffer_load_dwordx4 a[156:159], v3, s[36:39], s12 offen offset:1024 sc1
  buffer_load_dwordx4 a[160:163], v3, s[36:39], s13 offen offset:0 sc1
  buffer_load_dwordx4 a[164:167], v3, s[36:39], s13 offen offset:1024 sc1
  buffer_load_dwordx4 a[168:171], v3, s[36:39], s14 offen offset:0 sc1
  buffer_load_dwordx4 a[172:175], v3, s[36:39], s14 offen offset:1024 sc1
  s_waitcnt vmcnt(0)
  s_branch L_cback_22
L_catch_25:
  s_movk_i32 s61, 0x3fff
L_cspin_27:
  buffer_load_dword v253, v9, s[36:39], s70 offen offset:192 sc1
  s_waitcnt vmcnt(0)
  v_cmp_eq_u32 vcc, 0, v253
  s_cbranch_vccz L_cgo_28
  s_sub_u32 s61, s61, 1
  s_cbranch_scc0 L_cspin_27
L_cgo_28:
  buffer_load_dwordx4 a[176:179], v4, s[28:31], s9 offen offset:0 sc1
  buffer_load_dwordx4 a[180:183], v4, s[28:31], s9 offen offset:1024 sc1
  buffer_load_dwordx4 a[184:187], v4, s[28:31], s10 offen offset:0 sc1
  buffer_load_dwordx4 a[188:191], v4, s[28:31], s10 offen offset:1024 sc1
  buffer_load_dwordx4 a[192:195], v4, s[28:31], s11 offen offset:0 sc1
  buffer_load_dwordx4 a[196:199], v4, s[28:31], s11 offen offset:1024 sc1
  buffer_load_dwordx4 a[200:203], v4, s[28:31], s12 offen offset:0 sc1
  buffer_load_dwordx4 a[204:207], v4, s[28:31], s12 offen offset:1024 sc1
  buffer_load_dwordx4 a[208:211], v4, s[28:31], s13 offen offset:0 sc1
  buffer_load_dwordx4 a[212:215], v4, s[28:31], s13 offen offset:1024 sc1
  buffer_load_dwordx4 a[216:219], v4, s[28:31], s14 offen offset:0 sc1
  buffer_load_dwordx4 a[220:223], v4, s[28:31], s14 offen offset:1024 sc1
  s_waitcnt vmcnt(0)
  s_branch L_cback_26
L_spin_29:
  s_movk_i32 s61, 0x3fff
L_spin_31:
  buffer_load_dword v17, v6, s[36:39], s70 offen offset:0 sc1
  s_waitcnt vmcnt(0)
  v_cmp_gt_u32 vcc, 0x300, v17
  s_cbranch_vccz L_back_30
  s_sub_u32 s61, s61, 1
  s_cbranch_scc0 L_spin_31
  s_branch L_back_30
L_spin_32:
  s_movk_i32 s61, 0x3fff
L_spin_34:
  buffer_load_dword v254, v9, s[36:39], s70 offen offset:256 sc1
  s_waitcnt vmcnt(0)
  v_cmp_gt_u32 vcc, 0x1, v254
  s_cbranch_vccz L_back_33
  s_sub_u32 s61, s61, 1
  s_cbranch_scc0 L_spin_34
  s_branch L_back_33
L_spin_35:
  s_movk_i32 s61, 0x3fff
L_spin_37:
  buffer_load_dword v17, v6, s[36:39], s70 offen offset:0 sc1
  s_waitcnt vmcnt(0)
  v_cmp_gt_u32 vcc, 0x400, v17
  s_cbranch_vccz L_back_36
  s_sub_u32 s61, s61, 1
  s_cbranch_scc0 L_spin_37
  s_branch L_back_36
L_spin_38:
  s_movk_i32 s61, 0x3fff
L_spin_40:
  buffer_load_dword v255, v9, s[36:39], s70 offen offset:320 sc1
  s_waitcnt vmcnt(0)
  v_cmp_gt_u32 vcc, 0x1, v255
  s_cbranch_vccz L_back_39
  s_sub_u32 s61, s61, 1
  s_cbranch_scc0 L_spin_40
  s_branch L_back_39
L_spin_41:
  s_movk_i32 s61, 0x3fff
L_spin_43:
  buffer_load_dword v17, v6, s[36:39], s70 offen offset:0 sc1
  s_waitcnt vmcnt(0)
  v_cmp_gt_u32 vcc, 0x500, v17
  s_cbranch_vccz L_back_42
  s_sub_u32 s61, s61, 1
  s_cbranch_scc0 L_spin_43
  s_branch L_back_42
L_xspin_44:
  s_movk_i32 s61, 0x3fff
L_xspin_46:
  buffer_load_dwordx4 v[244:247], v21, s[36:39], s75 offen offset:0 sc1
  buffer_load_dwordx4 v[248:251], v21, s[36:39], s75 offen offset:1024 sc1
  buffer_load_dword v252, v6, s[36:39], s70 offen sc1
  s_waitcnt vmcnt(0)
  v_and_b32 v0, v244, v248
  v_lshlrev_b32 v0, 31, v0
  v_min_u32 v0, v0, v252
  v_cmp_gt_u32 vcc, 0x600, v0
  s_cbranch_vccz L_xback_45
  s_sub_u32 s61, s61, 1
  s_cbranch_scc0 L_xspin_46
  s_branch L_xback_45
L_spin_47:
  s_movk_i32 s61, 0x3fff
L_spin_49:
  buffer_load_dword v17, v6, s[36:39], s70 offen offset:64 sc1
  s_waitcnt vmcnt(0)
  v_cmp_gt_u32 vcc, 0x1, v17
  s_cbranch_vccz L_back_48
  s_sub_u32 s61, s61, 1
  s_cbranch_scc0 L_spin_49
  s_branch L_back_48
L_spin_50:
  s_movk_i32 s61, 0x3fff
L_spin_52:
  buffer_load_dword v252, v6, s[36:39], s70 offen offset:128 sc1
  s_waitcnt vmcnt(0)
  v_cmp_gt_u32 vcc, 0x1, v252
  s_cbranch_vccz L_back_51
  s_sub_u32 s61, s61, 1
  s_cbranch_scc0 L_spin_52
  s_branch L_back_51
L_spin_53:
  s_movk_i32 s61, 0x3fff
L_spin_55:
  buffer_load_dword v253, v9, s[36:39], s70 offen offset:192 sc1
  s_waitcnt vmcnt(0)
  v_cmp_gt_u32 vcc, 0x1, v253
  s_cbranch_vccz L_back_54
  s_sub_u32 s61, s61, 1
  s_cbranch_scc0 L_spin_55
  s_branch L_back_54
L_spin_56:
  s_movk_i32 s61, 0x3fff
L_spin_58:
  buffer_load_dword v254, v9, s[36:39], s70 offen offset:256 sc1
  s_waitcnt vmcnt(0)
  v_cmp_gt_u32 vcc, 0x1, v254
  s_cbranch_vccz L_back_57
  s_sub_u32 s61, s61, 1
  s_cbranch_scc0 L_spin_58
  s_branch L_back_57
L_spin_59:
  s_movk_i32 s61, 0x3fff
L_spin_61:
  buffer_load_dword v255, v9, s[36:39], s70 offen offset:320 sc1
  s_waitcnt vmcnt(0)
  v_cmp_gt_u32 vcc, 0x1, v255
  s_cbranch_vccz L_back_60
  s_sub_u32 s61, s61, 1
  s_cbranch_scc0 L_spin_61
  s_branch L_back_60
L_xspin_62:
  s_movk_i32 s61, 0x3fff
L_xspin_64:
  buffer_load_dwordx4 v[244:247], v21, s[36:39], s75 offen offset:0 sc1
  buffer_load_dwordx4 v[248:251], v21, s[36:39], s75 offen offset:1024 sc1
  buffer_load_dword v252, v6, s[36:39], s70 offen sc1
  s_waitcnt vmcnt(0)
  v_and_b32 v0, v244, v248
  v_lshlrev_b32 v0, 31, v0
  v_min_u32 v0, v0, v252
  v_cmp_gt_u32 vcc, 0x600, v0
  s_cbranch_vccz L_xback_63
  s_sub_u32 s61, s61, 1
  s_cbranch_scc0 L_xspin_64
  s_branch L_xback_63
L_split_s:
  s_waitcnt vmcnt(4)
L_kvp_7_s:
  v_min3_f32 v30, v131, v135, v139
  v_min3_f32 v31, v143, v147, v151
  v_min_f32 v30, v30, v31
  v_cvt_pk_bf16_f32 v152, v128, v129
  v_cvt_pk_bf16_f32 v153, v130, v132
  v_cvt_pk_bf16_f32 v154, v133, v134
  v_cvt_pk_bf16_f32 v155, v136, v137
  v_cmp_neq_f32 vcc, s55, v30
  s_nop 0
  v_mfma_f32_32x32x16_bf16 v[224:239], v[152:155], v[64:67], 0
  v_cvt_pk_bf16_f32 v156, v140, v141
  v_cvt_pk_bf16_f32 v157, v142, v144
  v_cvt_pk_bf16_f32 v158, v145, v146
  v_cvt_pk_bf16_f32 v159, v148, v149
  s_cbranch_vccz L_kvd_8_s
  s_sub_u32 s61, s61, 1
  s_cbranch_scc1 L_kvd_8_s
  buffer_load_dwordx4 v[128:131], v9, s[36:39], s60 offen offset:0 sc1
  buffer_load_dwordx4 v[132:135], v9, s[36:39], s60 offen offset:544 sc1
  buffer_load_dwordx4 v[136:139], v9, s[36:39], s60 offen offset:1088 sc1
  buffer_load_dwordx4 v[140:143], v9, s[36:39], s60 offen offset:1632 sc1
  buffer_load_dwordx4 v[144:147], v9, s[36:39], s60 offen offset:2176 sc1
  buffer_load_dwordx4 v[148:151], v9, s[36:39], s60 offen offset:2720 sc1
  s_waitcnt vmcnt(0)
  s_branch L_kvp_7_s
L_kvd_8_s:
  v_mfma_f32_32x32x16_bf16 v[240:255], v[156:159], v[68:71], 0
  v_add_f32 v232, s56, v232
  v_rcp_f32 v232, v232
  s_nop 0
  v_pk_mul_f32 v[224:225], v[224:225], v[232:233] op_sel_hi:[1,0]
  v_pk_mul_f32 v[226:227], v[226:227], v[232:233] op_sel_hi:[1,0]
  v_pk_mul_f32 v[228:229], v[228:229], v[232:233] op_sel_hi:[1,0]
  v_pk_mul_f32 v[230:231], v[230:231], v[232:233] op_sel_hi:[1,0]
  v_cvt_pk_bf16_f32 v72, v224, v225
  v_cvt_pk_bf16_f32 v73, v226, v227
  v_cvt_pk_bf16_f32 v74, v228, v229
  v_cvt_pk_bf16_f32 v75, v230, v231
  s_nop 0
  v_add_f32 v248, s56, v248
  v_rcp_f32 v248, v248
  s_nop 0
  v_pk_mul_f32 v[240:241], v[240:241], v[248:249] op_sel_hi:[1,0]
  v_pk_mul_f32 v[242:243], v[242:243], v[248:249] op_sel_hi:[1,0]
  v_pk_mul_f32 v[244:245], v[244:245], v[248:249] op_sel_hi:[1,0]
  v_pk_mul_f32 v[246:247], v[246:247], v[248:249] op_sel_hi:[1,0]
  v_cvt_pk_bf16_f32 v76, v240, v241
  v_cvt_pk_bf16_f32 v77, v242, v243
  v_cvt_pk_bf16_f32 v78, v244, v245
  v_cvt_pk_bf16_f32 v79, v246, v247
  buffer_store_dwordx4 v[72:75], v2, s[36:39], s54 offen offset:0 sc1
  buffer_store_dwordx4 v[76:79], v2, s[36:39], s54 offen offset:1024 sc1
  s_barrier
  ds_read_b64_tr_b16 a[0:1], v104 offset:0
  ds_read_b64_tr_b16 a[2:3], v104 offset:1024
  ds_read_b64_tr_b16 a[4:5], v105 offset:0
  ds_read_b64_tr_b16 a[6:7], v105 offset:1024
  ds_read_b64_tr_b16 a[8:9], v104 offset:2048
  ds_read_b64_tr_b16 a[10:11], v104 offset:3072
  ds_read_b64_tr_b16 a[12:13], v105 offset:2048
  ds_read_b64_tr_b16 a[14:15], v105 offset:3072
  ds_read_b64_tr_b16 a[16:17], v104 offset:4096
  ds_read_b64_tr_b16 a[18:19], v104 offset:5120
  ds_read_b64_tr_b16 a[20:21], v105 offset:4096
  ds_read_b64_tr_b16 a[22:23], v105 offset:5120
  ds_read_b64_tr_b16 a[24:25], v104 offset:6144
  ds_read_b64_tr_b16 a[26:27], v104 offset:7168
  ds_read_b64_tr_b16 a[28:29], v105 offset:6144
  ds_read_b64_tr_b16 a[30:31], v105 offset:7168
  ds_read_b64_tr_b16 a[32:33], v104 offset:8192
  ds_read_b64_tr_b16 a[34:35], v104 offset:9216
  ds_read_b64_tr_b16 a[36:37], v105 offset:8192
  ds_read_b64_tr_b16 a[38:39], v105 offset:9216
  ds_read_b64_tr_b16 a[40:41], v104 offset:10240
  ds_read_b64_tr_b16 a[42:43], v104 offset:11264
  ds_read_b64_tr_b16 a[44:45], v105 offset:10240
  ds_read_b64_tr_b16 a[46:47], v105 offset:11264
  ds_read_b64_tr_b16 a[48:49], v104 offset:12288
  ds_read_b64_tr_b16 a[50:51], v104 offset:13312
  ds_read_b64_tr_b16 a[52:53], v105 offset:12288
  ds_read_b64_tr_b16 a[54:55], v105 offset:13312
  ds_read_b64_tr_b16 a[56:57], v104 offset:14336
  ds_read_b64_tr_b16 a[58:59], v104 offset:15360
  ds_read_b64_tr_b16 a[60:61], v105 offset:14336
  ds_read_b64_tr_b16 a[62:63], v105 offset:15360
  ds_read_b64_tr_b16 a[64:65], v104 offset:16384
  ds_read_b64_tr_b16 a[66:67], v104 offset:17408
  ds_read_b64_tr_b16 a[68:69], v105 offset:16384
  ds_read_b64_tr_b16 a[70:71], v105 offset:17408
  ds_read_b64_tr_b16 a[72:73], v104 offset:18432
  ds_read_b64_tr_b16 a[74:75], v104 offset:19456
  ds_read_b64_tr_b16 a[76:77], v105 offset:18432
  ds_read_b64_tr_b16 a[78:79], v105 offset:19456
  s_waitcnt vmcnt(0)
  buffer_store_dword v18, off, s[36:39], s72 offset:0 sc1
  s_xor_b32 s26, s50, 2
  s_mul_i32 s26, s26, 229376
  s_add_u32 m0, s63, 49152
  s_add_u32 s27, s26, 27648
  buffer_load_dwordx4 v4, s[20:23], s26 offen lds
  buffer_load_dwordx4 v4, s[20:23], s27 offen offset:1024 lds
  s_xor_b32 s26, s50, 3
  s_mul_i32 s26, s26, 229376
  s_add_u32 m0, s63, 57344
  s_add_u32 s27, s26, 27648
  buffer_load_dwordx4 v4, s[20:23], s26 offen lds
  buffer_load_dwordx4 v4, s[20:23], s27 offen offset:1024 lds
  s_xor_b32 s26, s50, 4
  s_mul_i32 s26, s26, 229376
  s_add_u32 m0, s63, 65536
  s_add_u32 s27, s26, 27648
  buffer_load_dwordx4 v4, s[20:23], s26 offen lds
  buffer_load_dwordx4 v4, s[20:23], s27 offen offset:1024 lds
  s_xor_b32 s26, s50, 5
  s_mul_i32 s26, s26, 229376
  s_add_u32 m0, s63, 73728
  s_add_u32 s27, s26, 27648
  buffer_load_dwordx4 v4, s[20:23], s26 offen lds
  buffer_load_dwordx4 v4, s[20:23], s27 offen offset:1024 lds
  ds_read_b64_tr_b16 a[80:81], v104 offset:20480
  ds_read_b64_tr_b16 a[82:83], v104 offset:21504
  ds_read_b64_tr_b16 a[84:85], v105 offset:20480
  ds_read_b64_tr_b16 a[86:87], v105 offset:21504
  ds_read_b64_tr_b16 a[88:89], v104 offset:22528
  ds_read_b64_tr_b16 a[90:91], v104 offset:23552
  ds_read_b64_tr_b16 a[92:93], v105 offset:22528
  ds_read_b64_tr_b16 a[94:95], v105 offset:23552
  ds_read_b64_tr_b16 a[96:97], v104 offset:24576
  ds_read_b64_tr_b16 a[98:99], v104 offset:25600
  ds_read_b64_tr_b16 a[100:101], v105 offset:24576
  ds_read_b64_tr_b16 a[102:103], v105 offset:25600
  ds_read_b64_tr_b16 a[104:105], v104 offset:26624
  ds_read_b64_tr_b16 a[106:107], v104 offset:27648
  ds_read_b64_tr_b16 a[108:109], v105 offset:26624
  ds_read_b64_tr_b16 a[110:111], v105 offset:27648
  buffer_load_dword v31, v12, s[36:39], s51 offen sc1
  ds_read_b64_tr_b16 a[112:113], v104 offset:28672
  ds_read_b64_tr_b16 a[114:115], v104 offset:29696
  ds_read_b64_tr_b16 a[116:117], v105 offset:28672
  ds_read_b64_tr_b16 a[118:119], v105 offset:29696
  ds_read_b64_tr_b16 a[120:121], v104 offset:30720
  ds_read_b64_tr_b16 a[122:123], v104 offset:31744
  ds_read_b64_tr_b16 a[124:125], v105 offset:30720
  ds_read_b64_tr_b16 a[126:127], v105 offset:31744
  s_add_u32 s58, s62, 147456
  v_add_u32 v106, s58, v2
  v_xor_b32 v107, 0x1000, v106
  v_mov_b32 v22, 0
  v_mov_b32 v23, 0
  v_lshrrev_b32 v30, 5, v1
  v_lshl_add_u32 v108, v30, 2, v108
  s_lshl_b32 s58, s99, 1
  s_add_u32 s99, s58, s71
  s_xor_b32 s58, s99, 1
  s_lshl_b32 s58, s58, 6
  v_xor_b32 v5, s58, v5
  s_waitcnt lgkmcnt(0)
  s_barrier
  s_waitcnt vmcnt(0)
  v_cmp_gt_u32 vcc, 0x1, v31
  s_cbranch_vccnz L_spin_9_s
L_back_10_s:
  s_xor_b32 s57, s70, 0
  buffer_load_dwordx4 v[128:131], v2, s[36:39], s57 offen offset:0 sc1
  buffer_load_dwordx4 v[132:135], v2, s[36:39], s57 offen offset:1024 sc1
  s_xor_b32 s57, s70, 2048
  buffer_load_dwordx4 v[136:139], v2, s[36:39], s57 offen offset:0 sc1
  buffer_load_dwordx4 v[140:143], v2, s[36:39], s57 offen offset:1024 sc1
  s_xor_b32 s57, s70, 4096
  buffer_load_dwordx4 v[144:147], v2, s[36:39], s57 offen offset:0 sc1
  buffer_load_dwordx4 v[148:151], v2, s[36:39], s57 offen offset:1024 sc1
  s_xor_b32 s57, s70, 6144
  buffer_load_dwordx4 v[152:155], v2, s[36:39], s57 offen offset:0 sc1
  buffer_load_dwordx4 v[156:159], v2, s[36:39], s57 offen offset:1024 sc1
  s_lshl_b32 s58, s73, 2
  s_add_u32 s51, s74, s58
  s_waitcnt vmcnt(7)
  v_mfma_f32_32x32x16_bf16 v[48:63], a[4:7], v[128:131], 0
  s_xor_b32 s57, s70, 8192
  buffer_load_dwordx4 v[160:163], v2, s[36:39], s57 offen offset:0 sc1
  v_mfma_f32_32x32x16_bf16 v[32:47], a[0:3], v[128:131], v[32:47]
  s_waitcnt vmcnt(7)
  v_mfma_f32_32x32x16_bf16 v[48:63], a[12:15], v[132:135], v[48:63]
  buffer_load_dwordx4 v[164:167], v2, s[36:39], s57 offen offset:1024 sc1
  v_mfma_f32_32x32x16_bf16 v[32:47], a[8:11], v[132:135], v[32:47]
  s_waitcnt vmcnt(7)
  v_mfma_f32_32x32x16_bf16 v[48:63], a[20:23], v[136:139], v[48:63]
  s_xor_b32 s57, s70, 10240
  buffer_load_dwordx4 v[168:171], v2, s[36:39], s57 offen offset:0 sc1
  v_mfma_f32_32x32x16_bf16 v[32:47], a[16:19], v[136:139], v[32:47]
  s_waitcnt vmcnt(7)
  v_mfma_f32_32x32x16_bf16 v[48:63], a[28:31], v[140:143], v[48:63]
  buffer_load_dwordx4 v[172:175], v2, s[36:39], s57 offen offset:1024 sc1
  v_mfma_f32_32x32x16_bf16 v[32:47], a[24:27], v[140:143], v[32:47]
  s_waitcnt vmcnt(7)
  v_mfma_f32_32x32x16_bf16 v[48:63], a[36:39], v[144:147], v[48:63]
  s_xor_b32 s57, s70, 12288
  buffer_load_dwordx4 v[176:179], v2, s[36:39], s57 offen offset:0 sc1
  v_mfma_f32_32x32x16_bf16 v[32:47], a[32:35], v[144:147], v[32:47]
  s_waitcnt vmcnt(7)
  v_mfma_f32_32x32x16_bf16 v[48:63], a[44:47], v[148:151], v[48:63]
  buffer_load_dwordx4 v[180:183], v2, s[36:39], s57 offen offset:1024 sc1
  v_mfma_f32_32x32x16_bf16 v[32:47], a[40:43], v[148:151], v[32:47]
  s_waitcnt vmcnt(7)
  v_mfma_f32_32x32x16_bf16 v[48:63], a[52:55], v[152:155], v[48:63]
  s_xor_b32 s57, s70, 14336
  buffer_load_dwordx4 v[184:187], v2, s[36:39], s57 offen offset:0 sc1
  v_mfma_f32_32x32x16_bf16 v[32:47], a[48:51], v[152:155], v[32:47]
  s_waitcnt vmcnt(7)
  v_mfma_f32_32x32x16_bf16 v[48:63], a[60:63], v[156:159], v[48:63]
  buffer_load_dwordx4 v[188:191], v2, s[36:39], s57 offen offset:1024 sc1
  v_mfma_f32_32x32x16_bf16 v[32:47], a[56:59], v[156:159], v[32:47]
  s_waitcnt vmcnt(7)
  v_mfma_f32_32x32x16_bf16 v[48:63], a[68:71], v[160:163], v[48:63]
  s_xor_b32 s26, s50, 6
  s_mul_i32 s26, s26, 229376
  s_add_u32 m0, s63, 81920
  s_add_u32 s27, s26, 27648
  buffer_load_dwordx4 v4, s[20:23], s26 offen lds
  v_mfma_f32_32x32x16_bf16 v[32:47], a[64:67], v[160:163], v[32:47]
  s_waitcnt vmcnt(7)
  buffer_load_dwordx4 v4, s[20:23], s27 offen offset:1024 lds
  v_mfma_f32_32x32x16_bf16 v[48:63], a[76:79], v[164:167], v[48:63]
  s_xor_b32 s26, s50, 7
  s_mul_i32 s26, s26, 229376
  s_add_u32 m0, s63, 90112
  s_add_u32 s27, s26, 27648
  buffer_load_dwordx4 v4, s[20:23], s26 offen lds
  v_mfma_f32_32x32x16_bf16 v[32:47], a[72:75], v[164:167], v[32:47]
  s_waitcnt vmcnt(8)
  buffer_load_dwordx4 v4, s[20:23], s27 offen offset:1024 lds
  v_mfma_f32_32x32x16_bf16 v[48:63], a[84:87], v[168:171], v[48:63]
  s_xor_b32 s26, s50, 0
  s_mul_i32 s26, s26, 229376
  s_add_u32 m0, s63, 0
  s_add_u32 s27, s26, 27648
  buffer_load_dwordx4 v7, s[20:23], s26 offen lds
  v_mfma_f32_32x32x16_bf16 v[32:47], a[80:83], v[168:171], v[32:47]
  s_waitcnt vmcnt(9)
  buffer_load_dwordx4 v7, s[20:23], s27 offen offset:1024 lds
  v_mfma_f32_32x32x16_bf16 v[48:63], a[92:95], v[172:175], v[48:63]
  s_xor_b32 s26, s50, 1
  s_mul_i32 s26, s26, 229376
  s_add_u32 m0, s63, 8192
  s_add_u32 s27, s26, 27648
  buffer_load_dwordx4 v7, s[20:23], s26 offen lds
  v_mfma_f32_32x32x16_bf16 v[32:47], a[88:91], v[172:175], v[32:47]
  s_waitcnt vmcnt(10)
  buffer_load_dwordx4 v7, s[20:23], s27 offen offset:1024 lds
  v_mfma_f32_32x32x16_bf16 v[48:63], a[100:103], v[176:179], v[48:63]
  s_lshl_b32 s26, s2, 2
  s_add_u32 s26, s26, s3
  s_mul_i32 s26, s26, 1792
  v_min_u32 v0, 13, v1
  v_lshlrev_b32 v0, 7, v0
  v_mfma_f32_32x32x16_bf16 v[32:47], a[96:99], v[176:179], v[32:47]
  s_waitcnt vmcnt(10)
  buffer_load_dword a249, v0, s[16:19], s26 offen
  v_mfma_f32_32x32x16_bf16 v[48:63], a[108:111], v[180:183], v[48:63]
  s_waitcnt vmcnt(10)
  v_mfma_f32_32x32x16_bf16 v[48:63], a[116:119], v[184:187], v[48:63]
  s_waitcnt vmcnt(9)
  v_mfma_f32_32x32x16_bf16 v[48:63], a[124:127], v[188:191], v[48:63]
  v_mfma_f32_32x32x16_bf16 v[32:47], a[104:107], v[180:183], v[32:47]
  v_mfma_f32_32x32x16_bf16 v[32:47], a[112:115], v[184:187], v[32:47]
  s_nop 9
  ds_write_b128 v106, v[48:51] offset:0
  ds_write_b128 v106, v[52:55] offset:1024
  v_mfma_f32_32x32x16_bf16 v[32:47], a[120:123], v[188:191], v[32:47]
  s_waitcnt vmcnt(5)
  ds_write_b128 v106, v[56:59] offset:2048
  ds_write_b128 v106, v[60:63] offset:3072
  s_waitcnt lgkmcnt(0)
  s_barrier
  ds_read_b128 v[48:51], v107 offset:0
  ds_read_b128 v[52:55], v107 offset:1024
  ds_read_b128 v[56:59], v107 offset:2048
  ds_read_b128 v[60:63], v107 offset:3072
  s_waitcnt lgkmcnt(3)
  s_nop 1
  v_pk_add_f32 v[32:33], v[32:33], v[48:49]
  v_pk_add_f32 v[34:35], v[34:35], v[50:51]
  s_waitcnt lgkmcnt(2)
  v_pk_add_f32 v[36:37], v[36:37], v[52:53]
  v_pk_add_f32 v[38:39], v[38:39], v[54:55]
  v_cvt_pk_bf16_f32 v96, v32, v33
  v_cvt_pk_bf16_f32 v97, v34, v35
  v_cvt_pk_bf16_f32 v98, v36, v37
  v_cvt_pk_bf16_f32 v99, v38, v39
  buffer_store_dwordx4 v[96:99], v2, s[28:31], s76 offen offset:0 sc1
  s_waitcnt lgkmcnt(1)
  v_pk_add_f32 v[40:41], v[40:41], v[56:57]
  v_pk_add_f32 v[42:43], v[42:43], v[58:59]
  s_waitcnt lgkmcnt(0)
  v_pk_add_f32 v[44:45], v[44:45], v[60:61]
  v_pk_add_f32 v[46:47], v[46:47], v[62:63]
  v_cvt_pk_bf16_f32 v100, v40, v41
  v_cvt_pk_bf16_f32 v101, v42, v43
  v_cvt_pk_bf16_f32 v102, v44, v45
  v_cvt_pk_bf16_f32 v103, v46, v47
  buffer_store_dwordx4 v[100:103], v2, s[28:31], s76 offen offset:1024 sc1
  v_dot2c_f32_bf16 v22, s44, v96
  v_dot2c_f32_bf16 v23, v96, v96
  v_dot2c_f32_bf16 v22, s44, v97
  v_dot2c_f32_bf16 v23, v97, v97
  v_dot2c_f32_bf16 v22, s44, v98
  v_dot2c_f32_bf16 v23, v98, v98
  v_dot2c_f32_bf16 v22, s44, v99
  v_dot2c_f32_bf16 v23, v99, v99
  v_dot2c_f32_bf16 v22, s44, v100
  v_dot2c_f32_bf16 v23, v100, v100
  v_dot2c_f32_bf16 v22, s44, v101
  v_dot2c_f32_bf16 v23, v101, v101
  v_dot2c_f32_bf16 v22, s44, v102
  v_dot2c_f32_bf16 v23, v102, v102
  v_dot2c_f32_bf16 v22, s44, v103
  v_dot2c_f32_bf16 v23, v103, v103
  s_nop 2
  v_permlane32_swap_b32 v22, v23
  v_add_f32 v22, v22, v23
  buffer_store_dword v22, v108, s[36:39], s77 offen sc1
  s_xor_b32 s26, s50, 2
  s_mul_i32 s26, s26, 229376
  s_add_u32 m0, s63, 16384
  s_add_u32 s27, s26, 27648
  buffer_load_dwordx4 v7, s[20:23], s26 offen lds
  buffer_load_dwordx4 v7, s[20:23], s27 offen offset:1024 lds
  s_xor_b32 s26, s50, 3
  s_mul_i32 s26, s26, 229376
  s_add_u32 m0, s63, 24576
  s_add_u32 s27, s26, 27648
  buffer_load_dwordx4 v7, s[20:23], s26 offen lds
  buffer_load_dwordx4 v7, s[20:23], s27 offen offset:1024 lds
  v_accvgpr_read_b32 v14, a133
  s_lshl_b32 s57, s64, 15
  v_add_u32 v21, s57, v2
  s_lshl_b32 s70, s64, 9
  s_add_u32 s70, s70, 65536
  v_xor_b32 v15, 64, v14
  v_add_u32 v10, 0x8000, v14
  v_add_u32 v11, 0x8000, v15
  v_add_u32 v240, s63, v14
  v_add_u32 v241, s63, v15
  v_add_u32 v242, s63, v2
  s_lshl_b32 s58, s50, 12
  s_add_u32 s58, s58, s57
  s_add_u32 s73, s58, 0
  s_waitcnt vmcnt(4)
  buffer_store_dword v18, off, s[36:39], s51 offset:64 sc1
  s_cmp_ge_u32 s2, 224
  s_cbranch_scc1 L_idle_s
  s_xor_b32 s26, s50, 4
  s_mul_i32 s26, s26, 229376
  s_add_u32 m0, s63, 98304
  s_add_u32 s27, s26, 27648
  buffer_load_dwordx4 v7, s[20:23], s26 offen lds
  buffer_load_dwordx4 v7, s[20:23], s27 offen offset:1024 lds
  s_xor_b32 s26, s50, 5
  s_mul_i32 s26, s26, 229376
  s_add_u32 m0, s63, 106496
  s_add_u32 s27, s26, 27648
  buffer_load_dwordx4 v7, s[20:23], s26 offen lds
  buffer_load_dwordx4 v7, s[20:23], s27 offen offset:1024 lds
  s_xor_b32 s26, s50, 6
  s_mul_i32 s26, s26, 229376
  s_add_u32 m0, s63, 114688
  s_add_u32 s27, s26, 27648
  buffer_load_dwordx4 v7, s[20:23], s26 offen lds
  buffer_load_dwordx4 v7, s[20:23], s27 offen offset:1024 lds
  s_xor_b32 s26, s50, 7
  s_mul_i32 s26, s26, 229376
  s_add_u32 m0, s63, 122880
  s_add_u32 s27, s26, 27648
  buffer_load_dwordx4 v7, s[20:23], s26 offen lds
  buffer_load_dwordx4 v7, s[20:23], s27 offen offset:1024 lds
  buffer_load_dword v17, v6, s[36:39], s70 offen offset:64 sc1
  v_add_u32 v22, 0x18000, v240
  v_add_u32 v23, 0x18000, v241
  v_add_u32 v31, 0x18000, v242
  v_add_u32 v12, 0x20000, v14
  v_add_u32 v13, 0x20000, v15
  v_add_u32 v16, 0x18000, v2
  v_min_u32 v9, 6, v1
  s_mul_i32 s57, s71, 28
  v_lshl_add_u32 v9, v9, 2, s57
  v_and_b32 v20, 0x1f0, v2
  v_lshrrev_b32 v30, 5, v1
  v_lshlrev_b32 v30, 4, v30
  v_lshl_add_u32 v19, v20, 6, v30
  s_lshl_b32 s57, s5, 11
  s_add_u32 s74, s57, 1048576
  s_mul_i32 s57, s71, -28672
  s_add_u32 s57, s57, s74
  s_add_u32 s57, s57, 14336
  s_xor_b32 s75, s74, 0x800
  s_cmp_lt_u32 s5, 14
  s_cselect_b32 s75, s57, s75
  s_mov_b32 s52, 0x3f3504f3
  s_mov_b32 s53, 0x3f3504f3
  s_mov_b64 s[32:33], s[36:37]
  v_add_u32 v3, 0x100000, v21
  v_add_u32 v4, 0x0, v21
  v_add_u32 v7, 0x100000, v21
  v_add_u32 v8, 0x0, v21
  s_bfe_u32 s8, s94, 0x40000
  s_lshl_b32 s8, s8, 11
  s_bfe_u32 s9, s94, 0x40004
  s_lshl_b32 s9, s9, 11
  s_bfe_u32 s10, s94, 0x40008
  s_lshl_b32 s10, s10, 11
  s_bfe_u32 s11, s94, 0x4000c
  s_lshl_b32 s11, s11, 11
  s_bfe_u32 s12, s94, 0x40010
  s_lshl_b32 s12, s12, 11
  s_bfe_u32 s13, s94, 0x40014
  s_lshl_b32 s13, s13, 11
  s_bfe_u32 s14, s94, 0x40018
  s_lshl_b32 s14, s14, 11
  s_lshl_b32 s57, s64, 12
  s_add_u32 s57, s57, 262144
  v_lshl_add_u32 v30, v30, 7, v20
  s_lshl_b32 s60, s5, 11
  s_add_u32 s60, s60, 98304
  ds_read_b64_tr_b16 v[96:97], v10 offset:0
  ds_read_b64_tr_b16 v[98:99], v10 offset:1024
  ds_read_b64_tr_b16 v[100:101], v11 offset:0
  ds_read_b64_tr_b16 v[102:103], v11 offset:1024
  ds_read_b64_tr_b16 v[104:105], v10 offset:2048
  ds_read_b64_tr_b16 v[106:107], v10 offset:3072
  ds_read_b64_tr_b16 v[108:109], v11 offset:2048
  ds_read_b64_tr_b16 v[110:111], v11 offset:3072
  ds_read_b64_tr_b16 v[112:113], v10 offset:4096
  ds_read_b64_tr_b16 v[114:115], v10 offset:5120
  ds_read_b64_tr_b16 v[116:117], v11 offset:4096
  ds_read_b64_tr_b16 v[118:119], v11 offset:5120
  ds_read_b64_tr_b16 v[120:121], v10 offset:6144
  ds_read_b64_tr_b16 v[122:123], v10 offset:7168
  ds_read_b64_tr_b16 v[124:125], v11 offset:6144
  ds_read_b64_tr_b16 v[126:127], v11 offset:7168
  s_waitcnt vmcnt(0)
  v_cmp_gt_u32 vcc, 0x1, v17
  s_cbranch_vccnz L_spin_12_s
L_back_13_s:
  s_xor_b32 s59, s73, 0
  buffer_load_dwordx4 a[0:3], v2, s[28:31], s59 offen offset:0 sc1
  buffer_load_dwordx4 a[4:7], v2, s[28:31], s59 offen offset:1024 sc1
  buffer_load_dwordx4 a[8:11], v2, s[28:31], s59 offen offset:2048 sc1
  buffer_load_dwordx4 a[12:15], v2, s[28:31], s59 offen offset:3072 sc1
  s_xor_b32 s59, s73, 4096
  buffer_load_dwordx4 a[16:19], v2, s[28:31], s59 offen offset:0 sc1
  buffer_load_dwordx4 a[20:23], v2, s[28:31], s59 offen offset:1024 sc1
  buffer_load_dwordx4 a[24:27], v2, s[28:31], s59 offen offset:2048 sc1
  buffer_load_dwordx4 a[28:31], v2, s[28:31], s59 offen offset:3072 sc1
  ds_read_b64_tr_b16 v[160:161], v240 offset:0
  ds_read_b64_tr_b16 v[162:163], v240 offset:1024
  ds_read_b64_tr_b16 v[164:165], v241 offset:0
  ds_read_b64_tr_b16 v[166:167], v241 offset:1024
  ds_read_b64_tr_b16 v[168:169], v240 offset:8192
  ds_read_b64_tr_b16 v[170:171], v240 offset:9216
  ds_read_b64_tr_b16 v[172:173], v241 offset:8192
  ds_read_b64_tr_b16 v[174:175], v241 offset:9216
  s_waitcnt lgkmcnt(6)
  ds_write_b128 v242, v[160:163] offset:0
  s_waitcnt lgkmcnt(5)
  ds_write_b128 v242, v[164:167] offset:1024
  s_waitcnt lgkmcnt(4)
  ds_write_b128 v242, v[168:171] offset:8192
  s_waitcnt lgkmcnt(3)
  ds_write_b128 v242, v[172:175] offset:9216
  s_waitcnt vmcnt(7)
  v_mfma_f32_32x32x16_bf16 v[32:47], v[96:99], a[0:3], 0
  ds_read_b64_tr_b16 v[96:97], v10 offset:8192
  ds_read_b64_tr_b16 v[98:99], v10 offset:9216
  s_xor_b32 s59, s73, 8192
  buffer_load_dwordx4 a[32:35], v2, s[28:31], s59 offen offset:0 sc1
  v_mfma_f32_32x32x16_bf16 v[48:63], v[100:103], a[0:3], 0
  s_waitcnt vmcnt(7)
  ds_read_b64_tr_b16 v[100:101], v11 offset:8192
  ds_read_b64_tr_b16 v[102:103], v11 offset:9216
  ds_read_b64_tr_b16 v[176:177], v240 offset:16384
  ds_read_b64_tr_b16 v[178:179], v240 offset:17408
  v_mfma_f32_32x32x16_bf16 v[32:47], v[104:107], a[4:7], v[32:47]
  ds_read_b64_tr_b16 v[104:105], v10 offset:10240
  ds_read_b64_tr_b16 v[106:107], v10 offset:11264
  buffer_load_dwordx4 a[36:39], v2, s[28:31], s59 offen offset:1024 sc1
  v_mfma_f32_32x32x16_bf16 v[48:63], v[108:111], a[4:7], v[48:63]
  s_waitcnt vmcnt(7)
  ds_read_b64_tr_b16 v[108:109], v11 offset:10240
  ds_read_b64_tr_b16 v[110:111], v11 offset:11264
  ds_read_b64_tr_b16 v[180:181], v241 offset:16384
  ds_read_b64_tr_b16 v[182:183], v241 offset:17408
  v_mfma_f32_32x32x16_bf16 v[32:47], v[112:115], a[8:11], v[32:47]
  ds_read_b64_tr_b16 v[112:113], v10 offset:12288
  ds_read_b64_tr_b16 v[114:115], v10 offset:13312
  buffer_load_dwordx4 a[40:43], v2, s[28:31], s59 offen offset:2048 sc1
  v_mfma_f32_32x32x16_bf16 v[48:63], v[116:119], a[8:11], v[48:63]
  s_waitcnt vmcnt(7)
  ds_read_b64_tr_b16 v[116:117], v11 offset:12288
  ds_read_b64_tr_b16 v[118:119], v11 offset:13312
  ds_read_b64_tr_b16 v[184:185], v240 offset:24576
  ds_read_b64_tr_b16 v[186:187], v240 offset:25600
  v_mfma_f32_32x32x16_bf16 v[32:47], v[120:123], a[12:15], v[32:47]
  ds_read_b64_tr_b16 v[120:121], v10 offset:14336
  ds_read_b64_tr_b16 v[122:123], v10 offset:15360
  buffer_load_dwordx4 a[44:47], v2, s[28:31], s59 offen offset:3072 sc1
  v_mfma_f32_32x32x16_bf16 v[48:63], v[124:127], a[12:15], v[48:63]
  s_waitcnt vmcnt(7) lgkmcnt(14)
  ds_read_b64_tr_b16 v[124:125], v11 offset:14336
  ds_read_b64_tr_b16 v[126:127], v11 offset:15360
  ds_read_b64_tr_b16 v[188:189], v241 offset:24576
  ds_read_b64_tr_b16 v[190:191], v241 offset:25600
  v_mfma_f32_32x32x16_bf16 v[32:47], v[96:99], a[16:19], v[32:47]
  ds_read_b64_tr_b16 v[96:97], v10 offset:16384
  ds_read_b64_tr_b16 v[98:99], v10 offset:17408
  s_xor_b32 s59, s73, 12288
  buffer_load_dwordx4 a[48:51], v2, s[28:31], s59 offen offset:0 sc1
  v_mfma_f32_32x32x16_bf16 v[48:63], v[100:103], a[16:19], v[48:63]
  s_waitcnt vmcnt(7) lgkmcnt(14)
  ds_read_b64_tr_b16 v[100:101], v11 offset:16384
  ds_read_b64_tr_b16 v[102:103], v11 offset:17408
  s_lshl_b32 s58, s99, 11
  s_add_u32 s58, s58, 0
  buffer_load_dwordx4 v[244:247], v21, s[28:31], s58 offen offset:0 sc1
  v_mfma_f32_32x32x16_bf16 v[32:47], v[104:107], a[20:23], v[32:47]
  ds_read_b64_tr_b16 v[104:105], v10 offset:18432
  ds_read_b64_tr_b16 v[106:107], v10 offset:19456
  buffer_load_dwordx4 a[52:55], v2, s[28:31], s59 offen offset:1024 sc1
  ds_write_b128 v242, v[176:179] offset:16384
  ds_write_b128 v242, v[180:183] offset:17408
  v_mfma_f32_32x32x16_bf16 v[48:63], v[108:111], a[20:23], v[48:63]
  s_waitcnt vmcnt(8) lgkmcnt(8)
  ds_read_b64_tr_b16 v[108:109], v11 offset:18432
  ds_read_b64_tr_b16 v[110:111], v11 offset:19456
  buffer_load_dwordx4 v[248:251], v21, s[28:31], s58 offen offset:1024 sc1
  ds_write_b128 v242, v[184:187] offset:24576
  ds_write_b128 v242, v[188:191] offset:25600
  v_mfma_f32_32x32x16_bf16 v[32:47], v[112:115], a[24:27], v[32:47]
  ds_read_b64_tr_b16 v[112:113], v10 offset:20480
  ds_read_b64_tr_b16 v[114:115], v10 offset:21504
  buffer_load_dwordx4 a[56:59], v2, s[28:31], s59 offen offset:2048 sc1
  v_mfma_f32_32x32x16_bf16 v[48:63], v[116:119], a[24:27], v[48:63]
  s_waitcnt vmcnt(9)
  ds_read_b64_tr_b16 v[116:117], v11 offset:20480
  ds_read_b64_tr_b16 v[118:119], v11 offset:21504
  ds_read_b64_tr_b16 v[192:193], v22 offset:0
  ds_read_b64_tr_b16 v[194:195], v22 offset:1024
  v_mfma_f32_32x32x16_bf16 v[32:47], v[120:123], a[28:31], v[32:47]
  ds_read_b64_tr_b16 v[120:121], v10 offset:22528
  ds_read_b64_tr_b16 v[122:123], v10 offset:23552
  buffer_load_dwordx4 a[60:63], v2, s[28:31], s59 offen offset:3072 sc1
  v_mfma_f32_32x32x16_bf16 v[48:63], v[124:127], a[28:31], v[48:63]
  s_waitcnt vmcnt(9) lgkmcnt(14)
  ds_read_b64_tr_b16 v[124:125], v11 offset:22528
  ds_read_b64_tr_b16 v[126:127], v11 offset:23552
  ds_read_b64_tr_b16 v[196:197], v23 offset:0
  ds_read_b64_tr_b16 v[198:199], v23 offset:1024
  v_mfma_f32_32x32x16_bf16 v[32:47], v[96:99], a[32:35], v[32:47]
  ds_read_b64_tr_b16 v[96:97], v10 offset:24576
  ds_read_b64_tr_b16 v[98:99], v10 offset:25600
  s_xor_b32 s59, s73, 16384
  buffer_load_dwordx4 a[64:67], v2, s[28:31], s59 offen offset:0 sc1
  v_mfma_f32_32x32x16_bf16 v[48:63], v[100:103], a[32:35], v[48:63]
  s_waitcnt vmcnt(9)
  ds_read_b64_tr_b16 v[100:101], v11 offset:24576
  ds_read_b64_tr_b16 v[102:103], v11 offset:25600
  buffer_load_dwordx4 v[128:131], v30, s[36:39], s57 offen offset:0 sc1
  ds_read_b64_tr_b16 v[200:201], v22 offset:8192
  ds_read_b64_tr_b16 v[202:203], v22 offset:9216
  v_mfma_f32_32x32x16_bf16 v[32:47], v[104:107], a[36:39], v[32:47]
  s_waitcnt lgkmcnt(14)
  ds_read_b64_tr_b16 v[104:105], v10 offset:26624
  ds_read_b64_tr_b16 v[106:107], v10 offset:27648
  buffer_load_dwordx4 a[68:71], v2, s[28:31], s59 offen offset:1024 sc1
  v_mfma_f32_32x32x16_bf16 v[48:63], v[108:111], a[36:39], v[48:63]
  s_waitcnt vmcnt(10)
  ds_read_b64_tr_b16 v[108:109], v11 offset:26624
  ds_read_b64_tr_b16 v[110:111], v11 offset:27648
  buffer_load_dwordx4 v[132:135], v30, s[36:39], s57 offen offset:512 sc1
  ds_read_b64_tr_b16 v[204:205], v23 offset:8192
  ds_read_b64_tr_b16 v[206:207], v23 offset:9216
  v_mfma_f32_32x32x16_bf16 v[32:47], v[112:115], a[40:43], v[32:47]
  ds_read_b64_tr_b16 v[112:113], v10 offset:28672
  ds_read_b64_tr_b16 v[114:115], v10 offset:29696
  buffer_load_dwordx4 a[72:75], v2, s[28:31], s59 offen offset:2048 sc1
  v_mfma_f32_32x32x16_bf16 v[48:63], v[116:119], a[40:43], v[48:63]
  s_waitcnt vmcnt(11) lgkmcnt(14)
  ds_read_b64_tr_b16 v[116:117], v11 offset:28672
  ds_read_b64_tr_b16 v[118:119], v11 offset:29696
  buffer_load_dwordx4 v[136:139], v30, s[36:39], s57 offen offset:1024 sc1
  ds_write_b128 v31, v[192:195] offset:0
  ds_write_b128 v31, v[196:199] offset:1024
  v_mfma_f32_32x32x16_bf16 v[32:47], v[120:123], a[44:47], v[32:47]
  ds_read_b64_tr_b16 v[120:121], v10 offset:30720
  ds_read_b64_tr_b16 v[122:123], v10 offset:31744
  buffer_load_dwordx4 a[76:79], v2, s[28:31], s59 offen offset:3072 sc1
  v_mfma_f32_32x32x16_bf16 v[48:63], v[124:127], a[44:47], v[48:63]
  s_waitcnt vmcnt(12) lgkmcnt(8)
  ds_read_b64_tr_b16 v[124:125], v11 offset:30720
  ds_read_b64_tr_b16 v[126:127], v11 offset:31744
  buffer_load_dwordx4 v[140:143], v30, s[36:39], s57 offen offset:1536 sc1
  ds_write_b128 v31, v[200:203] offset:8192
  ds_write_b128 v31, v[204:207] offset:9216
  v_mfma_f32_32x32x16_bf16 v[32:47], v[96:99], a[48:51], v[32:47]
  ds_read_b64_tr_b16 v[96:97], v10 offset:32768
  ds_read_b64_tr_b16 v[98:99], v10 offset:33792
  s_xor_b32 s59, s73, 20480
  buffer_load_dwordx4 a[80:83], v2, s[28:31], s59 offen offset:0 sc1
  v_mfma_f32_32x32x16_bf16 v[48:63], v[100:103], a[48:51], v[48:63]
  s_waitcnt vmcnt(12)
  ds_read_b64_tr_b16 v[100:101], v11 offset:32768
  ds_read_b64_tr_b16 v[102:103], v11 offset:33792
  ds_read_b64_tr_b16 v[208:209], v22 offset:16384
  ds_read_b64_tr_b16 v[210:211], v22 offset:17408
  v_mfma_f32_32x32x16_bf16 v[32:47], v[104:107], a[52:55], v[32:47]
  ds_read_b64_tr_b16 v[104:105], v10 offset:34816
  ds_read_b64_tr_b16 v[106:107], v10 offset:35840
  buffer_load_dwordx4 a[84:87], v2, s[28:31], s59 offen offset:1024 sc1
  v_mfma_f32_32x32x16_bf16 v[48:63], v[108:111], a[52:55], v[48:63]
  s_waitcnt vmcnt(11) lgkmcnt(14)
  ds_read_b64_tr_b16 v[108:109], v11 offset:34816
  ds_read_b64_tr_b16 v[110:111], v11 offset:35840
  ds_read_b64_tr_b16 v[212:213], v23 offset:16384
  ds_read_b64_tr_b16 v[214:215], v23 offset:17408
  v_mfma_f32_32x32x16_bf16 v[32:47], v[112:115], a[56:59], v[32:47]
  ds_read_b64_tr_b16 v[112:113], v10 offset:36864
  ds_read_b64_tr_b16 v[114:115], v10 offset:37888
  buffer_load_dwordx4 a[88:91], v2, s[28:31], s59 offen offset:2048 sc1
  v_mfma_f32_32x32x16_bf16 v[48:63], v[116:119], a[56:59], v[48:63]
  s_waitcnt vmcnt(11) lgkmcnt(14)
  ds_read_b64_tr_b16 v[116:117], v11 offset:36864
  ds_read_b64_tr_b16 v[118:119], v11 offset:37888
  ds_read_b64_tr_b16 v[216:217], v22 offset:24576
  ds_read_b64_tr_b16 v[218:219], v22 offset:25600
  v_mfma_f32_32x32x16_bf16 v[32:47], v[120:123], a[60:63], v[32:47]
  ds_read_b64_tr_b16 v[120:121], v10 offset:38912
  ds_read_b64_tr_b16 v[122:123], v10 offset:39936
  buffer_load_dwordx4 a[92:95], v2, s[28:31], s59 offen offset:3072 sc1
  v_lshlrev_b32 v224, 16, v244
  v_and_b32 v225, 0xffff0000, v244
  v_lshlrev_b32 v226, 16, v245
  v_mfma_f32_32x32x16_bf16 v[48:63], v[124:127], a[60:63], v[48:63]
  s_waitcnt vmcnt(11) lgkmcnt(14)
  ds_read_b64_tr_b16 v[124:125], v11 offset:38912
  ds_read_b64_tr_b16 v[126:127], v11 offset:39936
  ds_read_b64_tr_b16 v[220:221], v23 offset:24576
  ds_read_b64_tr_b16 v[222:223], v23 offset:25600
  v_and_b32 v227, 0xffff0000, v245
  v_lshlrev_b32 v228, 16, v246
  v_mfma_f32_32x32x16_bf16 v[32:47], v[96:99], a[64:67], v[32:47]
  ds_read_b64_tr_b16 v[96:97], v10 offset:40960
  ds_read_b64_tr_b16 v[98:99], v10 offset:41984
  s_xor_b32 s59, s73, 24576
  buffer_load_dwordx4 a[96:99], v2, s[28:31], s59 offen offset:0 sc1
  v_and_b32 v229, 0xffff0000, v246
  v_lshlrev_b32 v230, 16, v247
  v_mfma_f32_32x32x16_bf16 v[48:63], v[100:103], a[64:67], v[48:63]
  s_waitcnt vmcnt(10) lgkmcnt(14)
  ds_read_b64_tr_b16 v[100:101], v11 offset:40960
  ds_read_b64_tr_b16 v[102:103], v11 offset:41984
  ds_write_b128 v31, v[208:211] offset:16384
  ds_write_b128 v31, v[212:215] offset:17408
  v_and_b32 v231, 0xffff0000, v247
  v_lshlrev_b32 v232, 16, v248
  v_mfma_f32_32x32x16_bf16 v[32:47], v[104:107], a[68:71], v[32:47]
  ds_read_b64_tr_b16 v[104:105], v10 offset:43008
  ds_read_b64_tr_b16 v[106:107], v10 offset:44032
  buffer_load_dwordx4 a[100:103], v2, s[28:31], s59 offen offset:1024 sc1
  v_and_b32 v233, 0xffff0000, v248
  v_lshlrev_b32 v234, 16, v249
  v_and_b32 v235, 0xffff0000, v249
  v_mfma_f32_32x32x16_bf16 v[48:63], v[108:111], a[68:71], v[48:63]
  s_waitcnt vmcnt(9) lgkmcnt(8)
  ds_read_b64_tr_b16 v[108:109], v11 offset:43008
  ds_read_b64_tr_b16 v[110:111], v11 offset:44032
  ds_write_b128 v31, v[216:219] offset:24576
  ds_write_b128 v31, v[220:223] offset:25600
  v_lshlrev_b32 v236, 16, v250
  v_and_b32 v237, 0xffff0000, v250
  v_mfma_f32_32x32x16_bf16 v[32:47], v[112:115], a[72:75], v[32:47]
  ds_read_b64_tr_b16 v[112:113], v10 offset:45056
  ds_read_b64_tr_b16 v[114:115], v10 offset:46080
  buffer_load_dwordx4 a[104:107], v2, s[28:31], s59 offen offset:2048 sc1
  v_lshlrev_b32 v238, 16, v251
  v_and_b32 v239, 0xffff0000, v251
  v_mfma_f32_32x32x16_bf16 v[48:63], v[116:119], a[72:75], v[48:63]
  s_waitcnt vmcnt(8)
  ds_read_b64_tr_b16 v[116:117], v11 offset:45056
  ds_read_b64_tr_b16 v[118:119], v11 offset:46080
  v_mfma_f32_32x32x16_bf16 v[32:47], v[120:123], a[76:79], v[32:47]
  ds_read_b64_tr_b16 v[120:121], v10 offset:47104
  ds_read_b64_tr_b16 v[122:123], v10 offset:48128
  buffer_load_dwordx4 a[108:111], v2, s[28:31], s59 offen offset:3072 sc1
  v_mfma_f32_32x32x16_bf16 v[48:63], v[124:127], a[76:79], v[48:63]
  s_waitcnt vmcnt(7) lgkmcnt(14)
  ds_read_b64_tr_b16 v[124:125], v11 offset:47104
  ds_read_b64_tr_b16 v[126:127], v11 offset:48128
  v_mfma_f32_32x32x16_bf16 v[32:47], v[96:99], a[80:83], v[32:47]
  ds_read_b64_tr_b16 v[96:97], v10 offset:49152
  ds_read_b64_tr_b16 v[98:99], v10 offset:50176
  s_xor_b32 s59, s73, 28672
  buffer_load_dwordx4 a[112:115], v2, s[28:31], s59 offen offset:0 sc1
  v_add_f32 v128, v128, v130
  v_add_f32 v129, v129, v131
  v_mfma_f32_32x32x16_bf16 v[48:63], v[100:103], a[80:83], v[48:63]
  s_waitcnt vmcnt(7) lgkmcnt(14)
  ds_read_b64_tr_b16 v[100:101], v11 offset:49152
  ds_read_b64_tr_b16 v[102:103], v11 offset:50176
  v_add_f32 v132, v132, v134
  v_add_f32 v133, v133, v135
  v_add_f32 v136, v136, v138
  v_add_f32 v137, v137, v139
  v_mfma_f32_32x32x16_bf16 v[32:47], v[104:107], a[84:87], v[32:47]
  s_waitcnt lgkmcnt(14)
  ds_read_b64_tr_b16 v[104:105], v10 offset:51200
  ds_read_b64_tr_b16 v[106:107], v10 offset:52224
  buffer_load_dwordx4 a[116:119], v2, s[28:31], s59 offen offset:1024 sc1
  v_add_f32 v140, v140, v142
  v_add_f32 v141, v141, v143
  v_add_f32 v128, v128, v132
  v_mfma_f32_32x32x16_bf16 v[48:63], v[108:111], a[84:87], v[48:63]
  s_waitcnt vmcnt(7) lgkmcnt(12)
  ds_read_b64_tr_b16 v[108:109], v11 offset:51200
  ds_read_b64_tr_b16 v[110:111], v11 offset:52224
  v_add_f32 v129, v129, v133
  v_add_f32 v136, v136, v140
  v_add_f32 v137, v137, v141
  v_add_f32 v128, v128, v136
  v_mfma_f32_32x32x16_bf16 v[32:47], v[112:115], a[88:91], v[32:47]
  s_waitcnt lgkmcnt(12)
  ds_read_b64_tr_b16 v[112:113], v10 offset:53248
  ds_read_b64_tr_b16 v[114:115], v10 offset:54272
  buffer_load_dwordx4 a[120:123], v2, s[28:31], s59 offen offset:2048 sc1
  v_add_f32 v129, v129, v137
  v_mov_b32 v27, 0
  s_nop 0
  v_permlane32_swap_b32 v128, v129
  v_mfma_f32_32x32x16_bf16 v[48:63], v[116:119], a[88:91], v[48:63]
  s_waitcnt vmcnt(7) lgkmcnt(12)
  ds_read_b64_tr_b16 v[116:117], v11 offset:53248
  ds_read_b64_tr_b16 v[118:119], v11 offset:54272
  v_add_f32 v128, v128, v129
  v_mov_b32 v129, v128
  s_nop 1
  v_permlane32_swap_b32 v128, v129
  v_mul_f32 v128, 0xbb000000, v128
  v_mfma_f32_32x32x16_bf16 v[32:47], v[120:123], a[92:95], v[32:47]
  s_waitcnt lgkmcnt(12)
  ds_read_b64_tr_b16 v[120:121], v10 offset:55296
  ds_read_b64_tr_b16 v[122:123], v10 offset:56320
  buffer_load_dwordx4 a[124:127], v2, s[28:31], s59 offen offset:3072 sc1
  v_mul_f32 v129, 0x3b000000, v129
  v_fma_f32 v129, -v128, v128, v129
  v_max_f32 v129, 0, v129
  v_mfma_f32_32x32x16_bf16 v[48:63], v[124:127], a[92:95], v[48:63]
  s_waitcnt vmcnt(7) lgkmcnt(12)
  ds_read_b64_tr_b16 v[124:125], v11 offset:55296
  ds_read_b64_tr_b16 v[126:127], v11 offset:56320
  buffer_load_dwordx4 v[144:147], v20, s[36:39], s60 offen offset:0 sc1
  buffer_load_dwordx4 v[148:151], v20, s[36:39], s60 offen offset:512 sc1
  buffer_load_dwordx4 v[152:155], v20, s[36:39], s60 offen offset:1024 sc1
  buffer_load_dwordx4 v[156:159], v20, s[36:39], s60 offen offset:1536 sc1
  v_mfma_f32_32x32x16_bf16 v[32:47], v[96:99], a[96:99], v[32:47]
  s_waitcnt lgkmcnt(12)
  ds_read_b64_tr_b16 v[96:97], v10 offset:57344
  ds_read_b64_tr_b16 v[98:99], v10 offset:58368
  v_add_f32 v129, 0x3727c5ac, v129
  v_rsq_f32 v28, v129
  v_cvt_pk_bf16_f32 v130, v128, v128
  v_mfma_f32_32x32x16_bf16 v[48:63], v[100:103], a[96:99], v[48:63]
  s_waitcnt vmcnt(10) lgkmcnt(12)
  ds_read_b64_tr_b16 v[100:101], v11 offset:57344
  ds_read_b64_tr_b16 v[102:103], v11 offset:58368
  v_mul_f32 v29, 0x3fb8aa3b, v28
  v_mul_f32 v129, v129, v28
  v_lshlrev_b32 v130, 16, v130
  v_sub_f32 v130, v128, v130
  v_mfma_f32_32x32x16_bf16 v[32:47], v[104:107], a[100:103], v[32:47]
  s_waitcnt lgkmcnt(12)
  ds_read_b64_tr_b16 v[104:105], v10 offset:59392
  ds_read_b64_tr_b16 v[106:107], v10 offset:60416
  v_cvt_pk_bf16_f32 v131, v129, v129
  v_cndmask_b32 v128, v128, v130, s[46:47]
  v_lshlrev_b32 v131, 16, v131
  v_cvt_pk_bf16_f32 v24, v128, v128
  v_mfma_f32_32x32x16_bf16 v[48:63], v[108:111], a[100:103], v[48:63]
  s_waitcnt vmcnt(9) lgkmcnt(12)
  ds_read_b64_tr_b16 v[108:109], v11 offset:59392
  ds_read_b64_tr_b16 v[110:111], v11 offset:60416
  v_sub_f32 v131, v129, v131
  v_mov_b32 v26, v24
  v_cndmask_b32 v129, v129, v131, s[46:47]
  v_cvt_pk_bf16_f32 v25, v129, 0
  v_mfma_f32_32x32x16_bf16 v[32:47], v[112:115], a[104:107], v[32:47]
  s_waitcnt lgkmcnt(12)
  ds_read_b64_tr_b16 v[112:113], v10 offset:61440
  ds_read_b64_tr_b16 v[114:115], v10 offset:62464
  v_mfma_f32_32x32x16_bf16 v[48:63], v[116:119], a[104:107], v[48:63]
  s_waitcnt vmcnt(8) lgkmcnt(12)
  ds_read_b64_tr_b16 v[116:117], v11 offset:61440
  ds_read_b64_tr_b16 v[118:119], v11 offset:62464
  v_mfma_f32_32x32x16_bf16 v[32:47], v[120:123], a[108:111], v[32:47]
  s_waitcnt lgkmcnt(12)
  ds_read_b64_tr_b16 v[120:121], v10 offset:63488
  ds_read_b64_tr_b16 v[122:123], v10 offset:64512
  v_mfma_f32_32x32x16_bf16 v[48:63], v[124:127], a[108:111], v[48:63]
  s_waitcnt vmcnt(7) lgkmcnt(12)
  ds_read_b64_tr_b16 v[124:125], v11 offset:63488
  ds_read_b64_tr_b16 v[126:127], v11 offset:64512
  v_mfma_f32_32x32x16_bf16 v[32:47], v[96:99], a[112:115], v[32:47]
  s_waitcnt lgkmcnt(12)
  v_mfma_f32_32x32x16_bf16 v[48:63], v[100:103], a[112:115], v[48:63]
  s_waitcnt vmcnt(6) lgkmcnt(10)
  v_mfma_f32_32x32x16_bf16 v[32:47], v[104:107], a[116:119], v[32:47]
  s_waitcnt lgkmcnt(8)
  v_mfma_f32_32x32x16_bf16 v[48:63], v[108:111], a[116:119], v[48:63]
  s_waitcnt lgkmcnt(0)
  s_barrier
  ds_read_b128 v[108:111], v2 offset:0
  s_add_u32 m0, s63, 131072
  s_add_u32 s27, s95, 7168
  buffer_load_dwordx4 v5, s[16:19], s95 offen lds
  buffer_load_dwordx4 v5, s[16:19], s27 offen offset:1024 lds
  s_waitcnt vmcnt(7)
  v_mfma_f32_32x32x16_bf16 v[32:47], v[112:115], a[120:123], v[32:47]
  s_waitcnt vmcnt(6)
  ds_read_b128 v[112:115], v2 offset:2048
  v_mov_b32 v0, 0x200
  buffer_store_dword v0, off, s[36:39], s72 sc1
  v_mfma_f32_32x32x16_bf16 v[48:63], v[116:119], a[120:123], v[48:63]
  s_waitcnt vmcnt(3)
  ds_read_b128 v[116:119], v2 offset:4096
  v_min3_u32 v130, v145, v147, v149
  v_min3_u32 v131, v151, v153, v155
  v_min3_u32 v130, v157, v159, v130
  v_min_u32 v130, v130, v131
  v_mfma_f32_32x32x16_bf16 v[32:47], v[120:123], a[124:127], v[32:47]
  ds_read_b128 v[120:123], v2 offset:6144
  v_cmp_eq_u32 vcc, 0, v130
  s_cbranch_vccnz L_ewspin_15_s
L_ewback_16_s:
  v_mfma_f32_32x32x16_bf16 v[48:63], v[124:127], a[124:127], v[48:63]
  ds_read_b128 v[124:127], v2 offset:8192
  v_mfma_f32_32x32x16_bf16 v[32:47], v[144:147], v[24:27], v[32:47]
  ds_read_b128 v[96:99], v2 offset:10240
  s_add_u32 m0, s63, 139264
  s_add_u32 s27, s96, 7168
  buffer_load_dwordx4 v5, s[16:19], s96 offen lds
  buffer_load_dwordx4 v5, s[16:19], s27 offen offset:1024 lds
  v_mfma_f32_32x32x16_bf16 v[48:63], v[148:151], v[24:27], v[48:63]
  ds_read_b128 v[100:103], v2 offset:12288
  v_mfma_f32_32x32x16_bf16 v[64:79], v[152:155], v[24:27], 0
  ds_read_b128 v[104:107], v2 offset:14336
  s_nop 2
  v_pk_mul_f32 v[32:33], v[32:33], v[28:29] op_sel:[0,1] op_sel_hi:[1,1]
  v_pk_mul_f32 v[34:35], v[34:35], v[28:29] op_sel:[0,1] op_sel_hi:[1,1]
  v_pk_mul_f32 v[36:37], v[36:37], v[28:29] op_sel:[0,1] op_sel_hi:[1,1]
  v_pk_mul_f32 v[38:39], v[38:39], v[28:29] op_sel:[0,1] op_sel_hi:[1,1]
  v_exp_f32 v128, v32
  v_exp_f32 v129, v33
  v_exp_f32 v130, v34
  v_exp_f32 v131, v35
  v_exp_f32 v132, v36
  v_exp_f32 v133, v37
  v_exp_f32 v134, v38
  v_exp_f32 v135, v39
  v_pk_fma_f32 v[128:129], v[128:129], s[52:53], s[52:53]
  v_pk_fma_f32 v[130:131], v[130:131], s[52:53], s[52:53]
  v_pk_fma_f32 v[132:133], v[132:133], s[52:53], s[52:53]
  v_pk_fma_f32 v[134:135], v[134:135], s[52:53], s[52:53]
  s_add_u32 m0, s63, 147456
  s_add_u32 s27, s97, 7168
  buffer_load_dwordx4 v5, s[16:19], s97 offen lds
  buffer_load_dwordx4 v5, s[16:19], s27 offen offset:1024 lds
  v_pk_fma_f32 v[128:129], v[128:129], v[128:129], 0.5 op_sel_hi:[1,1,0]
  v_pk_fma_f32 v[130:131], v[130:131], v[130:131], 0.5 op_sel_hi:[1,1,0]
  v_pk_fma_f32 v[132:133], v[132:133], v[132:133], 0.5 op_sel_hi:[1,1,0]
  v_pk_fma_f32 v[134:135], v[134:135], v[134:135], 0.5 op_sel_hi:[1,1,0]
  v_rcp_f32 v128, v128
  v_rcp_f32 v129, v129
  v_rcp_f32 v130, v130
  v_rcp_f32 v131, v131
  v_rcp_f32 v132, v132
  v_rcp_f32 v133, v133
  v_rcp_f32 v134, v134
  v_rcp_f32 v135, v135
  v_pk_fma_f32 v[32:33], v[32:33], v[128:129], v[32:33] neg_lo:[1,0,0] neg_hi:[1,0,0]
  v_pk_fma_f32 v[34:35], v[34:35], v[130:131], v[34:35] neg_lo:[1,0,0] neg_hi:[1,0,0]
  v_pk_fma_f32 v[36:37], v[36:37], v[132:133], v[36:37] neg_lo:[1,0,0] neg_hi:[1,0,0]
  v_pk_fma_f32 v[38:39], v[38:39], v[134:135], v[38:39] neg_lo:[1,0,0] neg_hi:[1,0,0]
  v_cvt_pk_bf16_f32 v160, v32, v33
  v_cvt_pk_bf16_f32 v161, v34, v35
  v_cvt_pk_bf16_f32 v162, v36, v37
  v_cvt_pk_bf16_f32 v163, v38, v39
  v_pk_mul_f32 v[40:41], v[40:41], v[28:29] op_sel:[0,1] op_sel_hi:[1,1]
  v_pk_mul_f32 v[42:43], v[42:43], v[28:29] op_sel:[0,1] op_sel_hi:[1,1]
  v_pk_mul_f32 v[44:45], v[44:45], v[28:29] op_sel:[0,1] op_sel_hi:[1,1]
  v_pk_mul_f32 v[46:47], v[46:47], v[28:29] op_sel:[0,1] op_sel_hi:[1,1]
  v_exp_f32 v128, v40
  v_exp_f32 v129, v41
  v_exp_f32 v130, v42
  v_exp_f32 v131, v43
  v_exp_f32 v132, v44
  v_exp_f32 v133, v45
  buffer_store_dwordx4 v[160:163], v3, s[36:39], s8 offen offset:0 sc1
  s_add_u32 m0, s63, 155648
  s_add_u32 s27, s98, 7168
  buffer_load_dwordx4 v5, s[16:19], s98 offen lds
  buffer_load_dwordx4 v5, s[16:19], s27 offen offset:1024 lds
  v_exp_f32 v134, v46
  v_exp_f32 v135, v47
  v_pk_fma_f32 v[128:129], v[128:129], s[52:53], s[52:53]
  v_pk_fma_f32 v[130:131], v[130:131], s[52:53], s[52:53]
  v_pk_fma_f32 v[132:133], v[132:133], s[52:53], s[52:53]
  v_pk_fma_f32 v[134:135], v[134:135], s[52:53], s[52:53]
  v_pk_fma_f32 v[128:129], v[128:129], v[128:129], 0.5 op_sel_hi:[1,1,0]
  v_pk_fma_f32 v[130:131], v[130:131], v[130:131], 0.5 op_sel_hi:[1,1,0]
  v_pk_fma_f32 v[132:133], v[132:133], v[132:133], 0.5 op_sel_hi:[1,1,0]
  v_pk_fma_f32 v[134:135], v[134:135], v[134:135], 0.5 op_sel_hi:[1,1,0]
  v_rcp_f32 v128, v128
  v_rcp_f32 v129, v129
  v_rcp_f32 v130, v130
  v_rcp_f32 v131, v131
  v_rcp_f32 v132, v132
  v_rcp_f32 v133, v133
  v_rcp_f32 v134, v134
  v_rcp_f32 v135, v135
  v_pk_fma_f32 v[40:41], v[40:41], v[128:129], v[40:41] neg_lo:[1,0,0] neg_hi:[1,0,0]
  v_pk_fma_f32 v[42:43], v[42:43], v[130:131], v[42:43] neg_lo:[1,0,0] neg_hi:[1,0,0]
  v_pk_fma_f32 v[44:45], v[44:45], v[132:133], v[44:45] neg_lo:[1,0,0] neg_hi:[1,0,0]
  v_pk_fma_f32 v[46:47], v[46:47], v[134:135], v[46:47] neg_lo:[1,0,0] neg_hi:[1,0,0]
  v_cvt_pk_bf16_f32 v164, v40, v41
  v_cvt_pk_bf16_f32 v165, v42, v43
  v_cvt_pk_bf16_f32 v166, v44, v45
  v_cvt_pk_bf16_f32 v167, v46, v47
  v_mul_f32 v48, v48, v29
  v_mul_f32 v49, v49, v29
  v_exp_f32 v128, v48
  v_mul_f32 v50, v50, v29
  v_fma_f32 v128, v128, s52, s52
  s_waitcnt lgkmcnt(7)
  v_mfma_f32_32x32x16_bf16 v[64:79], v[108:111], a[0:3], v[64:79]
  s_waitcnt lgkmcnt(6)
  ds_read_b128 v[108:111], v2 offset:16384
  buffer_store_dwordx4 v[164:167], v3, s[36:39], s8 offen offset:1024 sc1
  s_add_u32 m0, s63, 32768
  s_add_u32 s26, s96, 32768
  s_add_u32 s27, s96, 39936
  buffer_load_dwordx4 v5, s[16:19], s26 offen lds
  v_mfma_f32_32x32x16_bf16 v[64:79], v[112:115], a[4:7], v[64:79]
  s_waitcnt lgkmcnt(6)
  ds_read_b128 v[112:115], v2 offset:18432
  buffer_load_dwordx4 v5, s[16:19], s27 offen offset:1024 lds
  v_exp_f32 v129, v49
  v_mul_f32 v51, v51, v29
  v_fma_f32 v129, v129, s52, s52
  v_mfma_f32_32x32x16_bf16 v[64:79], v[116:119], a[8:11], v[64:79]
  s_waitcnt lgkmcnt(6)
  ds_read_b128 v[116:119], v2 offset:20480
  v_exp_f32 v130, v50
  v_fma_f32 v128, v128, v128, 0.5
  v_mul_f32 v52, v52, v29
  v_fma_f32 v130, v130, s52, s52
  v_mfma_f32_32x32x16_bf16 v[64:79], v[120:123], a[12:15], v[64:79]
  s_waitcnt lgkmcnt(6)
  ds_read_b128 v[120:123], v2 offset:22528
  buffer_load_dword v17, v6, s[36:39], s70 offen sc1
  s_add_u32 m0, s63, 40960
  s_add_u32 s26, s97, 32768
  s_add_u32 s27, s97, 39936
  buffer_load_dwordx4 v5, s[16:19], s26 offen lds
  v_mfma_f32_32x32x16_bf16 v[64:79], v[124:127], a[16:19], v[64:79]
  s_waitcnt lgkmcnt(6)
  ds_read_b128 v[124:127], v2 offset:24576
  buffer_load_dwordx4 v5, s[16:19], s27 offen offset:1024 lds
  v_exp_f32 v131, v51
  v_fma_f32 v129, v129, v129, 0.5
  v_mul_f32 v53, v53, v29
  v_mfma_f32_32x32x16_bf16 v[64:79], v[96:99], a[20:23], v[64:79]
  s_waitcnt lgkmcnt(6)
  ds_read_b128 v[96:99], v2 offset:26624
  v_rcp_f32 v128, v128
  v_exp_f32 v132, v52
  v_fma_f32 v131, v131, s52, s52
  v_mfma_f32_32x32x16_bf16 v[64:79], v[100:103], a[24:27], v[64:79]
  s_waitcnt lgkmcnt(6)
  ds_read_b128 v[100:103], v2 offset:28672
  v_fma_f32 v130, v130, v130, 0.5
  v_rcp_f32 v129, v129
  v_fma_f32 v48, -v48, v128, v48
  v_mul_f32 v54, v54, v29
  v_mfma_f32_32x32x16_bf16 v[64:79], v[104:107], a[28:31], v[64:79]
  s_waitcnt lgkmcnt(6)
  ds_read_b128 v[104:107], v2 offset:30720
  v_exp_f32 v133, v53
  v_fma_f32 v132, v132, s52, s52
  v_fma_f32 v131, v131, v131, 0.5
  v_fma_f32 v49, -v49, v129, v49
  v_mfma_f32_32x32x16_bf16 v[64:79], v[108:111], a[32:35], v[64:79]
  s_waitcnt lgkmcnt(6)
  ds_read_b128 v[108:111], v16 offset:0
  s_add_u32 m0, s63, 49152
  s_add_u32 s26, s98, 32768
  s_add_u32 s27, s98, 39936
  buffer_load_dwordx4 v5, s[16:19], s26 offen lds
  buffer_load_dwordx4 v5, s[16:19], s27 offen offset:1024 lds
  v_mfma_f32_32x32x16_bf16 v[64:79], v[112:115], a[36:39], v[64:79]
  s_waitcnt lgkmcnt(6)
  ds_read_b128 v[112:115], v16 offset:2048
  v_rcp_f32 v130, v130
  v_mul_f32 v55, v55, v29
  v_exp_f32 v134, v54
  v_mfma_f32_32x32x16_bf16 v[64:79], v[116:119], a[40:43], v[64:79]
  s_waitcnt lgkmcnt(6)
  ds_read_b128 v[116:119], v16 offset:4096
  v_fma_f32 v133, v133, s52, s52
  v_fma_f32 v132, v132, v132, 0.5
  v_rcp_f32 v131, v131
  v_fma_f32 v50, -v50, v130, v50
  v_mfma_f32_32x32x16_bf16 v[64:79], v[120:123], a[44:47], v[64:79]
  s_waitcnt lgkmcnt(6)
  ds_read_b128 v[120:123], v16 offset:6144
  v_cvt_pk_bf16_f32 v168, v48, v49
  v_mul_f32 v56, v56, v29
  v_exp_f32 v135, v55
  v_fma_f32 v134, v134, s52, s52
  v_mfma_f32_32x32x16_bf16 v[64:79], v[124:127], a[48:51], v[64:79]
  s_waitcnt lgkmcnt(6)
  ds_read_b128 v[124:127], v16 offset:8192
  v_fma_f32 v133, v133, v133, 0.5
  v_rcp_f32 v132, v132
  v_fma_f32 v51, -v51, v131, v51
  v_mul_f32 v57, v57, v29
  v_mfma_f32_32x32x16_bf16 v[64:79], v[96:99], a[52:55], v[64:79]
  s_waitcnt vmcnt(7) lgkmcnt(6)
  ds_read_b128 v[96:99], v16 offset:10240
  buffer_store_dword v18, off, s[36:39], s72 offset:128 sc1
  s_add_u32 m0, s63, 57344
  s_add_u32 s26, s95, 65536
  s_add_u32 s27, s95, 72704
  buffer_load_dwordx4 v5, s[16:19], s26 offen lds
  v_mfma_f32_32x32x16_bf16 v[64:79], v[100:103], a[56:59], v[64:79]
  s_waitcnt vmcnt(6)
  ds_read_b128 v[100:103], v16 offset:12288
  v_cmp_gt_u32 vcc, 0x200, v17
  s_cbranch_vccnz L_spin_18_s
L_back_19_s:
  buffer_load_dwordx4 v5, s[16:19], s27 offen offset:1024 lds
  v_exp_f32 v128, v56
  s_waitcnt lgkmcnt(7)
  v_mfma_f32_32x32x16_bf16 v[64:79], v[104:107], a[60:63], v[64:79]
  s_waitcnt lgkmcnt(6)
  ds_read_b128 v[104:107], v16 offset:14336
  v_fma_f32 v135, v135, s52, s52
  v_fma_f32 v134, v134, v134, 0.5
  v_rcp_f32 v133, v133
  v_fma_f32 v52, -v52, v132, v52
  v_mfma_f32_32x32x16_bf16 v[64:79], v[108:111], a[64:67], v[64:79]
  s_waitcnt lgkmcnt(6)
  ds_read_b128 v[108:111], v16 offset:16384
  v_cvt_pk_bf16_f32 v169, v50, v51
  v_mul_f32 v58, v58, v29
  v_exp_f32 v129, v57
  v_fma_f32 v128, v128, s52, s52
  v_mfma_f32_32x32x16_bf16 v[64:79], v[112:115], a[68:71], v[64:79]
  s_waitcnt lgkmcnt(6)
  ds_read_b128 v[112:115], v16 offset:18432
  v_fma_f32 v135, v135, v135, 0.5
  v_rcp_f32 v134, v134
  v_fma_f32 v53, -v53, v133, v53
  v_mul_f32 v59, v59, v29
  v_mfma_f32_32x32x16_bf16 v[64:79], v[116:119], a[72:75], v[64:79]
  s_waitcnt lgkmcnt(6)
  ds_read_b128 v[116:119], v16 offset:20480
  s_add_u32 m0, s63, 65536
  s_add_u32 s26, s96, 65536
  s_add_u32 s27, s96, 72704
  buffer_load_dwordx4 v5, s[16:19], s26 offen lds
  buffer_load_dwordx4 v5, s[16:19], s27 offen offset:1024 lds
  v_mfma_f32_32x32x16_bf16 v[64:79], v[120:123], a[76:79], v[64:79]
  s_waitcnt lgkmcnt(6)
  ds_read_b128 v[120:123], v16 offset:22528
  v_exp_f32 v130, v58
  v_fma_f32 v129, v129, s52, s52
  v_fma_f32 v128, v128, v128, 0.5
  v_fma_f32 v54, -v54, v134, v54
  v_mfma_f32_32x32x16_bf16 v[64:79], v[124:127], a[80:83], v[64:79]
  s_waitcnt lgkmcnt(6)
  ds_read_b128 v[124:127], v16 offset:24576
  v_rcp_f32 v135, v135
  v_cvt_pk_bf16_f32 v170, v52, v53
  v_mul_f32 v60, v60, v29
  v_fma_f32 v130, v130, s52, s52
  v_mfma_f32_32x32x16_bf16 v[64:79], v[96:99], a[84:87], v[64:79]
  s_waitcnt lgkmcnt(6)
  ds_read_b128 v[96:99], v16 offset:26624
  v_exp_f32 v131, v59
  v_fma_f32 v129, v129, v129, 0.5
  v_rcp_f32 v128, v128
  v_mfma_f32_32x32x16_bf16 v[64:79], v[100:103], a[88:91], v[64:79]
  s_waitcnt lgkmcnt(6)
  ds_read_b128 v[100:103], v16 offset:28672
  v_fma_f32 v55, -v55, v135, v55
  v_mul_f32 v61, v61, v29
  v_exp_f32 v132, v60
  v_fma_f32 v131, v131, s52, s52
  v_mfma_f32_32x32x16_bf16 v[64:79], v[104:107], a[92:95], v[64:79]
  s_waitcnt lgkmcnt(6)
  ds_read_b128 v[104:107], v16 offset:30720
  s_add_u32 m0, s63, 73728
  s_add_u32 s26, s97, 65536
  s_add_u32 s27, s97, 72704
  buffer_load_dwordx4 v5, s[16:19], s26 offen lds
  buffer_load_dwordx4 v5, s[16:19], s27 offen offset:1024 lds
  v_mfma_f32_32x32x16_bf16 v[64:79], v[108:111], a[96:99], v[64:79]
  s_waitcnt lgkmcnt(6)
  v_fma_f32 v130, v130, v130, 0.5
  v_rcp_f32 v129, v129
  v_fma_f32 v56, -v56, v128, v56
  v_cvt_pk_bf16_f32 v171, v54, v55
  v_mul_f32 v62, v62, v29
  v_mfma_f32_32x32x16_bf16 v[64:79], v[112:115], a[100:103], v[64:79]
  s_waitcnt lgkmcnt(5)
  ds_read_b128 v[112:115], v2 offset:1024
  buffer_store_dwordx4 v[168:171], v4, s[28:31], s8 offen offset:0 sc1
  v_exp_f32 v133, v61
  v_fma_f32 v132, v132, s52, s52
  v_fma_f32 v131, v131, v131, 0.5
  v_mfma_f32_32x32x16_bf16 v[64:79], v[116:119], a[104:107], v[64:79]
  s_waitcnt lgkmcnt(5)
  ds_read_b128 v[116:119], v2 offset:3072
  v_rcp_f32 v130, v130
  v_fma_f32 v57, -v57, v129, v57
  v_mul_f32 v63, v63, v29
  v_fma_f32 v133, v133, s52, s52
  v_mfma_f32_32x32x16_bf16 v[64:79], v[120:123], a[108:111], v[64:79]
  s_waitcnt lgkmcnt(5)
  ds_read_b128 v[120:123], v2 offset:5120
  v_exp_f32 v134, v62
  v_fma_f32 v132, v132, v132, 0.5
  v_rcp_f32 v131, v131
  v_mfma_f32_32x32x16_bf16 v[64:79], v[124:127], a[112:115], v[64:79]
  s_waitcnt lgkmcnt(5)
  ds_read_b128 v[124:127], v2 offset:7168
  s_add_u32 m0, s63, 81920
  s_add_u32 s26, s98, 65536
  s_add_u32 s27, s98, 72704
  buffer_load_dwordx4 v5, s[16:19], s26 offen lds
  buffer_load_dwordx4 v5, s[16:19], s27 offen offset:1024 lds
  v_mfma_f32_32x32x16_bf16 v[64:79], v[96:99], a[116:119], v[64:79]
  s_waitcnt lgkmcnt(5)
  ds_read_b128 v[96:99], v2 offset:9216
  buffer_load_dword v252, v6, s[36:39], s70 offen offset:128 sc1
  v_fma_f32 v58, -v58, v130, v58
  v_cvt_pk_bf16_f32 v172, v56, v57
  v_exp_f32 v135, v63
  v_mfma_f32_32x32x16_bf16 v[64:79], v[100:103], a[120:123], v[64:79]
  s_waitcnt lgkmcnt(5)
  ds_read_b128 v[100:103], v2 offset:11264
  v_fma_f32 v134, v134, s52, s52
  v_fma_f32 v133, v133, v133, 0.5
  v_rcp_f32 v132, v132
  v_fma_f32 v59, -v59, v131, v59
  v_mfma_f32_32x32x16_bf16 v[64:79], v[104:107], a[124:127], v[64:79]
  ds_read_b128 v[104:107], v2 offset:13312
  v_fma_f32 v135, v135, s52, s52
  v_fma_f32 v134, v134, v134, 0.5
  v_rcp_f32 v133, v133
  v_fma_f32 v60, -v60, v132, v60
  v_mfma_f32_32x32x16_bf16 v[80:95], v[156:159], v[24:27], 0
  s_waitcnt lgkmcnt(6)
  ds_read_b128 v[108:111], v2 offset:15360
  v_cvt_pk_bf16_f32 v173, v58, v59
  v_fma_f32 v135, v135, v135, 0.5
  v_rcp_f32 v134, v134
  v_fma_f32 v61, -v61, v133, v61
  v_mfma_f32_32x32x16_bf16 v[80:95], v[112:115], a[0:3], v[80:95]
  s_waitcnt lgkmcnt(6)
  ds_read_b128 v[112:115], v2 offset:17408
  s_add_u32 m0, s63, 90112
  s_add_u32 s26, s96, 98304
  s_add_u32 s27, s96, 105472
  buffer_load_dwordx4 v5, s[16:19], s26 offen lds
  buffer_load_dwordx4 v5, s[16:19], s27 offen offset:1024 lds
  v_mfma_f32_32x32x16_bf16 v[80:95], v[116:119], a[4:7], v[80:95]
  s_waitcnt lgkmcnt(6)
  ds_read_b128 v[116:119], v2 offset:19456
  v_rcp_f32 v135, v135
  v_fma_f32 v62, -v62, v134, v62
  v_cvt_pk_bf16_f32 v174, v60, v61
  v_fma_f32 v63, -v63, v135, v63
  v_mfma_f32_32x32x16_bf16 v[80:95], v[120:123], a[8:11], v[80:95]
  s_waitcnt lgkmcnt(6)
  ds_read_b128 v[120:123], v2 offset:21504
  v_cvt_pk_bf16_f32 v175, v62, v63
  v_mul_f32 v64, v64, v29
  v_mul_f32 v65, v65, v29
  v_exp_f32 v128, v64
  v_mfma_f32_32x32x16_bf16 v[80:95], v[124:127], a[12:15], v[80:95]
  s_waitcnt lgkmcnt(6)
  ds_read_b128 v[124:127], v2 offset:23552
  buffer_store_dwordx4 v[172:175], v4, s[28:31], s8 offen offset:1024 sc1
  v_mul_f32 v66, v66, v29
  v_exp_f32 v129, v65
  v_fma_f32 v128, v128, s52, s52
  v_mfma_f32_32x32x16_bf16 v[80:95], v[96:99], a[16:19], v[80:95]
  s_waitcnt lgkmcnt(6)
  ds_read_b128 v[96:99], v2 offset:25600
  v_mul_f32 v67, v67, v29
  v_exp_f32 v130, v66
  v_fma_f32 v129, v129, s52, s52
  v_fma_f32 v128, v128, v128, 0.5
  v_mfma_f32_32x32x16_bf16 v[80:95], v[100:103], a[20:23], v[80:95]
  s_waitcnt lgkmcnt(6)
  ds_read_b128 v[100:103], v2 offset:27648
  v_mul_f32 v68, v68, v29
  v_exp_f32 v131, v67
  v_fma_f32 v130, v130, s52, s52
  v_fma_f32 v129, v129, v129, 0.5
  v_mfma_f32_32x32x16_bf16 v[80:95], v[104:107], a[24:27], v[80:95]
  s_waitcnt lgkmcnt(6)
  ds_read_b128 v[104:107], v2 offset:29696
  v_rcp_f32 v128, v128
  v_mul_f32 v69, v69, v29
  v_exp_f32 v132, v68
  v_mfma_f32_32x32x16_bf16 v[80:95], v[108:111], a[28:31], v[80:95]
  s_waitcnt vmcnt(3) lgkmcnt(6)
  ds_read_b128 v[108:111], v2 offset:31744
  v_cmp_eq_u32 vcc, 0, v252
  s_nop 0
  s_cmp_eq_u64 vcc, 0
  s_cselect_b32 s34, s38, 0
  s_mov_b64 s[32:33], s[36:37]
  s_cselect_b32 s55, 1, 0
  v_mfma_f32_32x32x16_bf16 v[80:95], v[112:115], a[32:35], v[80:95]
  s_waitcnt lgkmcnt(6)
  ds_read_b128 v[112:115], v16 offset:1024
  buffer_load_dwordx4 a[128:131], v3, s[32:35], s9 offen offset:0 sc1
  buffer_load_dwordx4 a[132:135], v3, s[32:35], s9 offen offset:1024 sc1
  buffer_load_dwordx4 a[136:139], v3, s[32:35], s10 offen offset:0 sc1
  buffer_load_dwordx4 a[140:143], v3, s[32:35], s10 offen offset:1024 sc1
  buffer_load_dwordx4 a[144:147], v3, s[32:35], s11 offen offset:0 sc1
  v_mfma_f32_32x32x16_bf16 v[80:95], v[116:119], a[36:39], v[80:95]
  s_waitcnt lgkmcnt(6)
  ds_read_b128 v[116:119], v16 offset:3072
  v_fma_f32 v131, v131, s52, s52
  v_fma_f32 v130, v130, v130, 0.5
  v_rcp_f32 v129, v129
  v_fma_f32 v64, -v64, v128, v64
  v_mfma_f32_32x32x16_bf16 v[80:95], v[120:123], a[40:43], v[80:95]
  s_waitcnt lgkmcnt(6)
  ds_read_b128 v[120:123], v16 offset:5120
  v_mul_f32 v70, v70, v29
  v_exp_f32 v133, v69
  v_fma_f32 v132, v132, s52, s52
  v_fma_f32 v131, v131, v131, 0.5
  v_mfma_f32_32x32x16_bf16 v[80:95], v[124:127], a[44:47], v[80:95]
  s_waitcnt lgkmcnt(6)
  ds_read_b128 v[124:127], v16 offset:7168
  buffer_load_dwordx4 a[148:151], v3, s[32:35], s11 offen offset:1024 sc1
  v_rcp_f32 v130, v130
  v_fma_f32 v65, -v65, v129, v65
  v_mul_f32 v71, v71, v29
  v_mfma_f32_32x32x16_bf16 v[80:95], v[96:99], a[48:51], v[80:95]
  s_waitcnt lgkmcnt(6)
  ds_read_b128 v[96:99], v16 offset:9216
  v_exp_f32 v134, v70
  v_fma_f32 v133, v133, s52, s52
  v_fma_f32 v132, v132, v132, 0.5
  v_fma_f32 v66, -v66, v130, v66
  v_mfma_f32_32x32x16_bf16 v[80:95], v[100:103], a[52:55], v[80:95]
  s_waitcnt vmcnt(6) lgkmcnt(6)
  ds_read_b128 v[100:103], v16 offset:11264
  buffer_store_dword v18, off, s[36:39], s72 offset:192 sc1
  buffer_load_dwordx4 a[152:155], v3, s[32:35], s12 offen offset:0 sc1
  v_rcp_f32 v131, v131
  v_cvt_pk_bf16_f32 v176, v64, v65
  v_mfma_f32_32x32x16_bf16 v[80:95], v[104:107], a[56:59], v[80:95]
  s_waitcnt lgkmcnt(6)
  ds_read_b128 v[104:107], v16 offset:13312
  v_mul_f32 v72, v72, v29
  v_exp_f32 v135, v71
  v_fma_f32 v134, v134, s52, s52
  v_fma_f32 v133, v133, v133, 0.5
  v_mfma_f32_32x32x16_bf16 v[80:95], v[108:111], a[60:63], v[80:95]
  s_waitcnt lgkmcnt(6)
  ds_read_b128 v[108:111], v16 offset:15360
  buffer_load_dwordx4 a[156:159], v3, s[32:35], s12 offen offset:1024 sc1
  v_rcp_f32 v132, v132
  v_fma_f32 v67, -v67, v131, v67
  v_mul_f32 v73, v73, v29
  v_mfma_f32_32x32x16_bf16 v[80:95], v[112:115], a[64:67], v[80:95]
  s_waitcnt lgkmcnt(6)
  ds_read_b128 v[112:115], v16 offset:17408
  v_exp_f32 v128, v72
  v_fma_f32 v135, v135, s52, s52
  v_fma_f32 v134, v134, v134, 0.5
  v_fma_f32 v68, -v68, v132, v68
  v_mfma_f32_32x32x16_bf16 v[80:95], v[116:119], a[68:71], v[80:95]
  s_waitcnt lgkmcnt(6)
  ds_read_b128 v[116:119], v16 offset:19456
  buffer_load_dwordx4 a[160:163], v3, s[32:35], s13 offen offset:0 sc1
  v_rcp_f32 v133, v133
  v_cvt_pk_bf16_f32 v177, v66, v67
  v_and_b32 v176, -2, v176
  v_mfma_f32_32x32x16_bf16 v[80:95], v[120:123], a[72:75], v[80:95]
  s_waitcnt lgkmcnt(6)
  ds_read_b128 v[120:123], v16 offset:21504
  v_mul_f32 v74, v74, v29
  v_exp_f32 v129, v73
  v_fma_f32 v128, v128, s52, s52
  v_fma_f32 v135, v135, v135, 0.5
  v_mfma_f32_32x32x16_bf16 v[80:95], v[124:127], a[76:79], v[80:95]
  s_waitcnt lgkmcnt(6)
  ds_read_b128 v[124:127], v16 offset:23552
  buffer_load_dwordx4 a[164:167], v3, s[32:35], s13 offen offset:1024 sc1
  v_rcp_f32 v134, v134
  v_fma_f32 v69, -v69, v133, v69
  v_mul_f32 v75, v75, v29
  v_mfma_f32_32x32x16_bf16 v[80:95], v[96:99], a[80:83], v[80:95]
  s_waitcnt lgkmcnt(6)
  ds_read_b128 v[96:99], v16 offset:25600
  v_exp_f32 v130, v74
  v_fma_f32 v129, v129, s52, s52
  v_fma_f32 v128, v128, v128, 0.5
  v_fma_f32 v70, -v70, v134, v70
  v_mfma_f32_32x32x16_bf16 v[80:95], v[100:103], a[84:87], v[80:95]
  s_waitcnt lgkmcnt(6)
  ds_read_b128 v[100:103], v16 offset:27648
  buffer_load_dwordx4 a[168:171], v3, s[32:35], s14 offen offset:0 sc1
  v_rcp_f32 v135, v135
  v_cvt_pk_bf16_f32 v178, v68, v69
  v_mul_f32 v76, v76, v29
  v_mfma_f32_32x32x16_bf16 v[80:95], v[104:107], a[88:91], v[80:95]
  s_waitcnt lgkmcnt(6)
  ds_read_b128 v[104:107], v16 offset:29696
  v_exp_f32 v131, v75
  v_fma_f32 v130, v130, s52, s52
  v_fma_f32 v129, v129, v129, 0.5
  v_fma_f32 v71, -v71, v135, v71
  v_mfma_f32_32x32x16_bf16 v[80:95], v[108:111], a[92:95], v[80:95]
  s_waitcnt lgkmcnt(6)
  ds_read_b128 v[108:111], v16 offset:31744
  buffer_load_dwordx4 a[172:175], v3, s[32:35], s14 offen offset:1024 sc1
  v_rcp_f32 v128, v128
  v_mul_f32 v77, v77, v29
  v_fma_f32 v131, v131, s52, s52
  v_mfma_f32_32x32x16_bf16 v[80:95], v[112:115], a[96:99], v[80:95]
  s_barrier
  ds_read_b64_tr_b16 v[112:113], v12 offset:0
  ds_read_b64_tr_b16 v[114:115], v12 offset:1024
  v_exp_f32 v132, v76
  v_fma_f32 v130, v130, v130, 0.5
  s_waitcnt lgkmcnt(8)
  v_mfma_f32_32x32x16_bf16 v[80:95], v[116:119], a[100:103], v[80:95]
  s_waitcnt lgkmcnt(7)
  ds_read_b64_tr_b16 v[116:117], v12 offset:2048
  ds_read_b64_tr_b16 v[118:119], v12 offset:3072
  v_rcp_f32 v129, v129
  v_fma_f32 v72, -v72, v128, v72
  v_cvt_pk_bf16_f32 v179, v70, v71
  v_mfma_f32_32x32x16_bf16 v[80:95], v[120:123], a[104:107], v[80:95]
  s_waitcnt lgkmcnt(8)
  ds_read_b64_tr_b16 v[120:121], v12 offset:4096
  ds_read_b64_tr_b16 v[122:123], v12 offset:5120
  s_add_u32 m0, s63, 0
  s_add_u32 s26, s97, 98304
  s_add_u32 s27, s97, 105472
  buffer_load_dwordx4 v5, s[16:19], s26 offen lds
  v_mfma_f32_32x32x16_bf16 v[80:95], v[124:127], a[108:111], v[80:95]
  s_waitcnt lgkmcnt(9)
  ds_read_b64_tr_b16 v[124:125], v12 offset:6144
  ds_read_b64_tr_b16 v[126:127], v12 offset:7168
  v_mul_f32 v78, v78, v29
  v_exp_f32 v133, v77
  v_fma_f32 v132, v132, s52, s52
  v_mfma_f32_32x32x16_bf16 v[80:95], v[96:99], a[112:115], v[80:95]
  s_waitcnt lgkmcnt(10)
  ds_read_b64_tr_b16 v[96:97], v12 offset:8192
  ds_read_b64_tr_b16 v[98:99], v12 offset:9216
  buffer_load_dwordx4 v5, s[16:19], s27 offen offset:1024 lds
  v_fma_f32 v131, v131, v131, 0.5
  v_rcp_f32 v130, v130
  v_mfma_f32_32x32x16_bf16 v[80:95], v[100:103], a[116:119], v[80:95]
  s_waitcnt lgkmcnt(11)
  ds_read_b64_tr_b16 v[100:101], v12 offset:10240
  ds_read_b64_tr_b16 v[102:103], v12 offset:11264
  v_fma_f32 v73, -v73, v129, v73
  v_mul_f32 v79, v79, v29
  v_exp_f32 v134, v78
  v_mfma_f32_32x32x16_bf16 v[80:95], v[104:107], a[120:123], v[80:95]
  s_waitcnt lgkmcnt(12)
  ds_read_b64_tr_b16 v[104:105], v12 offset:12288
  ds_read_b64_tr_b16 v[106:107], v12 offset:13312
  buffer_load_dword v253, v9, s[36:39], s70 offen offset:192 sc1
  v_fma_f32 v133, v133, s52, s52
  v_fma_f32 v132, v132, v132, 0.5
  v_fma_f32 v74, -v74, v130, v74
  v_mfma_f32_32x32x16_bf16 v[80:95], v[108:111], a[124:127], v[80:95]
  s_waitcnt lgkmcnt(12)
  ds_read_b64_tr_b16 v[108:109], v12 offset:14336
  ds_read_b64_tr_b16 v[110:111], v12 offset:15360
  s_add_u32 m0, s63, 8192
  s_add_u32 s26, s98, 98304
  s_add_u32 s27, s98, 105472
  buffer_load_dwordx4 v5, s[16:19], s26 offen lds
  v_mfma_f32_32x32x16_bf16 v[192:207], v[112:115], v[160:163], 0
  s_waitcnt lgkmcnt(12)
  ds_read_b64_tr_b16 v[112:113], v12 offset:16384
  ds_read_b64_tr_b16 v[114:115], v12 offset:17408
  buffer_load_dwordx4 v5, s[16:19], s27 offen offset:1024 lds
  s_lshl_b32 s60, s99, 2
  s_add_u32 s60, s60, s70
  s_xor_b32 s59, s60, 4
  v_mfma_f32_32x32x16_bf16 v[192:207], v[116:119], v[164:167], v[192:207]
  s_waitcnt lgkmcnt(12)
  ds_read_b64_tr_b16 v[116:117], v12 offset:18432
  ds_read_b64_tr_b16 v[118:119], v12 offset:19456
  v_rcp_f32 v131, v131
  v_cvt_pk_bf16_f32 v180, v72, v73
  v_fma_f32 v134, v134, s52, s52
  v_mfma_f32_32x32x16_bf16 v[192:207], v[120:123], v[168:171], v[192:207]
  s_waitcnt lgkmcnt(12)
  ds_read_b64_tr_b16 v[120:121], v12 offset:20480
  ds_read_b64_tr_b16 v[122:123], v12 offset:21504
  v_exp_f32 v135, v79
  v_fma_f32 v133, v133, v133, 0.5
  v_fma_f32 v75, -v75, v131, v75
  v_mfma_f32_32x32x16_bf16 v[192:207], v[124:127], v[172:175], v[192:207]
  ds_read_b64_tr_b16 v[124:125], v12 offset:22528
  ds_read_b64_tr_b16 v[126:127], v12 offset:23552
  v_rcp_f32 v132, v132
  v_fma_f32 v135, v135, s52, s52
  v_fma_f32 v134, v134, v134, 0.5
  s_cmp_eq_u32 s55, 0
  s_cbranch_scc1 L_catch_21_s
L_cback_22_s:
  s_waitcnt vmcnt(17) lgkmcnt(14)
  v_mfma_f32_32x32x16_bf16 v[192:207], v[96:99], a[128:131], v[192:207]
  s_waitcnt vmcnt(16) lgkmcnt(12)
  ds_read_b64_tr_b16 v[96:97], v12 offset:24576
  ds_read_b64_tr_b16 v[98:99], v12 offset:25600
  v_rcp_f32 v133, v133
  v_fma_f32 v76, -v76, v132, v76
  v_mfma_f32_32x32x16_bf16 v[192:207], v[100:103], a[132:135], v[192:207]
  s_waitcnt vmcnt(15) lgkmcnt(12)
  ds_read_b64_tr_b16 v[100:101], v12 offset:26624
  ds_read_b64_tr_b16 v[102:103], v12 offset:27648
  v_cvt_pk_bf16_f32 v181, v74, v75
  v_and_b32 v180, -2, v180
  v_fma_f32 v135, v135, v135, 0.5
  v_fma_f32 v77, -v77, v133, v77
  v_mfma_f32_32x32x16_bf16 v[192:207], v[104:107], a[136:139], v[192:207]
  s_waitcnt vmcnt(14) lgkmcnt(12)
  ds_read_b64_tr_b16 v[104:105], v12 offset:28672
  ds_read_b64_tr_b16 v[106:107], v12 offset:29696
  v_rcp_f32 v134, v134
  v_rcp_f32 v135, v135
  v_mfma_f32_32x32x16_bf16 v[192:207], v[108:111], a[140:143], v[192:207]
  s_waitcnt vmcnt(5) lgkmcnt(12)
  ds_read_b64_tr_b16 v[108:109], v12 offset:30720
  ds_read_b64_tr_b16 v[110:111], v12 offset:31744
  v_mov_b32 v0, 0x300
  buffer_store_dword v0, off, s[36:39], s72 sc1
  v_fma_f32 v78, -v78, v134, v78
  v_cvt_pk_bf16_f32 v182, v76, v77
  v_mfma_f32_32x32x16_bf16 v[192:207], v[112:115], a[144:147], v[192:207]
  s_waitcnt lgkmcnt(12)
  ds_read_b64_tr_b16 v[112:113], v10 offset:24576
  ds_read_b64_tr_b16 v[114:115], v10 offset:25600
  v_fma_f32 v79, -v79, v135, v79
  v_cvt_pk_bf16_f32 v183, v78, v79
  v_mul_f32 v80, v80, v29
  v_mul_f32 v81, v81, v29
  v_mfma_f32_32x32x16_bf16 v[192:207], v[116:119], a[148:151], v[192:207]
  s_waitcnt vmcnt(3) lgkmcnt(12)
  ds_read_b64_tr_b16 v[116:117], v10 offset:26624
  ds_read_b64_tr_b16 v[118:119], v10 offset:27648
  v_cmp_eq_u32 vcc, 0, v253
  s_nop 0
  s_cmp_eq_u64 vcc, 0
  s_cselect_b32 s34, s30, 0
  s_mov_b64 s[32:33], s[28:29]
  s_cselect_b32 s56, 1, 0
  v_mfma_f32_32x32x16_bf16 v[192:207], v[120:123], a[152:155], v[192:207]
  s_waitcnt lgkmcnt(12)
  ds_read_b64_tr_b16 v[120:121], v13 offset:0
  ds_read_b64_tr_b16 v[122:123], v13 offset:1024
  buffer_load_dwordx4 a[176:179], v4, s[32:35], s9 offen offset:0 sc1
  buffer_load_dwordx4 a[180:183], v4, s[32:35], s9 offen offset:1024 sc1
  buffer_load_dwordx4 a[184:187], v4, s[32:35], s10 offen offset:0 sc1
  buffer_load_dwordx4 a[188:191], v4, s[32:35], s10 offen offset:1024 sc1
  v_mfma_f32_32x32x16_bf16 v[192:207], v[124:127], a[156:159], v[192:207]
  s_waitcnt lgkmcnt(12)
  ds_read_b64_tr_b16 v[124:125], v13 offset:2048
  ds_read_b64_tr_b16 v[126:127], v13 offset:3072
  buffer_load_dwordx4 a[192:195], v4, s[32:35], s11 offen offset:0 sc1
  v_exp_f32 v128, v80
  v_mul_f32 v82, v82, v29
  v_mfma_f32_32x32x16_bf16 v[192:207], v[96:99], a[160:163], v[192:207]
  s_waitcnt lgkmcnt(12)
  ds_read_b64_tr_b16 v[96:97], v13 offset:4096
  ds_read_b64_tr_b16 v[98:99], v13 offset:5120
  v_exp_f32 v129, v81
  v_fma_f32 v128, v128, s52, s52
  v_mul_f32 v83, v83, v29
  v_mfma_f32_32x32x16_bf16 v[192:207], v[100:103], a[164:167], v[192:207]
  s_waitcnt lgkmcnt(12)
  ds_read_b64_tr_b16 v[100:101], v13 offset:6144
  ds_read_b64_tr_b16 v[102:103], v13 offset:7168
  buffer_load_dword v17, v6, s[36:39], s70 offen sc1
  buffer_load_dwordx4 a[196:199], v4, s[32:35], s11 offen offset:1024 sc1
  v_exp_f32 v130, v82
  v_mfma_f32_32x32x16_bf16 v[192:207], v[104:107], a[168:171], v[192:207]
  s_waitcnt lgkmcnt(12)
  ds_read_b64_tr_b16 v[104:105], v13 offset:8192
  ds_read_b64_tr_b16 v[106:107], v13 offset:9216
  v_fma_f32 v129, v129, s52, s52
  v_fma_f32 v128, v128, v128, 0.5
  v_mul_f32 v84, v84, v29
  v_fma_f32 v130, v130, s52, s52
  v_mfma_f32_32x32x16_bf16 v[192:207], v[108:111], a[172:175], v[192:207]
  s_waitcnt lgkmcnt(12)
  ds_read_b64_tr_b16 v[108:109], v13 offset:10240
  ds_read_b64_tr_b16 v[110:111], v13 offset:11264
  buffer_load_dwordx4 a[200:203], v4, s[32:35], s12 offen offset:0 sc1
  v_exp_f32 v131, v83
  v_fma_f32 v129, v129, v129, 0.5
  v_mfma_f32_32x32x16_bf16 v[192:207], v[112:115], v[176:179], v[192:207]
  s_waitcnt lgkmcnt(12)
  ds_read_b64_tr_b16 v[112:113], v13 offset:12288
  ds_read_b64_tr_b16 v[114:115], v13 offset:13312
  v_rcp_f32 v128, v128
  v_mul_f32 v85, v85, v29
  v_fma_f32 v131, v131, s52, s52
  v_mfma_f32_32x32x16_bf16 v[192:207], v[116:119], v[180:183], v[192:207]
  s_waitcnt lgkmcnt(12)
  ds_read_b64_tr_b16 v[116:117], v13 offset:14336
  ds_read_b64_tr_b16 v[118:119], v13 offset:15360
  buffer_load_dwordx4 a[204:207], v4, s[32:35], s12 offen offset:1024 sc1
  v_exp_f32 v132, v84
  v_fma_f32 v130, v130, v130, 0.5
  v_mfma_f32_32x32x16_bf16 v[208:223], v[120:123], v[160:163], 0
  s_waitcnt lgkmcnt(12)
  ds_read_b64_tr_b16 v[120:121], v10 offset:0
  ds_read_b64_tr_b16 v[122:123], v10 offset:1024
  v_rcp_f32 v129, v129
  v_fma_f32 v80, -v80, v128, v80
  v_mul_f32 v86, v86, v29
  v_mfma_f32_32x32x16_bf16 v[208:223], v[124:127], v[164:167], v[208:223]
  s_waitcnt lgkmcnt(12)
  ds_read_b64_tr_b16 v[124:125], v10 offset:2048
  ds_read_b64_tr_b16 v[126:127], v10 offset:3072
  buffer_load_dwordx4 a[208:211], v4, s[32:35], s13 offen offset:0 sc1
  v_exp_f32 v133, v85
  v_fma_f32 v132, v132, s52, s52
  v_mfma_f32_32x32x16_bf16 v[208:223], v[96:99], v[168:171], v[208:223]
  s_waitcnt lgkmcnt(12)
  ds_read_b64_tr_b16 v[96:97], v10 offset:4096
  ds_read_b64_tr_b16 v[98:99], v10 offset:5120
  v_fma_f32 v131, v131, v131, 0.5
  v_rcp_f32 v130, v130
  v_fma_f32 v81, -v81, v129, v81
  v_mfma_f32_32x32x16_bf16 v[208:223], v[100:103], v[172:175], v[208:223]
  s_waitcnt lgkmcnt(12)
  ds_read_b64_tr_b16 v[100:101], v10 offset:6144
  ds_read_b64_tr_b16 v[102:103], v10 offset:7168
  buffer_load_dwordx4 a[212:215], v4, s[32:35], s13 offen offset:1024 sc1
  v_mul_f32 v87, v87, v29
  v_exp_f32 v134, v86
  v_mfma_f32_32x32x16_bf16 v[208:223], v[104:107], a[128:131], v[208:223]
  s_waitcnt lgkmcnt(12)
  ds_read_b64_tr_b16 v[104:105], v10 offset:8192
  ds_read_b64_tr_b16 v[106:107], v10 offset:9216
  v_fma_f32 v133, v133, s52, s52
  v_fma_f32 v132, v132, v132, 0.5
  v_rcp_f32 v131, v131
  v_mfma_f32_32x32x16_bf16 v[208:223], v[108:111], a[132:135], v[208:223]
  s_waitcnt lgkmcnt(12)
  ds_read_b64_tr_b16 v[108:109], v10 offset:10240
  ds_read_b64_tr_b16 v[110:111], v10 offset:11264
  buffer_load_dwordx4 a[216:219], v4, s[32:35], s14 offen offset:0 sc1
  v_fma_f32 v82, -v82, v130, v82
  v_cvt_pk_bf16_f32 v184, v80, v81
  v_mul_f32 v88, v88, v29
  v_mfma_f32_32x32x16_bf16 v[208:223], v[112:115], a[136:139], v[208:223]
  s_waitcnt vmcnt(6)
  ds_read_b64_tr_b16 v[112:113], v10 offset:12288
  ds_read_b64_tr_b16 v[114:115], v10 offset:13312
  v_cmp_gt_u32 vcc, 0x300, v17
  s_cbranch_vccnz L_spin_29_s
L_back_30_s:
  v_exp_f32 v135, v87
  s_waitcnt lgkmcnt(14)
  v_mfma_f32_32x32x16_bf16 v[208:223], v[116:119], a[140:143], v[208:223]
  ds_read_b64_tr_b16 v[116:117], v10 offset:14336
  ds_read_b64_tr_b16 v[118:119], v10 offset:15360
  buffer_load_dwordx4 a[220:223], v4, s[32:35], s14 offen offset:1024 sc1
  buffer_store_dwordx4 v[176:179], v7, s[36:39], s8 offen offset:0 sc1
  buffer_store_dwordx4 v[180:183], v7, s[36:39], s8 offen offset:1024 sc1
  v_fma_f32 v134, v134, s52, s52
  s_cmp_eq_u32 s56, 0
  s_cbranch_scc1 L_catch_25_s
L_cback_26_s:
  s_waitcnt lgkmcnt(14)
  v_mfma_f32_32x32x16_bf16 v[192:207], v[120:123], a[176:179], v[192:207]
  s_waitcnt lgkmcnt(12)
  ds_read_b64_tr_b16 v[120:121], v13 offset:16384
  ds_read_b64_tr_b16 v[122:123], v13 offset:17408
  v_fma_f32 v133, v133, v133, 0.5
  v_rcp_f32 v132, v132
  v_fma_f32 v83, -v83, v131, v83
  v_mfma_f32_32x32x16_bf16 v[192:207], v[124:127], a[180:183], v[192:207]
  s_waitcnt lgkmcnt(12)
  ds_read_b64_tr_b16 v[124:125], v10 offset:16384
  ds_read_b64_tr_b16 v[126:127], v10 offset:17408
  v_mul_f32 v89, v89, v29
  v_exp_f32 v128, v88
  v_fma_f32 v135, v135, s52, s52
  v_mfma_f32_32x32x16_bf16 v[192:207], v[96:99], a[184:187], v[192:207]
  s_waitcnt lgkmcnt(12)
  ds_read_b64_tr_b16 v[96:97], v13 offset:18432
  ds_read_b64_tr_b16 v[98:99], v13 offset:19456
  v_fma_f32 v134, v134, v134, 0.5
  v_rcp_f32 v133, v133
  v_fma_f32 v84, -v84, v132, v84
  v_mfma_f32_32x32x16_bf16 v[192:207], v[100:103], a[188:191], v[192:207]
  s_waitcnt lgkmcnt(12)
  ds_read_b64_tr_b16 v[100:101], v10 offset:18432
  ds_read_b64_tr_b16 v[102:103], v10 offset:19456
  v_cvt_pk_bf16_f32 v185, v82, v83
  v_mul_f32 v90, v90, v29
  v_exp_f32 v129, v89
  v_mfma_f32_32x32x16_bf16 v[192:207], v[104:107], a[192:195], v[192:207]
  s_waitcnt vmcnt(8) lgkmcnt(12)
  ds_read_b64_tr_b16 v[104:105], v13 offset:20480
  ds_read_b64_tr_b16 v[106:107], v13 offset:21504
  v_fma_f32 v128, v128, s52, s52
  v_fma_f32 v135, v135, v135, 0.5
  v_rcp_f32 v134, v134
  v_mfma_f32_32x32x16_bf16 v[192:207], v[108:111], a[196:199], v[192:207]
  s_waitcnt vmcnt(7) lgkmcnt(12)
  ds_read_b64_tr_b16 v[108:109], v10 offset:20480
  ds_read_b64_tr_b16 v[110:111], v10 offset:21504
  v_fma_f32 v85, -v85, v133, v85
  v_mul_f32 v91, v91, v29
  v_exp_f32 v130, v90
  v_mfma_f32_32x32x16_bf16 v[192:207], v[112:115], a[200:203], v[192:207]
  s_waitcnt vmcnt(6) lgkmcnt(12)
  ds_read_b64_tr_b16 v[112:113], v13 offset:22528
  ds_read_b64_tr_b16 v[114:115], v13 offset:23552
  v_fma_f32 v129, v129, s52, s52
  v_fma_f32 v128, v128, v128, 0.5
  v_rcp_f32 v135, v135
  v_mfma_f32_32x32x16_bf16 v[192:207], v[116:119], a[204:207], v[192:207]
  s_waitcnt lgkmcnt(12)
  ds_read_b64_tr_b16 v[116:117], v10 offset:22528
  ds_read_b64_tr_b16 v[118:119], v10 offset:23552
  v_fma_f32 v86, -v86, v134, v86
  v_cvt_pk_bf16_f32 v186, v84, v85
  v_mul_f32 v92, v92, v29
  v_fma_f32 v130, v130, s52, s52
  v_mfma_f32_32x32x16_bf16 v[208:223], v[120:123], a[144:147], v[208:223]
  s_waitcnt vmcnt(5) lgkmcnt(12)
  ds_read_b64_tr_b16 v[120:121], v10 offset:28672
  ds_read_b64_tr_b16 v[122:123], v10 offset:29696
  v_exp_f32 v131, v91
  v_fma_f32 v129, v129, v129, 0.5
  v_fma_f32 v87, -v87, v135, v87
  v_mfma_f32_32x32x16_bf16 v[192:207], v[124:127], a[208:211], v[192:207]
  s_waitcnt vmcnt(0) lgkmcnt(12)
  ds_read_b64_tr_b16 v[124:125], v13 offset:24576
  ds_read_b64_tr_b16 v[126:127], v13 offset:25600
  buffer_store_dword v18, off, s[36:39], s72 offset:256 sc1
  v_rcp_f32 v128, v128
  v_mul_f32 v93, v93, v29
  v_mfma_f32_32x32x16_bf16 v[208:223], v[96:99], a[148:151], v[208:223]
  s_waitcnt lgkmcnt(12)
  ds_read_b64_tr_b16 v[96:97], v13 offset:26624
  ds_read_b64_tr_b16 v[98:99], v13 offset:27648
  v_exp_f32 v132, v92
  v_fma_f32 v131, v131, s52, s52
  v_fma_f32 v130, v130, v130, 0.5
  v_mfma_f32_32x32x16_bf16 v[192:207], v[100:103], a[212:215], v[192:207]
  s_waitcnt lgkmcnt(12)
  ds_read_b64_tr_b16 v[100:101], v13 offset:28672
  ds_read_b64_tr_b16 v[102:103], v13 offset:29696
  v_rcp_f32 v129, v129
  v_fma_f32 v88, -v88, v128, v88
  v_cvt_pk_bf16_f32 v187, v86, v87
  v_mfma_f32_32x32x16_bf16 v[208:223], v[104:107], a[152:155], v[208:223]
  s_waitcnt lgkmcnt(12)
  ds_read_b64_tr_b16 v[104:105], v13 offset:30720
  ds_read_b64_tr_b16 v[106:107], v13 offset:31744
  v_mul_f32 v94, v94, v29
  v_exp_f32 v133, v93
  v_fma_f32 v132, v132, s52, s52
  v_mfma_f32_32x32x16_bf16 v[192:207], v[108:111], a[216:219], v[192:207]
  s_waitcnt lgkmcnt(12)
  ds_read_b64_tr_b16 v[108:109], v11 offset:24576
  ds_read_b64_tr_b16 v[110:111], v11 offset:25600
  v_fma_f32 v131, v131, v131, 0.5
  v_rcp_f32 v130, v130
  v_fma_f32 v89, -v89, v129, v89
  v_mfma_f32_32x32x16_bf16 v[208:223], v[112:115], a[156:159], v[208:223]
  s_waitcnt lgkmcnt(12)
  ds_read_b64_tr_b16 v[112:113], v11 offset:26624
  ds_read_b64_tr_b16 v[114:115], v11 offset:27648
  v_mul_f32 v95, v95, v29
  v_exp_f32 v134, v94
  v_fma_f32 v133, v133, s52, s52
  v_mfma_f32_32x32x16_bf16 v[192:207], v[116:119], a[220:223], v[192:207]
  s_waitcnt lgkmcnt(12)
  ds_read_b64_tr_b16 v[116:117], v10 offset:30720
  ds_read_b64_tr_b16 v[118:119], v10 offset:31744
  v_mov_b32 v0, 0x400
  buffer_store_dword v0, off, s[36:39], s72 sc1
  v_fma_f32 v132, v132, v132, 0.5
  v_fma_f32 v90, -v90, v130, v90
  v_mfma_f32_32x32x16_bf16 v[192:207], v[120:123], v[184:187], v[192:207]
  s_waitcnt lgkmcnt(12)
  ds_read_b64_tr_b16 v[120:121], v11 offset:0
  ds_read_b64_tr_b16 v[122:123], v11 offset:1024
  v_rcp_f32 v131, v131
  v_cvt_pk_bf16_f32 v188, v88, v89
  v_fma_f32 v134, v134, s52, s52
  v_mfma_f32_32x32x16_bf16 v[208:223], v[124:127], a[160:163], v[208:223]
  s_waitcnt lgkmcnt(12)
  ds_read_b64_tr_b16 v[124:125], v11 offset:2048
  ds_read_b64_tr_b16 v[126:127], v11 offset:3072
  v_exp_f32 v135, v95
  v_fma_f32 v133, v133, v133, 0.5
  v_fma_f32 v91, -v91, v131, v91
  v_mfma_f32_32x32x16_bf16 v[208:223], v[96:99], a[164:167], v[208:223]
  s_waitcnt lgkmcnt(12)
  ds_read_b64_tr_b16 v[96:97], v11 offset:4096
  ds_read_b64_tr_b16 v[98:99], v11 offset:5120
  v_rcp_f32 v132, v132
  v_fma_f32 v135, v135, s52, s52
  v_fma_f32 v134, v134, v134, 0.5
  v_mfma_f32_32x32x16_bf16 v[208:223], v[100:103], a[168:171], v[208:223]
  s_waitcnt lgkmcnt(12)
  ds_read_b64_tr_b16 v[100:101], v11 offset:6144
  ds_read_b64_tr_b16 v[102:103], v11 offset:7168
  buffer_load_dword v254, v9, s[36:39], s70 offen offset:256 sc1
  v_rcp_f32 v133, v133
  v_fma_f32 v92, -v92, v132, v92
  v_mfma_f32_32x32x16_bf16 v[208:223], v[104:107], a[172:175], v[208:223]
  s_waitcnt lgkmcnt(12)
  ds_read_b64_tr_b16 v[104:105], v11 offset:8192
  ds_read_b64_tr_b16 v[106:107], v11 offset:9216
  v_cvt_pk_bf16_f32 v189, v90, v91
  v_fma_f32 v135, v135, v135, 0.5
  v_rcp_f32 v134, v134
  v_mfma_f32_32x32x16_bf16 v[208:223], v[108:111], v[176:179], v[208:223]
  s_waitcnt lgkmcnt(12)
  ds_read_b64_tr_b16 v[108:109], v11 offset:10240
  ds_read_b64_tr_b16 v[110:111], v11 offset:11264
  buffer_load_dword v17, v6, s[36:39], s70 offen sc1
  v_fma_f32 v93, -v93, v133, v93
  v_rcp_f32 v135, v135
  v_mfma_f32_32x32x16_bf16 v[208:223], v[112:115], v[180:183], v[208:223]
  s_waitcnt lgkmcnt(12)
  ds_read_b64_tr_b16 v[112:113], v11 offset:12288
  ds_read_b64_tr_b16 v[114:115], v11 offset:13312
  v_fma_f32 v94, -v94, v134, v94
  v_cvt_pk_bf16_f32 v190, v92, v93
  v_fma_f32 v95, -v95, v135, v95
  v_cvt_pk_bf16_f32 v191, v94, v95
  s_nop 1
  v_mfma_f32_32x32x16_bf16 v[192:207], v[116:119], v[188:191], v[192:207]
  s_waitcnt lgkmcnt(12)
  ds_read_b64_tr_b16 v[116:117], v11 offset:14336
  ds_read_b64_tr_b16 v[118:119], v11 offset:15360
  v_mfma_f32_32x32x16_bf16 v[208:223], v[120:123], a[176:179], v[208:223]
  s_waitcnt lgkmcnt(12)
  ds_read_b64_tr_b16 v[120:121], v11 offset:16384
  ds_read_b64_tr_b16 v[122:123], v11 offset:17408
  v_mfma_f32_32x32x16_bf16 v[208:223], v[124:127], a[180:183], v[208:223]
  s_waitcnt lgkmcnt(12)
  ds_read_b64_tr_b16 v[124:125], v11 offset:18432
  ds_read_b64_tr_b16 v[126:127], v11 offset:19456
  v_mfma_f32_32x32x16_bf16 v[208:223], v[96:99], a[184:187], v[208:223]
  s_waitcnt lgkmcnt(12)
  ds_read_b64_tr_b16 v[96:97], v11 offset:20480
  ds_read_b64_tr_b16 v[98:99], v11 offset:21504
  v_mfma_f32_32x32x16_bf16 v[208:223], v[100:103], a[188:191], v[208:223]
  s_waitcnt lgkmcnt(12)
  ds_read_b64_tr_b16 v[100:101], v11 offset:22528
  ds_read_b64_tr_b16 v[102:103], v11 offset:23552
  v_mfma_f32_32x32x16_bf16 v[208:223], v[104:107], a[192:195], v[208:223]
  s_waitcnt lgkmcnt(12)
  ds_read_b64_tr_b16 v[104:105], v11 offset:28672
  ds_read_b64_tr_b16 v[106:107], v11 offset:29696
  v_mfma_f32_32x32x16_bf16 v[208:223], v[108:111], a[196:199], v[208:223]
  s_waitcnt lgkmcnt(12)
  ds_read_b64_tr_b16 v[108:109], v11 offset:30720
  ds_read_b64_tr_b16 v[110:111], v11 offset:31744
  v_mfma_f32_32x32x16_bf16 v[208:223], v[112:115], a[200:203], v[208:223]
  s_waitcnt vmcnt(1)
  ds_read_b64_tr_b16 v[112:113], v10 offset:32768
  ds_read_b64_tr_b16 v[114:115], v10 offset:33792
  v_cmp_gt_u32 vcc, 0x1, v254
  s_cbranch_vccnz L_spin_32_s
L_back_33_s:
  buffer_load_dwordx4 a[0:3], v7, s[36:39], s9 offen offset:0 sc1
  buffer_load_dwordx4 a[4:7], v7, s[36:39], s9 offen offset:1024 sc1
  s_waitcnt lgkmcnt(14)
  v_mfma_f32_32x32x16_bf16 v[208:223], v[116:119], a[204:207], v[208:223]
  s_waitcnt lgkmcnt(12)
  ds_read_b64_tr_b16 v[116:117], v11 offset:32768
  ds_read_b64_tr_b16 v[118:119], v11 offset:33792
  buffer_load_dwordx4 a[8:11], v7, s[36:39], s10 offen offset:0 sc1
  buffer_load_dwordx4 a[12:15], v7, s[36:39], s10 offen offset:1024 sc1
  buffer_load_dwordx4 a[16:19], v7, s[36:39], s11 offen offset:0 sc1
  v_mfma_f32_32x32x16_bf16 v[208:223], v[120:123], a[208:211], v[208:223]
  s_waitcnt vmcnt(5)
  ds_read_b64_tr_b16 v[120:121], v10 offset:34816
  ds_read_b64_tr_b16 v[122:123], v10 offset:35840
  v_cmp_gt_u32 vcc, 0x400, v17
  s_cbranch_vccnz L_spin_35_s
L_back_36_s:
  s_waitcnt lgkmcnt(14)
  v_mfma_f32_32x32x16_bf16 v[208:223], v[124:127], a[212:215], v[208:223]
  s_waitcnt lgkmcnt(12)
  ds_read_b64_tr_b16 v[124:125], v11 offset:34816
  ds_read_b64_tr_b16 v[126:127], v11 offset:35840
  buffer_load_dwordx4 a[20:23], v7, s[36:39], s11 offen offset:1024 sc1
  buffer_store_dwordx4 v[184:187], v8, s[28:31], s8 offen offset:0 sc1
  buffer_store_dwordx4 v[188:191], v8, s[28:31], s8 offen offset:1024 sc1
  v_mfma_f32_32x32x16_bf16 v[208:223], v[96:99], a[216:219], v[208:223]
  s_waitcnt lgkmcnt(12)
  ds_read_b64_tr_b16 v[96:97], v10 offset:36864
  ds_read_b64_tr_b16 v[98:99], v10 offset:37888
  v_mfma_f32_32x32x16_bf16 v[208:223], v[100:103], a[220:223], v[208:223]
  s_waitcnt lgkmcnt(12)
  ds_read_b64_tr_b16 v[100:101], v11 offset:36864
  ds_read_b64_tr_b16 v[102:103], v11 offset:37888
  buffer_load_dwordx4 a[24:27], v7, s[36:39], s12 offen offset:0 sc1
  v_mfma_f32_32x32x16_bf16 v[208:223], v[104:107], v[184:187], v[208:223]
  s_waitcnt lgkmcnt(12)
  ds_read_b64_tr_b16 v[104:105], v10 offset:38912
  ds_read_b64_tr_b16 v[106:107], v10 offset:39936
  v_mfma_f32_32x32x16_bf16 v[208:223], v[108:111], v[188:191], v[208:223]
  s_waitcnt vmcnt(8) lgkmcnt(12)
  ds_read_b64_tr_b16 v[108:109], v11 offset:38912
  ds_read_b64_tr_b16 v[110:111], v11 offset:39936
  buffer_load_dwordx4 a[28:31], v7, s[36:39], s12 offen offset:1024 sc1
  v_mfma_f32_32x32x16_bf16 v[192:207], v[112:115], a[0:3], v[192:207]
  s_waitcnt lgkmcnt(12)
  ds_read_b64_tr_b16 v[112:113], v10 offset:40960
  ds_read_b64_tr_b16 v[114:115], v10 offset:41984
  v_mfma_f32_32x32x16_bf16 v[208:223], v[116:119], a[0:3], v[208:223]
  s_waitcnt vmcnt(8) lgkmcnt(12)
  ds_read_b64_tr_b16 v[116:117], v11 offset:40960
  ds_read_b64_tr_b16 v[118:119], v11 offset:41984
  buffer_load_dwordx4 a[32:35], v7, s[36:39], s13 offen offset:0 sc1
  v_mfma_f32_32x32x16_bf16 v[192:207], v[120:123], a[4:7], v[192:207]
  s_waitcnt lgkmcnt(12)
  ds_read_b64_tr_b16 v[120:121], v10 offset:43008
  ds_read_b64_tr_b16 v[122:123], v10 offset:44032
  v_mfma_f32_32x32x16_bf16 v[208:223], v[124:127], a[4:7], v[208:223]
  s_waitcnt vmcnt(8) lgkmcnt(12)
  ds_read_b64_tr_b16 v[124:125], v11 offset:43008
  ds_read_b64_tr_b16 v[126:127], v11 offset:44032
  buffer_load_dwordx4 a[36:39], v7, s[36:39], s13 offen offset:1024 sc1
  v_mfma_f32_32x32x16_bf16 v[192:207], v[96:99], a[8:11], v[192:207]
  s_waitcnt lgkmcnt(12)
  ds_read_b64_tr_b16 v[96:97], v10 offset:45056
  ds_read_b64_tr_b16 v[98:99], v10 offset:46080
  v_mfma_f32_32x32x16_bf16 v[208:223], v[100:103], a[8:11], v[208:223]
  s_waitcnt vmcnt(4) lgkmcnt(12)
  ds_read_b64_tr_b16 v[100:101], v11 offset:45056
  ds_read_b64_tr_b16 v[102:103], v11 offset:46080
  buffer_load_dwordx4 a[40:43], v7, s[36:39], s14 offen offset:0 sc1
  buffer_store_dword v18, off, s[36:39], s72 offset:320 sc1
  v_mfma_f32_32x32x16_bf16 v[192:207], v[104:107], a[12:15], v[192:207]
  s_waitcnt lgkmcnt(12)
  ds_read_b64_tr_b16 v[104:105], v10 offset:47104
  ds_read_b64_tr_b16 v[106:107], v10 offset:48128
  v_mfma_f32_32x32x16_bf16 v[208:223], v[108:111], a[12:15], v[208:223]
  s_waitcnt lgkmcnt(12)
  ds_read_b64_tr_b16 v[108:109], v11 offset:47104
  ds_read_b64_tr_b16 v[110:111], v11 offset:48128
  buffer_load_dwordx4 a[44:47], v7, s[36:39], s14 offen offset:1024 sc1
  v_mfma_f32_32x32x16_bf16 v[192:207], v[112:115], a[16:19], v[192:207]
  s_waitcnt lgkmcnt(12)
  ds_read_b64_tr_b16 v[112:113], v10 offset:49152
  ds_read_b64_tr_b16 v[114:115], v10 offset:50176
  v_mfma_f32_32x32x16_bf16 v[208:223], v[116:119], a[16:19], v[208:223]
  s_waitcnt lgkmcnt(12)
  ds_read_b64_tr_b16 v[116:117], v11 offset:49152
  ds_read_b64_tr_b16 v[118:119], v11 offset:50176
  v_mfma_f32_32x32x16_bf16 v[192:207], v[120:123], a[20:23], v[192:207]
  s_waitcnt lgkmcnt(12)
  ds_read_b64_tr_b16 v[120:121], v10 offset:51200
  ds_read_b64_tr_b16 v[122:123], v10 offset:52224
  v_mfma_f32_32x32x16_bf16 v[208:223], v[124:127], a[20:23], v[208:223]
  s_waitcnt vmcnt(6) lgkmcnt(12)
  ds_read_b64_tr_b16 v[124:125], v11 offset:51200
  ds_read_b64_tr_b16 v[126:127], v11 offset:52224
  v_mfma_f32_32x32x16_bf16 v[192:207], v[96:99], a[24:27], v[192:207]
  s_waitcnt lgkmcnt(12)
  ds_read_b64_tr_b16 v[96:97], v10 offset:53248
  ds_read_b64_tr_b16 v[98:99], v10 offset:54272
  v_mfma_f32_32x32x16_bf16 v[208:223], v[100:103], a[24:27], v[208:223]
  s_waitcnt vmcnt(5) lgkmcnt(12)
  ds_read_b64_tr_b16 v[100:101], v11 offset:53248
  ds_read_b64_tr_b16 v[102:103], v11 offset:54272
  v_mfma_f32_32x32x16_bf16 v[192:207], v[104:107], a[28:31], v[192:207]
  s_waitcnt lgkmcnt(12)
  ds_read_b64_tr_b16 v[104:105], v10 offset:55296
  ds_read_b64_tr_b16 v[106:107], v10 offset:56320
  buffer_load_dword v255, v9, s[36:39], s70 offen offset:320 sc1
  v_mfma_f32_32x32x16_bf16 v[208:223], v[108:111], a[28:31], v[208:223]
  s_waitcnt vmcnt(5) lgkmcnt(12)
  ds_read_b64_tr_b16 v[108:109], v11 offset:55296
  ds_read_b64_tr_b16 v[110:111], v11 offset:56320
  v_mfma_f32_32x32x16_bf16 v[192:207], v[112:115], a[32:35], v[192:207]
  s_waitcnt lgkmcnt(12)
  ds_read_b64_tr_b16 v[112:113], v10 offset:57344
  ds_read_b64_tr_b16 v[114:115], v10 offset:58368
  v_mfma_f32_32x32x16_bf16 v[208:223], v[116:119], a[32:35], v[208:223]
  s_waitcnt vmcnt(4) lgkmcnt(12)
  ds_read_b64_tr_b16 v[116:117], v11 offset:57344
  ds_read_b64_tr_b16 v[118:119], v11 offset:58368
  v_mfma_f32_32x32x16_bf16 v[192:207], v[120:123], a[36:39], v[192:207]
  s_waitcnt lgkmcnt(12)
  ds_read_b64_tr_b16 v[120:121], v10 offset:59392
  ds_read_b64_tr_b16 v[122:123], v10 offset:60416
  v_mfma_f32_32x32x16_bf16 v[208:223], v[124:127], a[36:39], v[208:223]
  s_waitcnt vmcnt(3) lgkmcnt(12)
  ds_read_b64_tr_b16 v[124:125], v11 offset:59392
  ds_read_b64_tr_b16 v[126:127], v11 offset:60416
  v_mfma_f32_32x32x16_bf16 v[192:207], v[96:99], a[40:43], v[192:207]
  s_waitcnt lgkmcnt(12)
  ds_read_b64_tr_b16 v[96:97], v10 offset:61440
  ds_read_b64_tr_b16 v[98:99], v10 offset:62464
  v_mfma_f32_32x32x16_bf16 v[208:223], v[100:103], a[40:43], v[208:223]
  s_waitcnt vmcnt(1) lgkmcnt(12)
  ds_read_b64_tr_b16 v[100:101], v11 offset:61440
  ds_read_b64_tr_b16 v[102:103], v11 offset:62464
  v_mfma_f32_32x32x16_bf16 v[192:207], v[104:107], a[44:47], v[192:207]
  s_waitcnt lgkmcnt(12)
  ds_read_b64_tr_b16 v[104:105], v10 offset:63488
  ds_read_b64_tr_b16 v[106:107], v10 offset:64512
  v_mov_b32 v0, 0x500
  buffer_store_dword v0, off, s[36:39], s72 sc1
  v_mfma_f32_32x32x16_bf16 v[208:223], v[108:111], a[44:47], v[208:223]
  s_waitcnt vmcnt(1)
  ds_read_b64_tr_b16 v[108:109], v11 offset:63488
  ds_read_b64_tr_b16 v[110:111], v11 offset:64512
  v_cmp_gt_u32 vcc, 0x1, v255
  s_cbranch_vccnz L_spin_38_s
L_back_39_s:
  buffer_load_dwordx4 a[48:51], v8, s[28:31], s9 offen offset:0 sc1
  buffer_load_dwordx4 a[52:55], v8, s[28:31], s9 offen offset:1024 sc1
  buffer_load_dwordx4 a[56:59], v8, s[28:31], s10 offen offset:0 sc1
  buffer_load_dwordx4 a[60:63], v8, s[28:31], s10 offen offset:1024 sc1
  buffer_load_dwordx4 a[64:67], v8, s[28:31], s11 offen offset:0 sc1
  buffer_load_dwordx4 a[68:71], v8, s[28:31], s11 offen offset:1024 sc1
  buffer_load_dwordx4 a[72:75], v8, s[28:31], s12 offen offset:0 sc1
  buffer_load_dwordx4 a[76:79], v8, s[28:31], s12 offen offset:1024 sc1
  s_waitcnt vmcnt(7) lgkmcnt(14)
  v_mfma_f32_32x32x16_bf16 v[192:207], v[112:115], a[48:51], v[192:207]
  s_barrier
  ds_read_b64_tr_b16 v[112:113], v14 offset:0
  ds_read_b64_tr_b16 v[114:115], v14 offset:1024
  s_waitcnt lgkmcnt(14)
  v_mfma_f32_32x32x16_bf16 v[208:223], v[116:119], a[48:51], v[208:223]
  s_waitcnt vmcnt(6) lgkmcnt(12)
  ds_read_b64_tr_b16 v[116:117], v15 offset:0
  ds_read_b64_tr_b16 v[118:119], v15 offset:1024
  buffer_load_dwordx4 a[80:83], v8, s[28:31], s13 offen offset:0 sc1
  v_mfma_f32_32x32x16_bf16 v[192:207], v[120:123], a[52:55], v[192:207]
  s_waitcnt lgkmcnt(12)
  ds_read_b64_tr_b16 v[120:121], v14 offset:2048
  ds_read_b64_tr_b16 v[122:123], v14 offset:3072
  v_mfma_f32_32x32x16_bf16 v[208:223], v[124:127], a[52:55], v[208:223]
  s_waitcnt vmcnt(6) lgkmcnt(12)
  ds_read_b64_tr_b16 v[124:125], v15 offset:2048
  ds_read_b64_tr_b16 v[126:127], v15 offset:3072
  buffer_load_dwordx4 a[84:87], v8, s[28:31], s13 offen offset:1024 sc1
  v_mfma_f32_32x32x16_bf16 v[192:207], v[96:99], a[56:59], v[192:207]
  s_waitcnt lgkmcnt(12)
  ds_read_b64_tr_b16 v[96:97], v14 offset:4096
  ds_read_b64_tr_b16 v[98:99], v14 offset:5120
  v_mfma_f32_32x32x16_bf16 v[208:223], v[100:103], a[56:59], v[208:223]
  s_waitcnt vmcnt(6) lgkmcnt(12)
  ds_read_b64_tr_b16 v[100:101], v15 offset:4096
  ds_read_b64_tr_b16 v[102:103], v15 offset:5120
  buffer_load_dword v17, v6, s[36:39], s70 offen sc1
  buffer_load_dwordx4 a[88:91], v8, s[28:31], s14 offen offset:0 sc1
  v_mfma_f32_32x32x16_bf16 v[192:207], v[104:107], a[60:63], v[192:207]
  s_waitcnt lgkmcnt(12)
  ds_read_b64_tr_b16 v[104:105], v14 offset:6144
  ds_read_b64_tr_b16 v[106:107], v14 offset:7168
  v_mfma_f32_32x32x16_bf16 v[208:223], v[108:111], a[60:63], v[208:223]
  s_waitcnt vmcnt(7) lgkmcnt(12)
  ds_read_b64_tr_b16 v[108:109], v15 offset:6144
  ds_read_b64_tr_b16 v[110:111], v15 offset:7168
  buffer_load_dwordx4 a[92:95], v8, s[28:31], s14 offen offset:1024 sc1
  v_mfma_f32_32x32x16_bf16 v[192:207], v[112:115], a[64:67], v[192:207]
  s_waitcnt lgkmcnt(12)
  ds_read_b64_tr_b16 v[112:113], v14 offset:8192
  ds_read_b64_tr_b16 v[114:115], v14 offset:9216
  v_mfma_f32_32x32x16_bf16 v[208:223], v[116:119], a[64:67], v[208:223]
  s_waitcnt vmcnt(7) lgkmcnt(12)
  ds_read_b64_tr_b16 v[116:117], v15 offset:8192
  ds_read_b64_tr_b16 v[118:119], v15 offset:9216
  v_mfma_f32_32x32x16_bf16 v[192:207], v[120:123], a[68:71], v[192:207]
  s_waitcnt lgkmcnt(12)
  ds_read_b64_tr_b16 v[120:121], v14 offset:10240
  ds_read_b64_tr_b16 v[122:123], v14 offset:11264
  v_mfma_f32_32x32x16_bf16 v[208:223], v[124:127], a[68:71], v[208:223]
  s_waitcnt vmcnt(6) lgkmcnt(12)
  ds_read_b64_tr_b16 v[124:125], v15 offset:10240
  ds_read_b64_tr_b16 v[126:127], v15 offset:11264
  v_mfma_f32_32x32x16_bf16 v[192:207], v[96:99], a[72:75], v[192:207]
  s_waitcnt lgkmcnt(12)
  ds_read_b64_tr_b16 v[96:97], v14 offset:12288
  ds_read_b64_tr_b16 v[98:99], v14 offset:13312
  v_mfma_f32_32x32x16_bf16 v[208:223], v[100:103], a[72:75], v[208:223]
  s_waitcnt vmcnt(5) lgkmcnt(12)
  ds_read_b64_tr_b16 v[100:101], v15 offset:12288
  ds_read_b64_tr_b16 v[102:103], v15 offset:13312
  v_mfma_f32_32x32x16_bf16 v[192:207], v[104:107], a[76:79], v[192:207]
  s_waitcnt lgkmcnt(12)
  ds_read_b64_tr_b16 v[104:105], v14 offset:14336
  ds_read_b64_tr_b16 v[106:107], v14 offset:15360
  v_mfma_f32_32x32x16_bf16 v[208:223], v[108:111], a[76:79], v[208:223]
  s_waitcnt vmcnt(2)
  ds_read_b64_tr_b16 v[108:109], v15 offset:14336
  ds_read_b64_tr_b16 v[110:111], v15 offset:15360
  v_cmp_gt_u32 vcc, 0x500, v17
  s_cbranch_vccnz L_spin_41_s
L_back_42_s:
  s_waitcnt lgkmcnt(14)
  v_mfma_f32_32x32x16_bf16 v[192:207], v[112:115], a[80:83], v[192:207]
  s_waitcnt lgkmcnt(12)
  v_mfma_f32_32x32x16_bf16 v[208:223], v[116:119], a[80:83], v[208:223]
  s_waitcnt lgkmcnt(10)
  v_mfma_f32_32x32x16_bf16 v[192:207], v[120:123], a[84:87], v[192:207]
  s_waitcnt lgkmcnt(8)
  v_mfma_f32_32x32x16_bf16 v[208:223], v[124:127], a[84:87], v[208:223]
  s_waitcnt vmcnt(1) lgkmcnt(6)
  v_mfma_f32_32x32x16_bf16 v[192:207], v[96:99], a[88:91], v[192:207]
  s_waitcnt lgkmcnt(4)
  v_mfma_f32_32x32x16_bf16 v[208:223], v[100:103], a[88:91], v[208:223]
  s_waitcnt vmcnt(0) lgkmcnt(2)
  v_mfma_f32_32x32x16_bf16 v[192:207], v[104:107], a[92:95], v[192:207]
  s_waitcnt lgkmcnt(0)
  v_mov_b32 v0, 0x600
  buffer_store_dword v0, off, s[36:39], s72 sc1
  v_mfma_f32_32x32x16_bf16 v[208:223], v[108:111], a[92:95], v[208:223]
  s_nop 7
  v_cvt_pk_bf16_f32 v128, v192, v193
  v_cvt_pk_bf16_f32 v129, v194, v195
  v_or_b32 v128, 1, v128
  v_cvt_pk_bf16_f32 v130, v196, v197
  v_cvt_pk_bf16_f32 v131, v198, v199
  v_cvt_pk_bf16_f32 v132, v200, v201
  v_cvt_pk_bf16_f32 v133, v202, v203
  v_or_b32 v132, 1, v132
  v_cvt_pk_bf16_f32 v134, v204, v205
  v_cvt_pk_bf16_f32 v135, v206, v207
  v_pk_fma_f32 v[224:225], v[208:209], s[24:25], v[224:225]
  v_pk_fma_f32 v[226:227], v[210:211], s[24:25], v[226:227]
  v_pk_fma_f32 v[228:229], v[212:213], s[24:25], v[228:229]
  v_pk_fma_f32 v[230:231], v[214:215], s[24:25], v[230:231]
  v_pk_fma_f32 v[232:233], v[216:217], s[24:25], v[232:233]
  v_pk_fma_f32 v[234:235], v[218:219], s[24:25], v[234:235]
  buffer_store_dwordx4 v[128:131], v21, s[36:39], s74 offen offset:0 sc1
  buffer_store_dwordx4 v[132:135], v21, s[36:39], s74 offen offset:1024 sc1
  buffer_load_dwordx4 v[244:247], v21, s[36:39], s75 offen offset:0 sc1
  buffer_load_dwordx4 v[248:251], v21, s[36:39], s75 offen offset:1024 sc1
  buffer_load_dword v252, v6, s[36:39], s70 offen sc1
  v_pk_fma_f32 v[236:237], v[220:221], s[24:25], v[236:237]
  v_pk_fma_f32 v[238:239], v[222:223], s[24:25], v[238:239]
  s_lshl_b32 s57, s64, 15
  s_lshl_b32 s58, s99, 6
  s_add_u32 s57, s57, s58
  s_add_u32 s58, s57, 0x4000
  v_and_b32 v253, 31, v1
  v_lshrrev_b32 v254, 2, v253
  v_lshrrev_b32 v255, 5, v1
  v_xor_b32 v254, v254, v255
  v_and_b32 v254, 3, v254
  v_lshlrev_b32 v254, 4, v254
  v_lshl_add_u32 v253, v253, 6, v254
  v_add_u32 v253, s63, v253
  v_xor_b32 v254, 32, v253
  v_add_u32 v255, s63, v2
  v_lshrrev_b32 v0, 4, v1
  v_xor_b32 v0, v0, v1
  v_and_b32 v0, 3, v0
  v_lshlrev_b32 v0, 4, v0
  v_lshrrev_b32 v19, 2, v1
  v_lshl_add_u32 v19, v19, 10, v0
  s_waitcnt vmcnt(1)
  v_and_b32 v0, v244, v248
  v_lshlrev_b32 v0, 31, v0
  s_waitcnt vmcnt(0)
  v_min_u32 v0, v0, v252
  v_cmp_gt_u32 vcc, 0x600, v0
  s_cbranch_vccnz L_xspin_44_s
L_xback_45_s:
  v_lshlrev_b32 v128, 16, v244
  v_and_b32 v129, 0xffff0000, v244
  v_lshlrev_b32 v130, 16, v245
  v_and_b32 v131, 0xffff0000, v245
  v_lshlrev_b32 v132, 16, v246
  v_and_b32 v133, 0xffff0000, v246
  v_lshlrev_b32 v134, 16, v247
  v_and_b32 v135, 0xffff0000, v247
  v_pk_fma_f32 v[224:225], v[128:129], s[24:25], v[224:225]
  v_pk_fma_f32 v[226:227], v[130:131], s[24:25], v[226:227]
  v_pk_fma_f32 v[228:229], v[132:133], s[24:25], v[228:229]
  v_pk_fma_f32 v[230:231], v[134:135], s[24:25], v[230:231]
  v_cvt_pk_bf16_f32 v244, v224, v225
  v_cvt_pk_bf16_f32 v245, v226, v227
  v_cvt_pk_bf16_f32 v246, v228, v229
  v_cvt_pk_bf16_f32 v247, v230, v231
  s_nop 0
  v_permlane32_swap_b32 v244, v246
  v_permlane32_swap_b32 v245, v247
  ds_write_b128 v253, v[244:247] offset:16384
  v_lshlrev_b32 v136, 16, v248
  v_and_b32 v137, 0xffff0000, v248
  v_lshlrev_b32 v138, 16, v249
  v_and_b32 v139, 0xffff0000, v249
  v_lshlrev_b32 v140, 16, v250
  v_and_b32 v141, 0xffff0000, v250
  v_lshlrev_b32 v142, 16, v251
  v_and_b32 v143, 0xffff0000, v251
  v_pk_fma_f32 v[232:233], v[136:137], s[24:25], v[232:233]
  v_pk_fma_f32 v[234:235], v[138:139], s[24:25], v[234:235]
  v_pk_fma_f32 v[236:237], v[140:141], s[24:25], v[236:237]
  v_pk_fma_f32 v[238:239], v[142:143], s[24:25], v[238:239]
  v_cvt_pk_bf16_f32 v248, v232, v233
  v_cvt_pk_bf16_f32 v249, v234, v235
  v_cvt_pk_bf16_f32 v250, v236, v237
  v_cvt_pk_bf16_f32 v251, v238, v239
  s_nop 0
  v_permlane32_swap_b32 v248, v250
  v_permlane32_swap_b32 v249, v251
  ds_write_b128 v254, v[248:251] offset:16384
  ds_read_b128 v[244:247], v255 offset:16384
  ds_read_b128 v[248:251], v255 offset:17408
  s_waitcnt lgkmcnt(1)
  buffer_store_dwordx4 v[244:247], v19, s[28:31], s57 offen sc1
  s_waitcnt lgkmcnt(0)
  buffer_store_dwordx4 v[248:251], v19, s[28:31], s58 offen sc1
  s_endpgm
L_idle_s:
  s_waitcnt vmcnt(0) lgkmcnt(0)
  s_barrier
  s_and_b32 s57, s2, 31
  s_lshl_b32 s57, s57, 1
  s_and_b32 s58, s3, 1
  s_add_u32 s57, s57, s58
  s_lshl_b32 s59, s57, 6
  v_and_b32 v30, 31, v1
  v_lshlrev_b32 v30, 1, v30
  buffer_load_ushort v31, v30, s[40:43], s59 offen
  s_lshl_b32 s58, s58, 6
  s_lshr_b32 s59, s3, 1
  s_lshl_b32 s60, s59, 15
  v_xor_b32 v240, s58, v10
  v_add_u32 v240, s60, v240
  s_lshl_b32 s57, s57, 9
  s_lshl_b32 s58, s59, 3
  s_add_u32 s57, s57, s58
  s_add_u32 s60, s57, 98304
  s_sub_u32 s59, s59, 1
  v_mov_b32 v22, 0
  v_mov_b32 v23, 0
  ds_read_b64_tr_b16 v[160:161], v240 offset:0
  ds_read_b64_tr_b16 v[162:163], v240 offset:1024
  ds_read_b64_tr_b16 v[164:165], v240 offset:2048
  ds_read_b64_tr_b16 v[166:167], v240 offset:3072
  ds_read_b64_tr_b16 v[168:169], v240 offset:4096
  ds_read_b64_tr_b16 v[170:171], v240 offset:5120
  ds_read_b64_tr_b16 v[172:173], v240 offset:6144
  ds_read_b64_tr_b16 v[174:175], v240 offset:7168
  ds_read_b64_tr_b16 v[176:177], v240 offset:8192
  ds_read_b64_tr_b16 v[178:179], v240 offset:9216
  ds_read_b64_tr_b16 v[180:181], v240 offset:10240
  ds_read_b64_tr_b16 v[182:183], v240 offset:11264
  ds_read_b64_tr_b16 v[184:185], v240 offset:12288
  ds_read_b64_tr_b16 v[186:187], v240 offset:13312
  ds_read_b64_tr_b16 v[188:189], v240 offset:14336
  ds_read_b64_tr_b16 v[190:191], v240 offset:15360
  ds_read_b64_tr_b16 v[192:193], v240 offset:16384
  ds_read_b64_tr_b16 v[194:195], v240 offset:17408
  ds_read_b64_tr_b16 v[196:197], v240 offset:18432
  ds_read_b64_tr_b16 v[198:199], v240 offset:19456
  ds_read_b64_tr_b16 v[200:201], v240 offset:20480
  ds_read_b64_tr_b16 v[202:203], v240 offset:21504
  ds_read_b64_tr_b16 v[204:205], v240 offset:22528
  ds_read_b64_tr_b16 v[206:207], v240 offset:23552
  ds_read_b64_tr_b16 v[208:209], v240 offset:24576
  ds_read_b64_tr_b16 v[210:211], v240 offset:25600
  ds_read_b64_tr_b16 v[212:213], v240 offset:26624
  ds_read_b64_tr_b16 v[214:215], v240 offset:27648
  ds_read_b64_tr_b16 v[216:217], v240 offset:28672
  ds_read_b64_tr_b16 v[218:219], v240 offset:29696
  ds_read_b64_tr_b16 v[220:221], v240 offset:30720
  ds_read_b64_tr_b16 v[222:223], v240 offset:31744
  s_waitcnt lgkmcnt(14)
  v_dot2c_f32_bf16 v23, s44, v160
  v_dot2c_f32_bf16 v22, s44, v161
  v_dot2c_f32_bf16 v23, s44, v162
  v_dot2c_f32_bf16 v22, s44, v163
  v_dot2c_f32_bf16 v23, s44, v164
  v_dot2c_f32_bf16 v22, s44, v165
  v_dot2c_f32_bf16 v23, s44, v166
  v_dot2c_f32_bf16 v22, s44, v167
  v_dot2c_f32_bf16 v23, s44, v168
  v_dot2c_f32_bf16 v22, s44, v169
  v_dot2c_f32_bf16 v23, s44, v170
  v_dot2c_f32_bf16 v22, s44, v171
  v_dot2c_f32_bf16 v23, s44, v172
  v_dot2c_f32_bf16 v22, s44, v173
  v_dot2c_f32_bf16 v23, s44, v174
  v_dot2c_f32_bf16 v22, s44, v175
  v_dot2c_f32_bf16 v23, s44, v176
  v_dot2c_f32_bf16 v22, s44, v177
  v_dot2c_f32_bf16 v23, s44, v178
  v_dot2c_f32_bf16 v22, s44, v179
  v_dot2c_f32_bf16 v23, s44, v180
  v_dot2c_f32_bf16 v22, s44, v181
  v_dot2c_f32_bf16 v23, s44, v182
  v_dot2c_f32_bf16 v22, s44, v183
  v_dot2c_f32_bf16 v23, s44, v184
  v_dot2c_f32_bf16 v22, s44, v185
  v_dot2c_f32_bf16 v23, s44, v186
  v_dot2c_f32_bf16 v22, s44, v187
  v_dot2c_f32_bf16 v23, s44, v188
  v_dot2c_f32_bf16 v22, s44, v189
  v_dot2c_f32_bf16 v23, s44, v190
  v_dot2c_f32_bf16 v22, s44, v191
  v_dot2c_f32_bf16 v23, s44, v192
  v_dot2c_f32_bf16 v22, s44, v193
  v_dot2c_f32_bf16 v23, s44, v194
  v_dot2c_f32_bf16 v22, s44, v195
  s_waitcnt lgkmcnt(13)
  v_dot2c_f32_bf16 v23, s44, v196
  v_dot2c_f32_bf16 v22, s44, v197
  s_waitcnt lgkmcnt(12)
  v_dot2c_f32_bf16 v23, s44, v198
  v_dot2c_f32_bf16 v22, s44, v199
  s_waitcnt lgkmcnt(11)
  v_dot2c_f32_bf16 v23, s44, v200
  v_dot2c_f32_bf16 v22, s44, v201
  s_waitcnt lgkmcnt(10)
  v_dot2c_f32_bf16 v23, s44, v202
  v_dot2c_f32_bf16 v22, s44, v203
  s_waitcnt lgkmcnt(9)
  v_dot2c_f32_bf16 v23, s44, v204
  v_dot2c_f32_bf16 v22, s44, v205
  s_waitcnt lgkmcnt(8)
  v_dot2c_f32_bf16 v23, s44, v206
  v_dot2c_f32_bf16 v22, s44, v207
  s_waitcnt lgkmcnt(7)
  v_dot2c_f32_bf16 v23, s44, v208
  v_dot2c_f32_bf16 v22, s44, v209
  s_waitcnt lgkmcnt(6)
  v_dot2c_f32_bf16 v23, s44, v210
  v_dot2c_f32_bf16 v22, s44, v211
  s_waitcnt lgkmcnt(5)
  v_dot2c_f32_bf16 v23, s44, v212
  v_dot2c_f32_bf16 v22, s44, v213
  s_waitcnt lgkmcnt(4)
  v_dot2c_f32_bf16 v23, s44, v214
  v_dot2c_f32_bf16 v22, s44, v215
  s_waitcnt lgkmcnt(3)
  v_dot2c_f32_bf16 v23, s44, v216
  v_dot2c_f32_bf16 v22, s44, v217
  s_waitcnt lgkmcnt(2)
  v_dot2c_f32_bf16 v23, s44, v218
  v_dot2c_f32_bf16 v22, s44, v219
  s_waitcnt lgkmcnt(1)
  v_dot2c_f32_bf16 v23, s44, v220
  v_dot2c_f32_bf16 v22, s44, v221
  s_waitcnt lgkmcnt(0)
  v_dot2c_f32_bf16 v23, s44, v222
  v_dot2c_f32_bf16 v22, s44, v223
  s_barrier
  s_nop 1
  v_add_f32 v22, v22, v23
  s_waitcnt vmcnt(0)
  v_and_b32 v31, s59, v31
  v_mov_b32 v23, v22
  v_or_b32 v129, 0x3f800000, v31
  s_nop 0
  v_permlane32_swap_b32 v22, v23
  v_add_f32 v22, v22, v23
  v_cvt_pk_bf16_f32 v30, v22, v22
  v_lshlrev_b32 v30, 16, v30
  v_sub_f32 v30, v22, v30
  v_cvt_pk_bf16_f32 v128, v22, v30
  s_mov_b64 exec, 0xffffffff
  buffer_store_dwordx2 v[128:129], v2, s[36:39], s60 offen sc1
  s_mov_b64 exec, -1
  v_add_u32 v12, 0x20000, v14
  v_add_u32 v13, 0x20000, v15
  v_add_u32 v16, 0x18000, v2
  v_min_u32 v9, 6, v1
  s_mul_i32 s57, s71, 28
  v_lshl_add_u32 v9, v9, 2, s57
  v_and_b32 v20, 0x1f0, v2
  v_lshrrev_b32 v30, 5, v1
  v_lshlrev_b32 v30, 4, v30
  v_lshl_add_u32 v19, v20, 6, v30
  s_lshl_b32 s57, s5, 11
  s_add_u32 s74, s57, 1048576
  s_mul_i32 s57, s71, -28672
  s_add_u32 s57, s57, s74
  s_add_u32 s57, s57, 14336
  s_xor_b32 s75, s74, 0x800
  s_cmp_lt_u32 s5, 14
  s_cselect_b32 s75, s57, s75
  s_mov_b32 s52, 0x3f3504f3
  s_mov_b32 s53, 0x3f3504f3
  s_mov_b64 s[32:33], s[36:37]
  v_add_u32 v3, 0x100000, v21
  v_add_u32 v4, 0x0, v21
  v_add_u32 v7, 0x100000, v21
  v_add_u32 v8, 0x0, v21
  s_bfe_u32 s8, s94, 0x40000
  s_lshl_b32 s8, s8, 11
  s_bfe_u32 s9, s94, 0x40004
  s_lshl_b32 s9, s9, 11
  s_bfe_u32 s10, s94, 0x40008
  s_lshl_b32 s10, s10, 11
  s_bfe_u32 s11, s94, 0x4000c
  s_lshl_b32 s11, s11, 11
  s_bfe_u32 s12, s94, 0x40010
  s_lshl_b32 s12, s12, 11
  s_bfe_u32 s13, s94, 0x40014
  s_lshl_b32 s13, s13, 11
  s_bfe_u32 s14, s94, 0x40018
  s_lshl_b32 s14, s14, 11
  buffer_load_dword v17, v6, s[36:39], s70 offen offset:64 sc1
  s_add_u32 m0, s63, 131072
  s_add_u32 s27, s95, 7168
  buffer_load_dwordx4 v5, s[16:19], s95 offen lds
  buffer_load_dwordx4 v5, s[16:19], s27 offen offset:1024 lds
  s_add_u32 m0, s63, 139264
  s_add_u32 s27, s96, 7168
  buffer_load_dwordx4 v5, s[16:19], s96 offen lds
  buffer_load_dwordx4 v5, s[16:19], s27 offen offset:1024 lds
  s_add_u32 m0, s63, 147456
  s_add_u32 s27, s97, 7168
  buffer_load_dwordx4 v5, s[16:19], s97 offen lds
  buffer_load_dwordx4 v5, s[16:19], s27 offen offset:1024 lds
  s_add_u32 m0, s63, 155648
  s_add_u32 s27, s98, 7168
  buffer_load_dwordx4 v5, s[16:19], s98 offen lds
  buffer_load_dwordx4 v5, s[16:19], s27 offen offset:1024 lds
  s_waitcnt vmcnt(8)
  v_cmp_gt_u32 vcc, 0x1, v17
  s_cbranch_vccnz L_spin_47_s
L_back_48_s:
  s_lshl_b32 s58, s99, 11
  s_add_u32 s58, s58, 0
  buffer_load_dwordx4 v[244:247], v21, s[28:31], s58 offen offset:0 sc1
  buffer_load_dwordx4 v[248:251], v21, s[28:31], s58 offen offset:1024 sc1
  v_mov_b32 v132, 0
  v_mov_b32 v133, 0
  v_mov_b32 v134, 0
  v_mov_b32 v135, 0
  buffer_store_dwordx4 v[132:135], v21, s[36:39], s74 offen offset:0 sc1
  buffer_store_dwordx4 v[132:135], v21, s[36:39], s74 offen offset:1024 sc1
  s_add_u32 m0, s63, 32768
  s_add_u32 s26, s96, 32768
  s_add_u32 s27, s96, 39936
  buffer_load_dwordx4 v5, s[16:19], s26 offen lds
  buffer_load_dwordx4 v5, s[16:19], s27 offen offset:1024 lds
  s_add_u32 m0, s63, 40960
  s_add_u32 s26, s97, 32768
  s_add_u32 s27, s97, 39936
  buffer_load_dwordx4 v5, s[16:19], s26 offen lds
  buffer_load_dwordx4 v5, s[16:19], s27 offen offset:1024 lds
  s_add_u32 m0, s63, 49152
  s_add_u32 s26, s98, 32768
  s_add_u32 s27, s98, 39936
  buffer_load_dwordx4 v5, s[16:19], s26 offen lds
  buffer_load_dwordx4 v5, s[16:19], s27 offen offset:1024 lds
  s_add_u32 m0, s63, 57344
  s_add_u32 s26, s95, 65536
  s_add_u32 s27, s95, 72704
  buffer_load_dwordx4 v5, s[16:19], s26 offen lds
  buffer_load_dwordx4 v5, s[16:19], s27 offen offset:1024 lds
  s_waitcnt vmcnt(8)
  buffer_store_dword v18, off, s[36:39], s72 offset:128 sc1
  v_mov_b32 v0, 0x200
  buffer_store_dword v0, off, s[36:39], s72 sc1
  v_lshlrev_b32 v224, 16, v244
  v_and_b32 v225, 0xffff0000, v244
  v_lshlrev_b32 v226, 16, v245
  v_and_b32 v227, 0xffff0000, v245
  v_lshlrev_b32 v228, 16, v246
  v_and_b32 v229, 0xffff0000, v246
  v_lshlrev_b32 v230, 16, v247
  v_and_b32 v231, 0xffff0000, v247
  v_lshlrev_b32 v232, 16, v248
  v_and_b32 v233, 0xffff0000, v248
  v_lshlrev_b32 v234, 16, v249
  v_and_b32 v235, 0xffff0000, v249
  v_lshlrev_b32 v236, 16, v250
  v_and_b32 v237, 0xffff0000, v250
  v_lshlrev_b32 v238, 16, v251
  v_and_b32 v239, 0xffff0000, v251
  s_add_u32 m0, s63, 65536
  s_add_u32 s26, s96, 65536
  s_add_u32 s27, s96, 72704
  buffer_load_dwordx4 v5, s[16:19], s26 offen lds
  buffer_load_dwordx4 v5, s[16:19], s27 offen offset:1024 lds
  s_add_u32 m0, s63, 73728
  s_add_u32 s26, s97, 65536
  s_add_u32 s27, s97, 72704
  buffer_load_dwordx4 v5, s[16:19], s26 offen lds
  buffer_load_dwordx4 v5, s[16:19], s27 offen offset:1024 lds
  s_add_u32 m0, s63, 81920
  s_add_u32 s26, s98, 65536
  s_add_u32 s27, s98, 72704
  buffer_load_dwordx4 v5, s[16:19], s26 offen lds
  buffer_load_dwordx4 v5, s[16:19], s27 offen offset:1024 lds
  s_add_u32 m0, s63, 90112
  s_add_u32 s26, s96, 98304
  s_add_u32 s27, s96, 105472
  buffer_load_dwordx4 v5, s[16:19], s26 offen lds
  buffer_load_dwordx4 v5, s[16:19], s27 offen offset:1024 lds
  s_add_u32 m0, s63, 0
  s_add_u32 s26, s97, 98304
  s_add_u32 s27, s97, 105472
  buffer_load_dwordx4 v5, s[16:19], s26 offen lds
  buffer_load_dwordx4 v5, s[16:19], s27 offen offset:1024 lds
  s_add_u32 m0, s63, 8192
  s_add_u32 s26, s98, 98304
  s_add_u32 s27, s98, 105472
  buffer_load_dwordx4 v5, s[16:19], s26 offen lds
  buffer_load_dwordx4 v5, s[16:19], s27 offen offset:1024 lds
  s_waitcnt vmcnt(0)
  s_barrier
  ds_read_b64_tr_b16 v[96:97], v12 offset:0
  ds_read_b64_tr_b16 v[98:99], v12 offset:1024
  ds_read_b64_tr_b16 v[100:101], v13 offset:0
  ds_read_b64_tr_b16 v[102:103], v13 offset:1024
  ds_read_b64_tr_b16 v[104:105], v12 offset:2048
  ds_read_b64_tr_b16 v[106:107], v12 offset:3072
  ds_read_b64_tr_b16 v[108:109], v13 offset:2048
  ds_read_b64_tr_b16 v[110:111], v13 offset:3072
  ds_read_b64_tr_b16 v[112:113], v12 offset:8192
  ds_read_b64_tr_b16 v[114:115], v12 offset:9216
  ds_read_b64_tr_b16 v[116:117], v13 offset:8192
  ds_read_b64_tr_b16 v[118:119], v13 offset:9216
  ds_read_b64_tr_b16 v[120:121], v12 offset:10240
  ds_read_b64_tr_b16 v[122:123], v12 offset:11264
  ds_read_b64_tr_b16 v[124:125], v13 offset:10240
  ds_read_b64_tr_b16 v[126:127], v13 offset:11264
  buffer_load_dword v252, v6, s[36:39], s70 offen offset:128 sc1
  s_lshl_b32 s60, s99, 2
  s_add_u32 s60, s60, s70
  s_xor_b32 s59, s60, 4
  s_waitcnt vmcnt(0)
  v_cmp_gt_u32 vcc, 0x1, v252
  s_cbranch_vccnz L_spin_50_s
L_back_51_s:
  buffer_load_dwordx4 v[160:163], v3, s[36:39], s8 offen offset:0 sc1
  buffer_load_dwordx4 v[164:167], v3, s[36:39], s8 offen offset:1024 sc1
  buffer_load_dwordx4 a[128:131], v3, s[36:39], s9 offen offset:0 sc1
  buffer_load_dwordx4 a[132:135], v3, s[36:39], s9 offen offset:1024 sc1
  buffer_load_dwordx4 a[136:139], v3, s[36:39], s10 offen offset:0 sc1
  buffer_load_dwordx4 a[140:143], v3, s[36:39], s10 offen offset:1024 sc1
  buffer_load_dwordx4 a[144:147], v3, s[36:39], s11 offen offset:0 sc1
  buffer_load_dwordx4 a[148:151], v3, s[36:39], s11 offen offset:1024 sc1
  s_waitcnt vmcnt(7) lgkmcnt(14)
  v_mfma_f32_32x32x16_bf16 v[192:207], v[96:99], v[160:163], 0
  s_waitcnt lgkmcnt(12)
  ds_read_b64_tr_b16 v[96:97], v12 offset:12288
  ds_read_b64_tr_b16 v[98:99], v12 offset:13312
  v_mfma_f32_32x32x16_bf16 v[208:223], v[100:103], v[160:163], 0
  s_waitcnt vmcnt(6) lgkmcnt(12)
  ds_read_b64_tr_b16 v[100:101], v13 offset:12288
  ds_read_b64_tr_b16 v[102:103], v13 offset:13312
  buffer_load_dwordx4 a[152:155], v3, s[36:39], s12 offen offset:0 sc1
  v_mfma_f32_32x32x16_bf16 v[192:207], v[104:107], v[164:167], v[192:207]
  s_waitcnt lgkmcnt(12)
  ds_read_b64_tr_b16 v[104:105], v12 offset:14336
  ds_read_b64_tr_b16 v[106:107], v12 offset:15360
  v_mfma_f32_32x32x16_bf16 v[208:223], v[108:111], v[164:167], v[208:223]
  s_waitcnt vmcnt(6) lgkmcnt(12)
  ds_read_b64_tr_b16 v[108:109], v13 offset:14336
  ds_read_b64_tr_b16 v[110:111], v13 offset:15360
  buffer_load_dwordx4 a[156:159], v3, s[36:39], s12 offen offset:1024 sc1
  v_mfma_f32_32x32x16_bf16 v[192:207], v[112:115], a[128:131], v[192:207]
  s_waitcnt lgkmcnt(12)
  ds_read_b64_tr_b16 v[112:113], v12 offset:16384
  ds_read_b64_tr_b16 v[114:115], v12 offset:17408
  v_mfma_f32_32x32x16_bf16 v[208:223], v[116:119], a[128:131], v[208:223]
  s_waitcnt vmcnt(6) lgkmcnt(12)
  ds_read_b64_tr_b16 v[116:117], v13 offset:16384
  ds_read_b64_tr_b16 v[118:119], v13 offset:17408
  buffer_load_dwordx4 a[160:163], v3, s[36:39], s13 offen offset:0 sc1
  v_mfma_f32_32x32x16_bf16 v[192:207], v[120:123], a[132:135], v[192:207]
  s_waitcnt lgkmcnt(12)
  ds_read_b64_tr_b16 v[120:121], v12 offset:18432
  ds_read_b64_tr_b16 v[122:123], v12 offset:19456
  v_mfma_f32_32x32x16_bf16 v[208:223], v[124:127], a[132:135], v[208:223]
  s_waitcnt vmcnt(6) lgkmcnt(12)
  ds_read_b64_tr_b16 v[124:125], v13 offset:18432
  ds_read_b64_tr_b16 v[126:127], v13 offset:19456
  buffer_load_dwordx4 a[164:167], v3, s[36:39], s13 offen offset:1024 sc1
  v_mfma_f32_32x32x16_bf16 v[192:207], v[96:99], a[136:139], v[192:207]
  s_waitcnt lgkmcnt(12)
  ds_read_b64_tr_b16 v[96:97], v12 offset:20480
  ds_read_b64_tr_b16 v[98:99], v12 offset:21504
  v_mfma_f32_32x32x16_bf16 v[208:223], v[100:103], a[136:139], v[208:223]
  s_waitcnt vmcnt(6) lgkmcnt(12)
  ds_read_b64_tr_b16 v[100:101], v13 offset:20480
  ds_read_b64_tr_b16 v[102:103], v13 offset:21504
  buffer_load_dwordx4 a[168:171], v3, s[36:39], s14 offen offset:0 sc1
  v_mfma_f32_32x32x16_bf16 v[192:207], v[104:107], a[140:143], v[192:207]
  s_waitcnt lgkmcnt(12)
  ds_read_b64_tr_b16 v[104:105], v12 offset:22528
  ds_read_b64_tr_b16 v[106:107], v12 offset:23552
  v_mfma_f32_32x32x16_bf16 v[208:223], v[108:111], a[140:143], v[208:223]
  s_waitcnt vmcnt(6) lgkmcnt(12)
  ds_read_b64_tr_b16 v[108:109], v13 offset:22528
  ds_read_b64_tr_b16 v[110:111], v13 offset:23552
  buffer_load_dwordx4 a[172:175], v3, s[36:39], s14 offen offset:1024 sc1
  v_mfma_f32_32x32x16_bf16 v[192:207], v[112:115], a[144:147], v[192:207]
  s_waitcnt lgkmcnt(12)
  ds_read_b64_tr_b16 v[112:113], v12 offset:24576
  ds_read_b64_tr_b16 v[114:115], v12 offset:25600
  v_mfma_f32_32x32x16_bf16 v[208:223], v[116:119], a[144:147], v[208:223]
  s_waitcnt vmcnt(6) lgkmcnt(12)
  ds_read_b64_tr_b16 v[116:117], v13 offset:24576
  ds_read_b64_tr_b16 v[118:119], v13 offset:25600
  v_mfma_f32_32x32x16_bf16 v[192:207], v[120:123], a[148:151], v[192:207]
  s_waitcnt lgkmcnt(12)
  ds_read_b64_tr_b16 v[120:121], v12 offset:26624
  ds_read_b64_tr_b16 v[122:123], v12 offset:27648
  v_mfma_f32_32x32x16_bf16 v[208:223], v[124:127], a[148:151], v[208:223]
  s_waitcnt vmcnt(5) lgkmcnt(12)
  ds_read_b64_tr_b16 v[124:125], v13 offset:26624
  ds_read_b64_tr_b16 v[126:127], v13 offset:27648
  v_mfma_f32_32x32x16_bf16 v[192:207], v[96:99], a[152:155], v[192:207]
  s_waitcnt lgkmcnt(12)
  ds_read_b64_tr_b16 v[96:97], v12 offset:28672
  ds_read_b64_tr_b16 v[98:99], v12 offset:29696
  v_mfma_f32_32x32x16_bf16 v[208:223], v[100:103], a[152:155], v[208:223]
  s_waitcnt vmcnt(4) lgkmcnt(12)
  ds_read_b64_tr_b16 v[100:101], v13 offset:28672
  ds_read_b64_tr_b16 v[102:103], v13 offset:29696
  v_mfma_f32_32x32x16_bf16 v[192:207], v[104:107], a[156:159], v[192:207]
  s_waitcnt lgkmcnt(12)
  ds_read_b64_tr_b16 v[104:105], v12 offset:30720
  ds_read_b64_tr_b16 v[106:107], v12 offset:31744
  v_mfma_f32_32x32x16_bf16 v[208:223], v[108:111], a[156:159], v[208:223]
  s_waitcnt vmcnt(3) lgkmcnt(12)
  ds_read_b64_tr_b16 v[108:109], v13 offset:30720
  ds_read_b64_tr_b16 v[110:111], v13 offset:31744
  v_mfma_f32_32x32x16_bf16 v[192:207], v[112:115], a[160:163], v[192:207]
  s_waitcnt lgkmcnt(12)
  ds_read_b64_tr_b16 v[112:113], v12 offset:4096
  ds_read_b64_tr_b16 v[114:115], v12 offset:5120
  v_mfma_f32_32x32x16_bf16 v[208:223], v[116:119], a[160:163], v[208:223]
  s_waitcnt vmcnt(2) lgkmcnt(12)
  ds_read_b64_tr_b16 v[116:117], v13 offset:4096
  ds_read_b64_tr_b16 v[118:119], v13 offset:5120
  v_mfma_f32_32x32x16_bf16 v[192:207], v[120:123], a[164:167], v[192:207]
  s_waitcnt lgkmcnt(12)
  ds_read_b64_tr_b16 v[120:121], v12 offset:6144
  ds_read_b64_tr_b16 v[122:123], v12 offset:7168
  v_mfma_f32_32x32x16_bf16 v[208:223], v[124:127], a[164:167], v[208:223]
  s_waitcnt vmcnt(1) lgkmcnt(12)
  ds_read_b64_tr_b16 v[124:125], v13 offset:6144
  ds_read_b64_tr_b16 v[126:127], v13 offset:7168
  v_mfma_f32_32x32x16_bf16 v[192:207], v[96:99], a[168:171], v[192:207]
  s_waitcnt lgkmcnt(12)
  ds_read_b64_tr_b16 v[96:97], v10 offset:0
  ds_read_b64_tr_b16 v[98:99], v10 offset:1024
  v_mfma_f32_32x32x16_bf16 v[208:223], v[100:103], a[168:171], v[208:223]
  s_waitcnt vmcnt(0) lgkmcnt(12)
  ds_read_b64_tr_b16 v[100:101], v11 offset:0
  ds_read_b64_tr_b16 v[102:103], v11 offset:1024
  v_mfma_f32_32x32x16_bf16 v[192:207], v[104:107], a[172:175], v[192:207]
  s_waitcnt lgkmcnt(12)
  ds_read_b64_tr_b16 v[104:105], v10 offset:2048
  ds_read_b64_tr_b16 v[106:107], v10 offset:3072
  v_mov_b32 v0, 0x300
  buffer_store_dword v0, off, s[36:39], s72 sc1
  v_mfma_f32_32x32x16_bf16 v[208:223], v[108:111], a[172:175], v[208:223]
  ds_read_b64_tr_b16 v[108:109], v11 offset:2048
  ds_read_b64_tr_b16 v[110:111], v11 offset:3072
  buffer_load_dword v253, v9, s[36:39], s70 offen offset:192 sc1
  s_waitcnt vmcnt(0)
  v_cmp_gt_u32 vcc, 0x1, v253
  s_cbranch_vccnz L_spin_53_s
L_back_54_s:
  buffer_load_dwordx4 v[168:171], v4, s[28:31], s8 offen offset:0 sc1
  buffer_load_dwordx4 v[172:175], v4, s[28:31], s8 offen offset:1024 sc1
  buffer_load_dwordx4 a[176:179], v4, s[28:31], s9 offen offset:0 sc1
  buffer_load_dwordx4 a[180:183], v4, s[28:31], s9 offen offset:1024 sc1
  buffer_load_dwordx4 a[184:187], v4, s[28:31], s10 offen offset:0 sc1
  buffer_load_dwordx4 a[188:191], v4, s[28:31], s10 offen offset:1024 sc1
  buffer_load_dwordx4 a[192:195], v4, s[28:31], s11 offen offset:0 sc1
  buffer_load_dwordx4 a[196:199], v4, s[28:31], s11 offen offset:1024 sc1
  s_waitcnt vmcnt(7) lgkmcnt(14)
  v_mfma_f32_32x32x16_bf16 v[192:207], v[112:115], v[168:171], v[192:207]
  s_waitcnt lgkmcnt(12)
  ds_read_b64_tr_b16 v[112:113], v10 offset:4096
  ds_read_b64_tr_b16 v[114:115], v10 offset:5120
  v_mfma_f32_32x32x16_bf16 v[208:223], v[116:119], v[168:171], v[208:223]
  s_waitcnt vmcnt(6) lgkmcnt(12)
  ds_read_b64_tr_b16 v[116:117], v11 offset:4096
  ds_read_b64_tr_b16 v[118:119], v11 offset:5120
  buffer_load_dwordx4 a[200:203], v4, s[28:31], s12 offen offset:0 sc1
  v_mfma_f32_32x32x16_bf16 v[192:207], v[120:123], v[172:175], v[192:207]
  s_waitcnt lgkmcnt(12)
  ds_read_b64_tr_b16 v[120:121], v10 offset:6144
  ds_read_b64_tr_b16 v[122:123], v10 offset:7168
  v_mfma_f32_32x32x16_bf16 v[208:223], v[124:127], v[172:175], v[208:223]
  s_waitcnt vmcnt(6) lgkmcnt(12)
  ds_read_b64_tr_b16 v[124:125], v11 offset:6144
  ds_read_b64_tr_b16 v[126:127], v11 offset:7168
  buffer_load_dwordx4 a[204:207], v4, s[28:31], s12 offen offset:1024 sc1
  v_mfma_f32_32x32x16_bf16 v[192:207], v[96:99], a[176:179], v[192:207]
  s_waitcnt lgkmcnt(12)
  ds_read_b64_tr_b16 v[96:97], v10 offset:8192
  ds_read_b64_tr_b16 v[98:99], v10 offset:9216
  v_mfma_f32_32x32x16_bf16 v[208:223], v[100:103], a[176:179], v[208:223]
  s_waitcnt vmcnt(6) lgkmcnt(12)
  ds_read_b64_tr_b16 v[100:101], v11 offset:8192
  ds_read_b64_tr_b16 v[102:103], v11 offset:9216
  buffer_load_dwordx4 a[208:211], v4, s[28:31], s13 offen offset:0 sc1
  v_mfma_f32_32x32x16_bf16 v[192:207], v[104:107], a[180:183], v[192:207]
  s_waitcnt lgkmcnt(12)
  ds_read_b64_tr_b16 v[104:105], v10 offset:10240
  ds_read_b64_tr_b16 v[106:107], v10 offset:11264
  v_mfma_f32_32x32x16_bf16 v[208:223], v[108:111], a[180:183], v[208:223]
  s_waitcnt vmcnt(6) lgkmcnt(12)
  ds_read_b64_tr_b16 v[108:109], v11 offset:10240
  ds_read_b64_tr_b16 v[110:111], v11 offset:11264
  buffer_load_dwordx4 a[212:215], v4, s[28:31], s13 offen offset:1024 sc1
  v_mfma_f32_32x32x16_bf16 v[192:207], v[112:115], a[184:187], v[192:207]
  s_waitcnt lgkmcnt(12)
  ds_read_b64_tr_b16 v[112:113], v10 offset:12288
  ds_read_b64_tr_b16 v[114:115], v10 offset:13312
  v_mfma_f32_32x32x16_bf16 v[208:223], v[116:119], a[184:187], v[208:223]
  s_waitcnt vmcnt(6) lgkmcnt(12)
  ds_read_b64_tr_b16 v[116:117], v11 offset:12288
  ds_read_b64_tr_b16 v[118:119], v11 offset:13312
  buffer_load_dwordx4 a[216:219], v4, s[28:31], s14 offen offset:0 sc1
  v_mfma_f32_32x32x16_bf16 v[192:207], v[120:123], a[188:191], v[192:207]
  s_waitcnt lgkmcnt(12)
  ds_read_b64_tr_b16 v[120:121], v10 offset:14336
  ds_read_b64_tr_b16 v[122:123], v10 offset:15360
  v_mfma_f32_32x32x16_bf16 v[208:223], v[124:127], a[188:191], v[208:223]
  s_waitcnt vmcnt(6) lgkmcnt(12)
  ds_read_b64_tr_b16 v[124:125], v11 offset:14336
  ds_read_b64_tr_b16 v[126:127], v11 offset:15360
  buffer_load_dwordx4 a[220:223], v4, s[28:31], s14 offen offset:1024 sc1
  v_mfma_f32_32x32x16_bf16 v[192:207], v[96:99], a[192:195], v[192:207]
  s_waitcnt lgkmcnt(12)
  ds_read_b64_tr_b16 v[96:97], v10 offset:16384
  ds_read_b64_tr_b16 v[98:99], v10 offset:17408
  v_mfma_f32_32x32x16_bf16 v[208:223], v[100:103], a[192:195], v[208:223]
  s_waitcnt vmcnt(6) lgkmcnt(12)
  ds_read_b64_tr_b16 v[100:101], v11 offset:16384
  ds_read_b64_tr_b16 v[102:103], v11 offset:17408
  v_mfma_f32_32x32x16_bf16 v[192:207], v[104:107], a[196:199], v[192:207]
  s_waitcnt lgkmcnt(12)
  ds_read_b64_tr_b16 v[104:105], v10 offset:18432
  ds_read_b64_tr_b16 v[106:107], v10 offset:19456
  v_mfma_f32_32x32x16_bf16 v[208:223], v[108:111], a[196:199], v[208:223]
  s_waitcnt vmcnt(5) lgkmcnt(12)
  ds_read_b64_tr_b16 v[108:109], v11 offset:18432
  ds_read_b64_tr_b16 v[110:111], v11 offset:19456
  v_mfma_f32_32x32x16_bf16 v[192:207], v[112:115], a[200:203], v[192:207]
  s_waitcnt lgkmcnt(12)
  ds_read_b64_tr_b16 v[112:113], v10 offset:20480
  ds_read_b64_tr_b16 v[114:115], v10 offset:21504
  v_mfma_f32_32x32x16_bf16 v[208:223], v[116:119], a[200:203], v[208:223]
  s_waitcnt vmcnt(4) lgkmcnt(12)
  ds_read_b64_tr_b16 v[116:117], v11 offset:20480
  ds_read_b64_tr_b16 v[118:119], v11 offset:21504
  v_mfma_f32_32x32x16_bf16 v[192:207], v[120:123], a[204:207], v[192:207]
  s_waitcnt lgkmcnt(12)
  ds_read_b64_tr_b16 v[120:121], v10 offset:22528
  ds_read_b64_tr_b16 v[122:123], v10 offset:23552
  v_mfma_f32_32x32x16_bf16 v[208:223], v[124:127], a[204:207], v[208:223]
  s_waitcnt vmcnt(3) lgkmcnt(12)
  ds_read_b64_tr_b16 v[124:125], v11 offset:22528
  ds_read_b64_tr_b16 v[126:127], v11 offset:23552
  v_mfma_f32_32x32x16_bf16 v[192:207], v[96:99], a[208:211], v[192:207]
  s_waitcnt lgkmcnt(12)
  ds_read_b64_tr_b16 v[96:97], v10 offset:24576
  ds_read_b64_tr_b16 v[98:99], v10 offset:25600
  v_mfma_f32_32x32x16_bf16 v[208:223], v[100:103], a[208:211], v[208:223]
  s_waitcnt vmcnt(2) lgkmcnt(12)
  ds_read_b64_tr_b16 v[100:101], v11 offset:24576
  ds_read_b64_tr_b16 v[102:103], v11 offset:25600
  v_mfma_f32_32x32x16_bf16 v[192:207], v[104:107], a[212:215], v[192:207]
  s_waitcnt lgkmcnt(12)
  ds_read_b64_tr_b16 v[104:105], v10 offset:26624
  ds_read_b64_tr_b16 v[106:107], v10 offset:27648
  v_mfma_f32_32x32x16_bf16 v[208:223], v[108:111], a[212:215], v[208:223]
  s_waitcnt vmcnt(1) lgkmcnt(12)
  ds_read_b64_tr_b16 v[108:109], v11 offset:26624
  ds_read_b64_tr_b16 v[110:111], v11 offset:27648
  v_mfma_f32_32x32x16_bf16 v[192:207], v[112:115], a[216:219], v[192:207]
  s_waitcnt lgkmcnt(12)
  ds_read_b64_tr_b16 v[112:113], v10 offset:32768
  ds_read_b64_tr_b16 v[114:115], v10 offset:33792
  v_mfma_f32_32x32x16_bf16 v[208:223], v[116:119], a[216:219], v[208:223]
  s_waitcnt vmcnt(0) lgkmcnt(12)
  ds_read_b64_tr_b16 v[116:117], v11 offset:32768
  ds_read_b64_tr_b16 v[118:119], v11 offset:33792
  v_mfma_f32_32x32x16_bf16 v[192:207], v[120:123], a[220:223], v[192:207]
  s_waitcnt lgkmcnt(12)
  ds_read_b64_tr_b16 v[120:121], v10 offset:34816
  ds_read_b64_tr_b16 v[122:123], v10 offset:35840
  v_mov_b32 v0, 0x400
  buffer_store_dword v0, off, s[36:39], s72 sc1
  v_mfma_f32_32x32x16_bf16 v[208:223], v[124:127], a[220:223], v[208:223]
  ds_read_b64_tr_b16 v[124:125], v11 offset:34816
  ds_read_b64_tr_b16 v[126:127], v11 offset:35840
  buffer_load_dword v254, v9, s[36:39], s70 offen offset:256 sc1
  s_waitcnt vmcnt(0)
  v_cmp_gt_u32 vcc, 0x1, v254
  s_cbranch_vccnz L_spin_56_s
L_back_57_s:
  buffer_load_dwordx4 v[176:179], v7, s[36:39], s8 offen offset:0 sc1
  buffer_load_dwordx4 v[180:183], v7, s[36:39], s8 offen offset:1024 sc1
  buffer_load_dwordx4 a[0:3], v7, s[36:39], s9 offen offset:0 sc1
  buffer_load_dwordx4 a[4:7], v7, s[36:39], s9 offen offset:1024 sc1
  buffer_load_dwordx4 a[8:11], v7, s[36:39], s10 offen offset:0 sc1
  buffer_load_dwordx4 a[12:15], v7, s[36:39], s10 offen offset:1024 sc1
  buffer_load_dwordx4 a[16:19], v7, s[36:39], s11 offen offset:0 sc1
  buffer_load_dwordx4 a[20:23], v7, s[36:39], s11 offen offset:1024 sc1
  s_waitcnt vmcnt(7) lgkmcnt(14)
  v_mfma_f32_32x32x16_bf16 v[192:207], v[96:99], v[176:179], v[192:207]
  s_waitcnt lgkmcnt(12)
  ds_read_b64_tr_b16 v[96:97], v10 offset:36864
  ds_read_b64_tr_b16 v[98:99], v10 offset:37888
  v_mfma_f32_32x32x16_bf16 v[208:223], v[100:103], v[176:179], v[208:223]
  s_waitcnt vmcnt(6) lgkmcnt(12)
  ds_read_b64_tr_b16 v[100:101], v11 offset:36864
  ds_read_b64_tr_b16 v[102:103], v11 offset:37888
  buffer_load_dwordx4 a[24:27], v7, s[36:39], s12 offen offset:0 sc1
  v_mfma_f32_32x32x16_bf16 v[192:207], v[104:107], v[180:183], v[192:207]
  s_waitcnt lgkmcnt(12)
  ds_read_b64_tr_b16 v[104:105], v10 offset:38912
  ds_read_b64_tr_b16 v[106:107], v10 offset:39936
  v_mfma_f32_32x32x16_bf16 v[208:223], v[108:111], v[180:183], v[208:223]
  s_waitcnt vmcnt(6) lgkmcnt(12)
  ds_read_b64_tr_b16 v[108:109], v11 offset:38912
  ds_read_b64_tr_b16 v[110:111], v11 offset:39936
  buffer_load_dwordx4 a[28:31], v7, s[36:39], s12 offen offset:1024 sc1
  v_mfma_f32_32x32x16_bf16 v[192:207], v[112:115], a[0:3], v[192:207]
  s_waitcnt lgkmcnt(12)
  ds_read_b64_tr_b16 v[112:113], v10 offset:40960
  ds_read_b64_tr_b16 v[114:115], v10 offset:41984
  v_mfma_f32_32x32x16_bf16 v[208:223], v[116:119], a[0:3], v[208:223]
  s_waitcnt vmcnt(6) lgkmcnt(12)
  ds_read_b64_tr_b16 v[116:117], v11 offset:40960
  ds_read_b64_tr_b16 v[118:119], v11 offset:41984
  buffer_load_dwordx4 a[32:35], v7, s[36:39], s13 offen offset:0 sc1
  v_mfma_f32_32x32x16_bf16 v[192:207], v[120:123], a[4:7], v[192:207]
  s_waitcnt lgkmcnt(12)
  ds_read_b64_tr_b16 v[120:121], v10 offset:43008
  ds_read_b64_tr_b16 v[122:123], v10 offset:44032
  v_mfma_f32_32x32x16_bf16 v[208:223], v[124:127], a[4:7], v[208:223]
  s_waitcnt vmcnt(6) lgkmcnt(12)
  ds_read_b64_tr_b16 v[124:125], v11 offset:43008
  ds_read_b64_tr_b16 v[126:127], v11 offset:44032
  buffer_load_dwordx4 a[36:39], v7, s[36:39], s13 offen offset:1024 sc1
  v_mfma_f32_32x32x16_bf16 v[192:207], v[96:99], a[8:11], v[192:207]
  s_waitcnt lgkmcnt(12)
  ds_read_b64_tr_b16 v[96:97], v10 offset:45056
  ds_read_b64_tr_b16 v[98:99], v10 offset:46080
  v_mfma_f32_32x32x16_bf16 v[208:223], v[100:103], a[8:11], v[208:223]
  s_waitcnt vmcnt(6) lgkmcnt(12)
  ds_read_b64_tr_b16 v[100:101], v11 offset:45056
  ds_read_b64_tr_b16 v[102:103], v11 offset:46080
  buffer_load_dwordx4 a[40:43], v7, s[36:39], s14 offen offset:0 sc1
  v_mfma_f32_32x32x16_bf16 v[192:207], v[104:107], a[12:15], v[192:207]
  s_waitcnt lgkmcnt(12)
  ds_read_b64_tr_b16 v[104:105], v10 offset:47104
  ds_read_b64_tr_b16 v[106:107], v10 offset:48128
  v_mfma_f32_32x32x16_bf16 v[208:223], v[108:111], a[12:15], v[208:223]
  s_waitcnt vmcnt(6) lgkmcnt(12)
  ds_read_b64_tr_b16 v[108:109], v11 offset:47104
  ds_read_b64_tr_b16 v[110:111], v11 offset:48128
  buffer_load_dwordx4 a[44:47], v7, s[36:39], s14 offen offset:1024 sc1
  v_mfma_f32_32x32x16_bf16 v[192:207], v[112:115], a[16:19], v[192:207]
  s_waitcnt lgkmcnt(12)
  ds_read_b64_tr_b16 v[112:113], v10 offset:49152
  ds_read_b64_tr_b16 v[114:115], v10 offset:50176
  v_mfma_f32_32x32x16_bf16 v[208:223], v[116:119], a[16:19], v[208:223]
  s_waitcnt vmcnt(6) lgkmcnt(12)
  ds_read_b64_tr_b16 v[116:117], v11 offset:49152
  ds_read_b64_tr_b16 v[118:119], v11 offset:50176
  v_mfma_f32_32x32x16_bf16 v[192:207], v[120:123], a[20:23], v[192:207]
  s_waitcnt lgkmcnt(12)
  ds_read_b64_tr_b16 v[120:121], v10 offset:51200
  ds_read_b64_tr_b16 v[122:123], v10 offset:52224
  v_mfma_f32_32x32x16_bf16 v[208:223], v[124:127], a[20:23], v[208:223]
  s_waitcnt vmcnt(5) lgkmcnt(12)
  ds_read_b64_tr_b16 v[124:125], v11 offset:51200
  ds_read_b64_tr_b16 v[126:127], v11 offset:52224
  v_mfma_f32_32x32x16_bf16 v[192:207], v[96:99], a[24:27], v[192:207]
  s_waitcnt lgkmcnt(12)
  ds_read_b64_tr_b16 v[96:97], v10 offset:53248
  ds_read_b64_tr_b16 v[98:99], v10 offset:54272
  v_mfma_f32_32x32x16_bf16 v[208:223], v[100:103], a[24:27], v[208:223]
  s_waitcnt vmcnt(4) lgkmcnt(12)
  ds_read_b64_tr_b16 v[100:101], v11 offset:53248
  ds_read_b64_tr_b16 v[102:103], v11 offset:54272
  v_mfma_f32_32x32x16_bf16 v[192:207], v[104:107], a[28:31], v[192:207]
  s_waitcnt lgkmcnt(12)
  ds_read_b64_tr_b16 v[104:105], v10 offset:55296
  ds_read_b64_tr_b16 v[106:107], v10 offset:56320
  v_mfma_f32_32x32x16_bf16 v[208:223], v[108:111], a[28:31], v[208:223]
  s_waitcnt vmcnt(3) lgkmcnt(12)
  ds_read_b64_tr_b16 v[108:109], v11 offset:55296
  ds_read_b64_tr_b16 v[110:111], v11 offset:56320
  v_mfma_f32_32x32x16_bf16 v[192:207], v[112:115], a[32:35], v[192:207]
  s_waitcnt lgkmcnt(12)
  ds_read_b64_tr_b16 v[112:113], v10 offset:28672
  ds_read_b64_tr_b16 v[114:115], v10 offset:29696
  v_mfma_f32_32x32x16_bf16 v[208:223], v[116:119], a[32:35], v[208:223]
  s_waitcnt vmcnt(2) lgkmcnt(12)
  ds_read_b64_tr_b16 v[116:117], v11 offset:28672
  ds_read_b64_tr_b16 v[118:119], v11 offset:29696
  v_mfma_f32_32x32x16_bf16 v[192:207], v[120:123], a[36:39], v[192:207]
  s_waitcnt lgkmcnt(12)
  ds_read_b64_tr_b16 v[120:121], v10 offset:30720
  ds_read_b64_tr_b16 v[122:123], v10 offset:31744
  v_mfma_f32_32x32x16_bf16 v[208:223], v[124:127], a[36:39], v[208:223]
  s_waitcnt vmcnt(1) lgkmcnt(12)
  ds_read_b64_tr_b16 v[124:125], v11 offset:30720
  ds_read_b64_tr_b16 v[126:127], v11 offset:31744
  v_mfma_f32_32x32x16_bf16 v[192:207], v[96:99], a[40:43], v[192:207]
  s_waitcnt lgkmcnt(12)
  ds_read_b64_tr_b16 v[96:97], v10 offset:57344
  ds_read_b64_tr_b16 v[98:99], v10 offset:58368
  v_mfma_f32_32x32x16_bf16 v[208:223], v[100:103], a[40:43], v[208:223]
  s_waitcnt vmcnt(0) lgkmcnt(12)
  ds_read_b64_tr_b16 v[100:101], v11 offset:57344
  ds_read_b64_tr_b16 v[102:103], v11 offset:58368
  v_mfma_f32_32x32x16_bf16 v[192:207], v[104:107], a[44:47], v[192:207]
  s_waitcnt lgkmcnt(12)
  ds_read_b64_tr_b16 v[104:105], v10 offset:59392
  ds_read_b64_tr_b16 v[106:107], v10 offset:60416
  v_mov_b32 v0, 0x500
  buffer_store_dword v0, off, s[36:39], s72 sc1
  v_mfma_f32_32x32x16_bf16 v[208:223], v[108:111], a[44:47], v[208:223]
  ds_read_b64_tr_b16 v[108:109], v11 offset:59392
  ds_read_b64_tr_b16 v[110:111], v11 offset:60416
  buffer_load_dword v255, v9, s[36:39], s70 offen offset:320 sc1
  s_waitcnt vmcnt(0)
  v_cmp_gt_u32 vcc, 0x1, v255
  s_cbranch_vccnz L_spin_59_s
L_back_60_s:
  buffer_load_dwordx4 v[184:187], v8, s[28:31], s8 offen offset:0 sc1
  buffer_load_dwordx4 v[188:191], v8, s[28:31], s8 offen offset:1024 sc1
  buffer_load_dwordx4 a[48:51], v8, s[28:31], s9 offen offset:0 sc1
  buffer_load_dwordx4 a[52:55], v8, s[28:31], s9 offen offset:1024 sc1
  buffer_load_dwordx4 a[56:59], v8, s[28:31], s10 offen offset:0 sc1
  buffer_load_dwordx4 a[60:63], v8, s[28:31], s10 offen offset:1024 sc1
  buffer_load_dwordx4 a[64:67], v8, s[28:31], s11 offen offset:0 sc1
  buffer_load_dwordx4 a[68:71], v8, s[28:31], s11 offen offset:1024 sc1
  s_waitcnt vmcnt(7) lgkmcnt(14)
  v_mfma_f32_32x32x16_bf16 v[192:207], v[112:115], v[184:187], v[192:207]
  s_waitcnt lgkmcnt(12)
  ds_read_b64_tr_b16 v[112:113], v10 offset:61440
  ds_read_b64_tr_b16 v[114:115], v10 offset:62464
  v_mfma_f32_32x32x16_bf16 v[208:223], v[116:119], v[184:187], v[208:223]
  s_waitcnt vmcnt(6) lgkmcnt(12)
  ds_read_b64_tr_b16 v[116:117], v11 offset:61440
  ds_read_b64_tr_b16 v[118:119], v11 offset:62464
  buffer_load_dwordx4 a[72:75], v8, s[28:31], s12 offen offset:0 sc1
  v_mfma_f32_32x32x16_bf16 v[192:207], v[120:123], v[188:191], v[192:207]
  s_waitcnt lgkmcnt(12)
  ds_read_b64_tr_b16 v[120:121], v10 offset:63488
  ds_read_b64_tr_b16 v[122:123], v10 offset:64512
  v_mfma_f32_32x32x16_bf16 v[208:223], v[124:127], v[188:191], v[208:223]
  s_waitcnt vmcnt(6) lgkmcnt(12)
  ds_read_b64_tr_b16 v[124:125], v11 offset:63488
  ds_read_b64_tr_b16 v[126:127], v11 offset:64512
  buffer_load_dwordx4 a[76:79], v8, s[28:31], s12 offen offset:1024 sc1
  v_mfma_f32_32x32x16_bf16 v[192:207], v[96:99], a[48:51], v[192:207]
  s_waitcnt lgkmcnt(12)
  ds_read_b64_tr_b16 v[96:97], v14 offset:0
  ds_read_b64_tr_b16 v[98:99], v14 offset:1024
  v_mfma_f32_32x32x16_bf16 v[208:223], v[100:103], a[48:51], v[208:223]
  s_waitcnt vmcnt(6) lgkmcnt(12)
  ds_read_b64_tr_b16 v[100:101], v15 offset:0
  ds_read_b64_tr_b16 v[102:103], v15 offset:1024
  buffer_load_dwordx4 a[80:83], v8, s[28:31], s13 offen offset:0 sc1
  v_mfma_f32_32x32x16_bf16 v[192:207], v[104:107], a[52:55], v[192:207]
  s_waitcnt lgkmcnt(12)
  ds_read_b64_tr_b16 v[104:105], v14 offset:2048
  ds_read_b64_tr_b16 v[106:107], v14 offset:3072
  v_mfma_f32_32x32x16_bf16 v[208:223], v[108:111], a[52:55], v[208:223]
  s_waitcnt vmcnt(6) lgkmcnt(12)
  ds_read_b64_tr_b16 v[108:109], v15 offset:2048
  ds_read_b64_tr_b16 v[110:111], v15 offset:3072
  buffer_load_dwordx4 a[84:87], v8, s[28:31], s13 offen offset:1024 sc1
  v_mfma_f32_32x32x16_bf16 v[192:207], v[112:115], a[56:59], v[192:207]
  s_waitcnt lgkmcnt(12)
  ds_read_b64_tr_b16 v[112:113], v14 offset:4096
  ds_read_b64_tr_b16 v[114:115], v14 offset:5120
  v_mfma_f32_32x32x16_bf16 v[208:223], v[116:119], a[56:59], v[208:223]
  s_waitcnt vmcnt(6) lgkmcnt(12)
  ds_read_b64_tr_b16 v[116:117], v15 offset:4096
  ds_read_b64_tr_b16 v[118:119], v15 offset:5120
  buffer_load_dwordx4 a[88:91], v8, s[28:31], s14 offen offset:0 sc1
  v_mfma_f32_32x32x16_bf16 v[192:207], v[120:123], a[60:63], v[192:207]
  s_waitcnt lgkmcnt(12)
  ds_read_b64_tr_b16 v[120:121], v14 offset:6144
  ds_read_b64_tr_b16 v[122:123], v14 offset:7168
  v_mfma_f32_32x32x16_bf16 v[208:223], v[124:127], a[60:63], v[208:223]
  s_waitcnt vmcnt(6) lgkmcnt(12)
  ds_read_b64_tr_b16 v[124:125], v15 offset:6144
  ds_read_b64_tr_b16 v[126:127], v15 offset:7168
  buffer_load_dwordx4 a[92:95], v8, s[28:31], s14 offen offset:1024 sc1
  v_mfma_f32_32x32x16_bf16 v[192:207], v[96:99], a[64:67], v[192:207]
  s_waitcnt lgkmcnt(12)
  ds_read_b64_tr_b16 v[96:97], v14 offset:8192
  ds_read_b64_tr_b16 v[98:99], v14 offset:9216
  v_mfma_f32_32x32x16_bf16 v[208:223], v[100:103], a[64:67], v[208:223]
  s_waitcnt vmcnt(6) lgkmcnt(12)
  ds_read_b64_tr_b16 v[100:101], v15 offset:8192
  ds_read_b64_tr_b16 v[102:103], v15 offset:9216
  v_mfma_f32_32x32x16_bf16 v[192:207], v[104:107], a[68:71], v[192:207]
  s_waitcnt lgkmcnt(12)
  ds_read_b64_tr_b16 v[104:105], v14 offset:10240
  ds_read_b64_tr_b16 v[106:107], v14 offset:11264
  v_mfma_f32_32x32x16_bf16 v[208:223], v[108:111], a[68:71], v[208:223]
  s_waitcnt vmcnt(5) lgkmcnt(12)
  ds_read_b64_tr_b16 v[108:109], v15 offset:10240
  ds_read_b64_tr_b16 v[110:111], v15 offset:11264
  v_mfma_f32_32x32x16_bf16 v[192:207], v[112:115], a[72:75], v[192:207]
  s_waitcnt lgkmcnt(12)
  ds_read_b64_tr_b16 v[112:113], v14 offset:12288
  ds_read_b64_tr_b16 v[114:115], v14 offset:13312
  v_mfma_f32_32x32x16_bf16 v[208:223], v[116:119], a[72:75], v[208:223]
  s_waitcnt vmcnt(4) lgkmcnt(12)
  ds_read_b64_tr_b16 v[116:117], v15 offset:12288
  ds_read_b64_tr_b16 v[118:119], v15 offset:13312
  v_mfma_f32_32x32x16_bf16 v[192:207], v[120:123], a[76:79], v[192:207]
  s_waitcnt lgkmcnt(12)
  ds_read_b64_tr_b16 v[120:121], v14 offset:14336
  ds_read_b64_tr_b16 v[122:123], v14 offset:15360
  v_mfma_f32_32x32x16_bf16 v[208:223], v[124:127], a[76:79], v[208:223]
  s_waitcnt vmcnt(3) lgkmcnt(12)
  ds_read_b64_tr_b16 v[124:125], v15 offset:14336
  ds_read_b64_tr_b16 v[126:127], v15 offset:15360
  v_mfma_f32_32x32x16_bf16 v[192:207], v[96:99], a[80:83], v[192:207]
  s_waitcnt lgkmcnt(12)
  v_mfma_f32_32x32x16_bf16 v[208:223], v[100:103], a[80:83], v[208:223]
  s_waitcnt vmcnt(2) lgkmcnt(10)
  v_mfma_f32_32x32x16_bf16 v[192:207], v[104:107], a[84:87], v[192:207]
  s_waitcnt lgkmcnt(8)
  v_mfma_f32_32x32x16_bf16 v[208:223], v[108:111], a[84:87], v[208:223]
  s_waitcnt vmcnt(1) lgkmcnt(6)
  v_mfma_f32_32x32x16_bf16 v[192:207], v[112:115], a[88:91], v[192:207]
  s_waitcnt lgkmcnt(4)
  v_mfma_f32_32x32x16_bf16 v[208:223], v[116:119], a[88:91], v[208:223]
  s_waitcnt vmcnt(0) lgkmcnt(2)
  v_mfma_f32_32x32x16_bf16 v[192:207], v[120:123], a[92:95], v[192:207]
  s_waitcnt lgkmcnt(0)
  v_mov_b32 v0, 0x600
  buffer_store_dword v0, off, s[36:39], s72 sc1
  v_mfma_f32_32x32x16_bf16 v[208:223], v[124:127], a[92:95], v[208:223]
  s_nop 7
  v_cvt_pk_bf16_f32 v128, v192, v193
  v_cvt_pk_bf16_f32 v129, v194, v195
  v_or_b32 v128, 1, v128
  v_cvt_pk_bf16_f32 v130, v196, v197
  v_cvt_pk_bf16_f32 v131, v198, v199
  v_cvt_pk_bf16_f32 v132, v200, v201
  v_cvt_pk_bf16_f32 v133, v202, v203
  v_or_b32 v132, 1, v132
  v_cvt_pk_bf16_f32 v134, v204, v205
  v_cvt_pk_bf16_f32 v135, v206, v207
  v_pk_fma_f32 v[224:225], v[208:209], s[24:25], v[224:225]
  v_pk_fma_f32 v[226:227], v[210:211], s[24:25], v[226:227]
  v_pk_fma_f32 v[228:229], v[212:213], s[24:25], v[228:229]
  v_pk_fma_f32 v[230:231], v[214:215], s[24:25], v[230:231]
  v_pk_fma_f32 v[232:233], v[216:217], s[24:25], v[232:233]
  v_pk_fma_f32 v[234:235], v[218:219], s[24:25], v[234:235]
  buffer_store_dwordx4 v[128:131], v21, s[36:39], s74 offen offset:0 sc1
  buffer_store_dwordx4 v[132:135], v21, s[36:39], s74 offen offset:1024 sc1
  buffer_load_dwordx4 v[244:247], v21, s[36:39], s75 offen offset:0 sc1
  buffer_load_dwordx4 v[248:251], v21, s[36:39], s75 offen offset:1024 sc1
  buffer_load_dword v252, v6, s[36:39], s70 offen sc1
  v_pk_fma_f32 v[236:237], v[220:221], s[24:25], v[236:237]
  v_pk_fma_f32 v[238:239], v[222:223], s[24:25], v[238:239]
  s_lshl_b32 s57, s64, 15
  s_lshl_b32 s58, s99, 6
  s_add_u32 s57, s57, s58
  s_add_u32 s58, s57, 0x4000
  v_and_b32 v253, 31, v1
  v_lshrrev_b32 v254, 2, v253
  v_lshrrev_b32 v255, 5, v1
  v_xor_b32 v254, v254, v255
  v_and_b32 v254, 3, v254
  v_lshlrev_b32 v254, 4, v254
  v_lshl_add_u32 v253, v253, 6, v254
  v_add_u32 v253, s63, v253
  v_xor_b32 v254, 32, v253
  v_add_u32 v255, s63, v2
  v_lshrrev_b32 v0, 4, v1
  v_xor_b32 v0, v0, v1
  v_and_b32 v0, 3, v0
  v_lshlrev_b32 v0, 4, v0
  v_lshrrev_b32 v19, 2, v1
  v_lshl_add_u32 v19, v19, 10, v0
  s_waitcnt vmcnt(1)
  v_and_b32 v0, v244, v248
  v_lshlrev_b32 v0, 31, v0
  s_waitcnt vmcnt(0)
  v_min_u32 v0, v0, v252
  v_cmp_gt_u32 vcc, 0x600, v0
  s_cbranch_vccnz L_xspin_62_s
L_xback_63_s:
  v_lshlrev_b32 v128, 16, v244
  v_and_b32 v129, 0xffff0000, v244
  v_lshlrev_b32 v130, 16, v245
  v_and_b32 v131, 0xffff0000, v245
  v_lshlrev_b32 v132, 16, v246
  v_and_b32 v133, 0xffff0000, v246
  v_lshlrev_b32 v134, 16, v247
  v_and_b32 v135, 0xffff0000, v247
  v_pk_fma_f32 v[224:225], v[128:129], s[24:25], v[224:225]
  v_pk_fma_f32 v[226:227], v[130:131], s[24:25], v[226:227]
  v_pk_fma_f32 v[228:229], v[132:133], s[24:25], v[228:229]
  v_pk_fma_f32 v[230:231], v[134:135], s[24:25], v[230:231]
  v_cvt_pk_bf16_f32 v244, v224, v225
  v_cvt_pk_bf16_f32 v245, v226, v227
  v_cvt_pk_bf16_f32 v246, v228, v229
  v_cvt_pk_bf16_f32 v247, v230, v231
  s_nop 0
  v_permlane32_swap_b32 v244, v246
  v_permlane32_swap_b32 v245, v247
  ds_write_b128 v253, v[244:247] offset:16384
  v_lshlrev_b32 v136, 16, v248
  v_and_b32 v137, 0xffff0000, v248
  v_lshlrev_b32 v138, 16, v249
  v_and_b32 v139, 0xffff0000, v249
  v_lshlrev_b32 v140, 16, v250
  v_and_b32 v141, 0xffff0000, v250
  v_lshlrev_b32 v142, 16, v251
  v_and_b32 v143, 0xffff0000, v251
  v_pk_fma_f32 v[232:233], v[136:137], s[24:25], v[232:233]
  v_pk_fma_f32 v[234:235], v[138:139], s[24:25], v[234:235]
  v_pk_fma_f32 v[236:237], v[140:141], s[24:25], v[236:237]
  v_pk_fma_f32 v[238:239], v[142:143], s[24:25], v[238:239]
  v_cvt_pk_bf16_f32 v248, v232, v233
  v_cvt_pk_bf16_f32 v249, v234, v235
  v_cvt_pk_bf16_f32 v250, v236, v237
  v_cvt_pk_bf16_f32 v251, v238, v239
  s_nop 0
  v_permlane32_swap_b32 v248, v250
  v_permlane32_swap_b32 v249, v251
  ds_write_b128 v254, v[248:251] offset:16384
  ds_read_b128 v[244:247], v255 offset:16384
  ds_read_b128 v[248:251], v255 offset:17408
  s_waitcnt lgkmcnt(1)
  buffer_store_dwordx4 v[244:247], v19, s[28:31], s57 offen sc1
  s_waitcnt lgkmcnt(0)
  buffer_store_dwordx4 v[248:251], v19, s[28:31], s58 offen sc1
L_fin_s:
L_end_s:
  s_endpgm
  s_waitcnt vmcnt(0) lgkmcnt(0)
L_spin_9_s:
  s_movk_i32 s61, 0x3fff
L_spin_11_s:
  buffer_load_dword v31, v12, s[36:39], s51 offen offset:0 sc1
  s_waitcnt vmcnt(0)
  v_cmp_gt_u32 vcc, 0x1, v31
  s_cbranch_vccz L_back_10_s
  s_sub_u32 s61, s61, 1
  s_cbranch_scc0 L_spin_11_s
  s_branch L_back_10_s
L_spin_12_s:
  s_movk_i32 s61, 0x3fff
L_spin_14_s:
  buffer_load_dword v17, v6, s[36:39], s70 offen offset:64 sc1
  s_waitcnt vmcnt(0)
  v_cmp_gt_u32 vcc, 0x1, v17
  s_cbranch_vccz L_back_13_s
  s_sub_u32 s61, s61, 1
  s_cbranch_scc0 L_spin_14_s
  s_branch L_back_13_s
L_ewspin_15_s:
  s_movk_i32 s61, 0x3fff
L_ewspin_17_s:
  buffer_load_dwordx4 v[144:147], v20, s[36:39], s60 offen offset:0 sc1
  buffer_load_dwordx4 v[148:151], v20, s[36:39], s60 offen offset:512 sc1
  buffer_load_dwordx4 v[152:155], v20, s[36:39], s60 offen offset:1024 sc1
  buffer_load_dwordx4 v[156:159], v20, s[36:39], s60 offen offset:1536 sc1
  s_waitcnt vmcnt(0)
  v_min3_u32 v130, v145, v147, v149
  v_min3_u32 v131, v151, v153, v155
  v_min3_u32 v130, v157, v159, v130
  v_min_u32 v130, v130, v131
  v_cmp_eq_u32 vcc, 0, v130
  s_cbranch_vccz L_ewback_16_s
  s_sub_u32 s61, s61, 1
  s_cbranch_scc0 L_ewspin_17_s
  s_branch L_ewback_16_s
L_spin_18_s:
  s_movk_i32 s61, 0x3fff
L_spin_20_s:
  buffer_load_dword v17, v6, s[36:39], s70 offen offset:0 sc1
  s_waitcnt vmcnt(0)
  v_cmp_gt_u32 vcc, 0x200, v17
  s_cbranch_vccz L_back_19_s
  s_sub_u32 s61, s61, 1
  s_cbranch_scc0 L_spin_20_s
  s_branch L_back_19_s
L_catch_21_s:
  s_movk_i32 s61, 0x3fff
L_cspin_23_s:
  buffer_load_dword v252, v6, s[36:39], s70 offen offset:128 sc1
  s_waitcnt vmcnt(0)
  v_cmp_eq_u32 vcc, 0, v252
  s_cbranch_vccz L_cgo_24_s
  s_sub_u32 s61, s61, 1
  s_cbranch_scc0 L_cspin_23_s
L_cgo_24_s:
  buffer_load_dwordx4 a[128:131], v3, s[36:39], s9 offen offset:0 sc1
  buffer_load_dwordx4 a[132:135], v3, s[36:39], s9 offen offset:1024 sc1
  buffer_load_dwordx4 a[136:139], v3, s[36:39], s10 offen offset:0 sc1
  buffer_load_dwordx4 a[140:143], v3, s[36:39], s10 offen offset:1024 sc1
  buffer_load_dwordx4 a[144:147], v3, s[36:39], s11 offen offset:0 sc1
  buffer_load_dwordx4 a[148:151], v3, s[36:39], s11 offen offset:1024 sc1
  buffer_load_dwordx4 a[152:155], v3, s[36:39], s12 offen offset:0 sc1
  buffer_load_dwordx4 a[156:159], v3, s[36:39], s12 offen offset:1024 sc1
  buffer_load_dwordx4 a[160:163], v3, s[36:39], s13 offen offset:0 sc1
  buffer_load_dwordx4 a[164:167], v3, s[36:39], s13 offen offset:1024 sc1
  buffer_load_dwordx4 a[168:171], v3, s[36:39], s14 offen offset:0 sc1
  buffer_load_dwordx4 a[172:175], v3, s[36:39], s14 offen offset:1024 sc1
  s_waitcnt vmcnt(0)
  s_branch L_cback_22_s
L_catch_25_s:
  s_movk_i32 s61, 0x3fff
L_cspin_27_s:
  buffer_load_dword v253, v9, s[36:39], s70 offen offset:192 sc1
  s_waitcnt vmcnt(0)
  v_cmp_eq_u32 vcc, 0, v253
  s_cbranch_vccz L_cgo_28_s
  s_sub_u32 s61, s61, 1
  s_cbranch_scc0 L_cspin_27_s
L_cgo_28_s:
  buffer_load_dwordx4 a[176:179], v4, s[28:31], s9 offen offset:0 sc1
  buffer_load_dwordx4 a[180:183], v4, s[28:31], s9 offen offset:1024 sc1
  buffer_load_dwordx4 a[184:187], v4, s[28:31], s10 offen offset:0 sc1
  buffer_load_dwordx4 a[188:191], v4, s[28:31], s10 offen offset:1024 sc1
  buffer_load_dwordx4 a[192:195], v4, s[28:31], s11 offen offset:0 sc1
  buffer_load_dwordx4 a[196:199], v4, s[28:31], s11 offen offset:1024 sc1
  buffer_load_dwordx4 a[200:203], v4, s[28:31], s12 offen offset:0 sc1
  buffer_load_dwordx4 a[204:207], v4, s[28:31], s12 offen offset:1024 sc1
  buffer_load_dwordx4 a[208:211], v4, s[28:31], s13 offen offset:0 sc1
  buffer_load_dwordx4 a[212:215], v4, s[28:31], s13 offen offset:1024 sc1
  buffer_load_dwordx4 a[216:219], v4, s[28:31], s14 offen offset:0 sc1
  buffer_load_dwordx4 a[220:223], v4, s[28:31], s14 offen offset:1024 sc1
  s_waitcnt vmcnt(0)
  s_branch L_cback_26_s
L_spin_29_s:
  s_movk_i32 s61, 0x3fff
L_spin_31_s:
  buffer_load_dword v17, v6, s[36:39], s70 offen offset:0 sc1
  s_waitcnt vmcnt(0)
  v_cmp_gt_u32 vcc, 0x300, v17
  s_cbranch_vccz L_back_30_s
  s_sub_u32 s61, s61, 1
  s_cbranch_scc0 L_spin_31_s
  s_branch L_back_30_s
L_spin_32_s:
  s_movk_i32 s61, 0x3fff
L_spin_34_s:
  buffer_load_dword v254, v9, s[36:39], s70 offen offset:256 sc1
  s_waitcnt vmcnt(0)
  v_cmp_gt_u32 vcc, 0x1, v254
  s_cbranch_vccz L_back_33_s
  s_sub_u32 s61, s61, 1
  s_cbranch_scc0 L_spin_34_s
  s_branch L_back_33_s
L_spin_35_s:
  s_movk_i32 s61, 0x3fff
L_spin_37_s:
  buffer_load_dword v17, v6, s[36:39], s70 offen offset:0 sc1
  s_waitcnt vmcnt(0)
  v_cmp_gt_u32 vcc, 0x400, v17
  s_cbranch_vccz L_back_36_s
  s_sub_u32 s61, s61, 1
  s_cbranch_scc0 L_spin_37_s
  s_branch L_back_36_s
L_spin_38_s:
  s_movk_i32 s61, 0x3fff
L_spin_40_s:
  buffer_load_dword v255, v9, s[36:39], s70 offen offset:320 sc1
  s_waitcnt vmcnt(0)
  v_cmp_gt_u32 vcc, 0x1, v255
  s_cbranch_vccz L_back_39_s
  s_sub_u32 s61, s61, 1
  s_cbranch_scc0 L_spin_40_s
  s_branch L_back_39_s
L_spin_41_s:
  s_movk_i32 s61, 0x3fff
L_spin_43_s:
  buffer_load_dword v17, v6, s[36:39], s70 offen offset:0 sc1
  s_waitcnt vmcnt(0)
  v_cmp_gt_u32 vcc, 0x500, v17
  s_cbranch_vccz L_back_42_s
  s_sub_u32 s61, s61, 1
  s_cbranch_scc0 L_spin_43_s
  s_branch L_back_42_s
L_xspin_44_s:
  s_movk_i32 s61, 0x3fff
L_xspin_46_s:
  buffer_load_dwordx4 v[244:247], v21, s[36:39], s75 offen offset:0 sc1
  buffer_load_dwordx4 v[248:251], v21, s[36:39], s75 offen offset:1024 sc1
  buffer_load_dword v252, v6, s[36:39], s70 offen sc1
  s_waitcnt vmcnt(0)
  v_and_b32 v0, v244, v248
  v_lshlrev_b32 v0, 31, v0
  v_min_u32 v0, v0, v252
  v_cmp_gt_u32 vcc, 0x600, v0
  s_cbranch_vccz L_xback_45_s
  s_sub_u32 s61, s61, 1
  s_cbranch_scc0 L_xspin_46_s
  s_branch L_xback_45_s
L_spin_47_s:
  s_movk_i32 s61, 0x3fff
L_spin_49_s:
  buffer_load_dword v17, v6, s[36:39], s70 offen offset:64 sc1
  s_waitcnt vmcnt(0)
  v_cmp_gt_u32 vcc, 0x1, v17
  s_cbranch_vccz L_back_48_s
  s_sub_u32 s61, s61, 1
  s_cbranch_scc0 L_spin_49_s
  s_branch L_back_48_s
L_spin_50_s:
  s_movk_i32 s61, 0x3fff
L_spin_52_s:
  buffer_load_dword v252, v6, s[36:39], s70 offen offset:128 sc1
  s_waitcnt vmcnt(0)
  v_cmp_gt_u32 vcc, 0x1, v252
  s_cbranch_vccz L_back_51_s
  s_sub_u32 s61, s61, 1
  s_cbranch_scc0 L_spin_52_s
  s_branch L_back_51_s
L_spin_53_s:
  s_movk_i32 s61, 0x3fff
L_spin_55_s:
  buffer_load_dword v253, v9, s[36:39], s70 offen offset:192 sc1
  s_waitcnt vmcnt(0)
  v_cmp_gt_u32 vcc, 0x1, v253
  s_cbranch_vccz L_back_54_s
  s_sub_u32 s61, s61, 1
  s_cbranch_scc0 L_spin_55_s
  s_branch L_back_54_s
L_spin_56_s:
  s_movk_i32 s61, 0x3fff
L_spin_58_s:
  buffer_load_dword v254, v9, s[36:39], s70 offen offset:256 sc1
  s_waitcnt vmcnt(0)
  v_cmp_gt_u32 vcc, 0x1, v254
  s_cbranch_vccz L_back_57_s
  s_sub_u32 s61, s61, 1
  s_cbranch_scc0 L_spin_58_s
  s_branch L_back_57_s
L_spin_59_s:
  s_movk_i32 s61, 0x3fff
L_spin_61_s:
  buffer_load_dword v255, v9, s[36:39], s70 offen offset:320 sc1
  s_waitcnt vmcnt(0)
  v_cmp_gt_u32 vcc, 0x1, v255
  s_cbranch_vccz L_back_60_s
  s_sub_u32 s61, s61, 1
  s_cbranch_scc0 L_spin_61_s
  s_branch L_back_60_s
L_xspin_62_s:
  s_movk_i32 s61, 0x3fff
L_xspin_64_s:
  buffer_load_dwordx4 v[244:247], v21, s[36:39], s75 offen offset:0 sc1
  buffer_load_dwordx4 v[248:251], v21, s[36:39], s75 offen offset:1024 sc1
  buffer_load_dword v252, v6, s[36:39], s70 offen sc1
  s_waitcnt vmcnt(0)
  v_and_b32 v0, v244, v248
  v_lshlrev_b32 v0, 31, v0
  v_min_u32 v0, v0, v252
  v_cmp_gt_u32 vcc, 0x600, v0
  s_cbranch_vccz L_xback_63_s
  s_sub_u32 s61, s61, 1
  s_cbranch_scc0 L_xspin_64_s
  s_branch L_xback_63_s
.section .rodata,"a"
.p2align 6
.amdhsa_kernel sequential_preLN__linear_attn_block__dense_activation_mish__prompt_kernel
  .amdhsa_next_free_vgpr 512
  .amdhsa_next_free_sgpr 102
  .amdhsa_accum_offset 256
  .amdhsa_group_segment_fixed_size 0
  .amdhsa_kernarg_size 80
  .amdhsa_user_sgpr_count 2
  .amdhsa_user_sgpr_kernarg_segment_ptr 1
  .amdhsa_system_sgpr_workgroup_id_x 1
.end_amdhsa_kernel
```
